```python
import torch

def _softmax(x, axis=-1):
    return torch.softmax(x, dim=axis)
def _gelu(x):
    return torch.nn.functional.gelu(x, approximate="tanh")
def _silu(x):
    return torch.nn.functional.silu(x)
def _sigmoid(x):
    return torch.sigmoid(x)
def _layernorm(x, axis=-1, eps=1e-5):
    m = x.mean(dim=axis, keepdim=True)
    v = x.var(dim=axis, keepdim=True, unbiased=False)
    return (x - m) / torch.sqrt(v + eps)
def _scatter_add(tgt, idx, src, axis=0):
    return tgt.clone().index_add_(axis, idx, src)
def _segment_sum(src, seg, n):
    out = torch.zeros((n,) + src.shape[1:], dtype=src.dtype)
    return out.index_add_(0, seg, src)
def _pad(x, pw):
    flat = tuple(v for pair in reversed(pw) for v in pair)
    return torch.nn.functional.pad(x, flat)

kernel_name = 'parallel_sum__linear_kernel_hedgehog__glu_gated_bilinear__prompt'

def setup_inputs():

    _w = (lambda a: (lambda t: t.to(torch.bfloat16) if t.is_floating_point() else t)(torch.as_tensor(a)))
    def _A_setup():
        B, S, D, H = 1, 2048, 512, 32
        Dh = D // H
        return {
            "x": _w((lambda *s: torch.randn(*s, dtype=torch.bfloat16) * 0.05)(B, S, D)),
            "wqkv": _w((lambda *s: torch.randn(*s, dtype=torch.bfloat16) * 0.2)(D, 3 * D)),
            "w_phi": _w((lambda *s: torch.randn(*s, dtype=torch.bfloat16) * 0.2)(H, Dh, Dh) * (Dh ** -0.5)),
            "wo": _w((lambda *s: torch.randn(*s, dtype=torch.bfloat16) * 0.05)(D, D)),
        }
    _A_in = _A_setup()

    def _B_setup():
        B, S, D, F = 1, 2048, 512, 1792
        return {
            "x": _w((lambda *s: torch.randn(*s, dtype=torch.bfloat16) * 0.05)(B, S, D)),
            "w_gate": _w((lambda *s: torch.randn(*s, dtype=torch.bfloat16) * 0.4)(D, F) * (D ** -0.5)),
            "w_up": _w((lambda *s: torch.randn(*s, dtype=torch.bfloat16) * 0.4)(D, F) * (D ** -0.5)),
            "w_down": _w((lambda *s: torch.randn(*s, dtype=torch.bfloat16) * 0.4)(F, D) * (F ** -0.5)),
        }
    _B_in = _B_setup()

    return {
        "A_x": _A_in["x"],
        "A_wqkv": _A_in["wqkv"],
        "A_w_phi": _A_in["w_phi"],
        "A_wo": _A_in["wo"],
        "B_x": _B_in["x"],
        "B_w_gate": _B_in["w_gate"],
        "B_w_up": _B_in["w_up"],
        "B_w_down": _B_in["w_down"],
    }

def reference(A_x, A_wqkv, A_w_phi, A_wo, B_x, B_w_gate, B_w_up, B_w_down):
    def _A_ref(x, wqkv, w_phi, wo):
        B, S, D = x.shape
        H = 32; Dh = D // H
        qkv = (lambda x, *d: x.permute(*d))((x @ wqkv).reshape(B, S, 3, H, Dh), 2, 0, 3, 1, 4)
        q, k, v = qkv[0], qkv[1], qkv[2]
        pq = torch.einsum("bhsd,hdf->bhsf", q, w_phi)
        pk = torch.einsum("bhsd,hdf->bhsf", k, w_phi)
        phi_q = torch.concatenate([_softmax(pq, axis=-1), _softmax(-pq, axis=-1)], axis=-1)
        phi_k = torch.concatenate([_softmax(pk, axis=-1), _softmax(-pk, axis=-1)], axis=-1)
        kv = torch.einsum("bhsf,bhsd->bhfd", phi_k, v)
        z  = torch.einsum("bhsf->bhf", phi_k)
        num = torch.einsum("bhqf,bhfd->bhqd", phi_q, kv)
        den = torch.einsum("bhqf,bhf->bhq", phi_q, z)[..., None] + 1e-6
        o = num / den
        return (lambda x, *d: x.permute(*d))(o, 0, 2, 1, 3).reshape(B, S, D) @ wo

    def _B_ref(x, w_gate, w_up, w_down):
        g = torch.einsum("bsd,df->bsf", x, w_gate)
        u = torch.einsum("bsd,df->bsf", x, w_up)
        h = g * u
        return torch.einsum("bsf,fd->bsd", h, w_down)

    x = A_x
    xn = _layernorm(x, axis=-1)
    return x + _A_ref(xn, A_wqkv, A_w_phi, A_wo) + _B_ref(xn, B_w_gate, B_w_up, B_w_down)
```

```asm
; @launch grid=(256,1,1) block=(256,1,1) lds=163840
.amdgcn_target "amdgcn-amd-amdhsa--gfx950"
.text
.globl parallel_sum__linear_kernel_hedgehog__glu_gated_bilinear__prompt_kernel
.p2align 8
.type parallel_sum__linear_kernel_hedgehog__glu_gated_bilinear__prompt_kernel,@function
parallel_sum__linear_kernel_hedgehog__glu_gated_bilinear__prompt_kernel:
    s_cmp_ge_u32 s2, 256
    s_cbranch_scc1 L_exit
    s_load_dwordx2 s[4:5], s[0:1], 0
    s_load_dwordx2 s[8:9], s[0:1], 8
    s_load_dwordx2 s[12:13], s[0:1], 40
    s_load_dwordx2 s[16:17], s[0:1], 48
    s_load_dwordx2 s[28:29], s[0:1], 80
    s_load_dwordx2 s[40:41], s[0:1], 16
    s_load_dwordx2 s[24:25], s[0:1], 24
    s_load_dwordx2 s[20:21], s[0:1], 56
    s_load_dwordx2 s[32:33], s[0:1], 64
    s_load_dwordx2 s[36:37], s[0:1], 72
    v_lshrrev_b32 v1, 6, v0
    v_and_b32 v197, 63, v0
    v_readfirstlane_b32 s44, v1
    s_and_b32 s55, s2, 7
    s_lshr_b32 s54, s2, 3
    s_and_b32 s47, s55, 1
    s_lshl_b32 s47, s47, 3
    s_and_b32 s83, s54, 7
    s_add_u32 s47, s47, s83
    s_lshr_b32 s48, s55, 1
    s_lshr_b32 s49, s54, 3
    s_and_b32 s50, s49, 1
    s_lshl_b32 s51, s48, 1
    s_add_u32 s51, s51, s50
    s_and_b32 s45, s44, 1
    s_lshr_b32 s46, s44, 1
    s_xor_b32 s3, s45, s46
    s_lshl_b32 s81, s44, 11
    s_mul_i32 s80, s46, 8224
    s_lshl_b32 s84, s45, 12
    s_add_u32 s80, s80, s84
    s_mov_b32 s56, 0
    s_mov_b32 s64, 0
    s_mov_b32 s72, 0
    s_lshl_b32 s83, s47, 2
    s_add_u32 s83, s83, s44
    s_lshl_b32 s83, s83, 15
    v_lshrrev_b32 v2, 3, v197
    v_lshlrev_b32 v2, 10, v2
    v_add_u32 v2, s83, v2
    v_lshrrev_b32 v3, 4, v197
    v_xor_b32 v3, v3, v197
    v_and_b32 v3, 7, v3
    v_lshl_add_u32 v182, v3, 4, v2
    v_add_u32 v184, 14336, v182
    v_xor_b32 v3, 4, v3
    v_lshl_add_u32 v183, v3, 4, v2
    v_add_u32 v183, 7168, v183
    v_add_u32 v185, 14336, v183
    s_mov_b32 s6, 0x200000
    s_mov_b32 s7, 0x20000
    s_mov_b32 s10, 0x180000
    s_mov_b32 s11, 0x20000
    s_mov_b32 s14, 0x1c0000
    s_mov_b32 s15, 0x20000
    s_mov_b32 s18, 0x1c0000
    s_mov_b32 s19, 0x20000
    s_waitcnt lgkmcnt(0)
    s_add_u32 m0, s80, 0
    s_nop 0
    buffer_load_dwordx4 v182, s[4:7], s56 offen lds
    buffer_load_dwordx4 v183, s[4:7], s56 offen offset:1024 lds
    buffer_load_dwordx4 v184, s[4:7], s56 offen offset:2048 lds
    buffer_load_dwordx4 v185, s[4:7], s56 offen offset:3072 lds
    s_cmp_ge_u32 s49, 2
    s_cbranch_scc1 L_proB
    s_lshl_b32 s83, s51, 7
    s_add_u32 s83, s83, 1024
    s_mul_i32 s84, s44, 49152
    s_add_u32 s84, s84, s83
    v_lshrrev_b32 v240, 3, v197
    v_mul_u32_u24 v240, 3072, v240
    v_bfe_u32 v241, v197, 4, 1
    v_lshlrev_b32 v241, 2, v241
    v_xor_b32 v241, v241, v197
    v_and_b32 v241, 7, v241
    v_lshl_add_u32 v240, v241, 4, v240
    v_add_u32 v186, s84, v240
    s_add_u32 m0, s81, 65792
    v_add_u32 v187, 23552, v186
    buffer_load_dwordx4 v186, s[8:11], s64 offen lds
    buffer_load_dwordx4 v187, s[8:11], s64 offen offset:1024 lds
    s_add_u32 m0, s81, 74016
    s_add_u32 s83, s64, 1024
    buffer_load_dwordx4 v186, s[8:11], s83 offen lds
    buffer_load_dwordx4 v187, s[8:11], s83 offen offset:1024 lds
    s_lshl_b32 s83, s48, 1
    s_add_u32 s83, s83, s49
    s_lshl_b32 s83, s83, 1
    s_add_u32 s83, s83, s47
    s_mul_i32 s84, s83, 37
    s_lshr_b32 s84, s84, 8
    s_mul_i32 s84, s84, 7
    s_sub_u32 s85, s83, s84
    s_add_u32 s84, s85, 1
    s_sub_u32 s83, s84, 7
    s_cmp_gt_u32 s84, 7
    s_cselect_b32 s84, s83, s84
    s_lshl_b32 s57, s84, 7
    s_mul_i32 s65, s84, 196608
    s_mul_i32 s73, s84, 229376
    s_lshl_b32 s82, s44, 10
    s_and_b32 s55, s2, 7
    s_and_b32 s52, s55, 3
    s_lshl_b32 s52, s52, 3
    s_and_b32 s83, s54, 7
    s_add_u32 s52, s52, s83
    s_lshr_b32 s53, s55, 2
    s_lshl_b32 s53, s53, 2
    s_lshr_b32 s83, s54, 3
    s_add_u32 s53, s53, s83
    s_xor_b32 s53, s53, 2
    s_mov_b32 s22, 0x1c0000
    s_mov_b32 s23, 0x20000
    s_mov_b32 s26, 0x80000
    s_mov_b32 s27, 0x20000
    s_mov_b32 s30, 0x10000000
    s_mov_b32 s31, 0x20000
    s_mov_b32 s34, 0x200000
    s_mov_b32 s35, 0x20000
    s_mov_b32 s38, 0x100
    s_mov_b32 s39, 0x20000
    s_mov_b32 s42, 0x4000
    s_mov_b32 s43, 0x20000
    s_getpc_b64 s[86:87]
L_pcA:
    s_add_u32 s86, s86, L_mainA-L_pcA
    s_addc_u32 s87, s87, 0
    s_bfe_u32 s83, s2, 0x40003
    s_lshl_b32 s83, s83, 2
    s_add_u32 s83, s83, s44
    s_lshl_b32 s83, s83, 9
    v_and_b32 v76, 3, v197
    v_lshl_add_u32 v76, v76, 7, s83
    v_min_u32 v76, L_endA-L_mainA-4, v76
    v_mov_b32 v77, s87
    v_add_co_u32 v76, vcc, s86, v76
    s_nop 1
    v_addc_co_u32 v77, vcc, 0, v77, vcc
    global_load_dword v78, v[76:77], off
    s_mov_b64 exec, 0
    s_cmp_eq_u32 s44, 0
    s_cbranch_scc1 L_padA0_0
    s_cmp_eq_u32 s44, 1
    s_cbranch_scc1 L_padA0_1
    s_cmp_eq_u32 s44, 2
    s_cbranch_scc1 L_padA0_2
    s_branch L_padA0_3
L_retA0:
    s_mov_b64 exec, -1
    s_lshl_b32 s83, s51, 2
    s_lshl_b32 s84, s46, 1
    s_add_u32 s83, s83, s84
    s_lshl_b32 s83, s83, 9
    v_bfe_u32 v240, v197, 4, 1
    v_xor_b32 v240, s45, v240
    v_lshlrev_b32 v240, 9, v240
    v_lshrrev_b32 v241, 5, v197
    v_lshl_add_u32 v240, v241, 7, v240
    v_and_b32 v241, 15, v197
    v_lshl_add_u32 v240, v241, 1, v240
    v_add_u32 v240, s83, v240
    buffer_load_ushort v80, v240, s[40:43], 0 offen offset:0
    buffer_load_ushort v81, v240, s[40:43], 0 offen offset:32
    buffer_load_ushort v82, v240, s[40:43], 0 offen offset:64
    buffer_load_ushort v83, v240, s[40:43], 0 offen offset:96
    buffer_load_ushort v84, v240, s[40:43], 0 offen offset:256
    buffer_load_ushort v85, v240, s[40:43], 0 offen offset:288
    buffer_load_ushort v86, v240, s[40:43], 0 offen offset:320
    buffer_load_ushort v87, v240, s[40:43], 0 offen offset:352
    s_add_u32 m0, s80, 16448
    s_nop 0
    buffer_load_dwordx4 v182, s[4:7], s57 offen lds
    buffer_load_dwordx4 v183, s[4:7], s57 offen offset:1024 lds
    buffer_load_dwordx4 v184, s[4:7], s57 offen offset:2048 lds
    buffer_load_dwordx4 v185, s[4:7], s57 offen offset:3072 lds
    s_add_u32 m0, s81, 82240
    s_nop 0
    buffer_load_dwordx4 v186, s[8:11], s65 offen lds
    buffer_load_dwordx4 v187, s[8:11], s65 offen offset:1024 lds
    s_add_u32 m0, s81, 90464
    s_add_u32 s83, s65, 1024
    buffer_load_dwordx4 v186, s[8:11], s83 offen lds
    buffer_load_dwordx4 v187, s[8:11], s83 offen offset:1024 lds
    s_branch L_mainA
L_proB:
    s_mul_i32 s83, s48, 896
    s_lshl_b32 s84, s50, 7
    s_add_u32 s83, s83, s84
    s_mul_i32 s84, s44, 57344
    s_add_u32 s84, s84, s83
    v_lshrrev_b32 v240, 3, v197
    v_mul_u32_u24 v240, 3584, v240
    v_bfe_u32 v241, v197, 4, 1
    v_lshlrev_b32 v241, 2, v241
    v_xor_b32 v241, v241, v197
    v_and_b32 v241, 7, v241
    v_lshl_add_u32 v240, v241, 4, v240
    v_add_u32 v188, s84, v240
    s_add_u32 m0, s81, 65792
    v_add_u32 v189, 27648, v188
    buffer_load_dwordx4 v188, s[12:15], s72 offen lds
    buffer_load_dwordx4 v189, s[12:15], s72 offen offset:1024 lds
    s_add_u32 m0, s81, 74016
    s_nop 0
    buffer_load_dwordx4 v188, s[16:19], s72 offen lds
    buffer_load_dwordx4 v189, s[16:19], s72 offen offset:1024 lds
    s_lshl_b32 s83, s48, 1
    s_add_u32 s83, s83, s49
    s_lshl_b32 s83, s83, 1
    s_add_u32 s83, s83, s47
    s_mul_i32 s84, s83, 37
    s_lshr_b32 s84, s84, 8
    s_mul_i32 s84, s84, 7
    s_sub_u32 s85, s83, s84
    s_add_u32 s84, s85, 1
    s_sub_u32 s83, s84, 7
    s_cmp_gt_u32 s84, 7
    s_cselect_b32 s84, s83, s84
    s_lshl_b32 s57, s84, 7
    s_mul_i32 s65, s84, 196608
    s_mul_i32 s73, s84, 229376
    s_lshl_b32 s82, s44, 10
    s_and_b32 s55, s2, 7
    s_and_b32 s52, s55, 3
    s_lshl_b32 s52, s52, 3
    s_and_b32 s83, s54, 7
    s_add_u32 s52, s52, s83
    s_lshr_b32 s53, s55, 2
    s_lshl_b32 s53, s53, 2
    s_lshr_b32 s83, s54, 3
    s_add_u32 s53, s53, s83
    s_xor_b32 s53, s53, 2
    s_mov_b32 s22, 0x1c0000
    s_mov_b32 s23, 0x20000
    s_mov_b32 s26, 0x80000
    s_mov_b32 s27, 0x20000
    s_mov_b32 s30, 0x10000000
    s_mov_b32 s31, 0x20000
    s_mov_b32 s34, 0x200000
    s_mov_b32 s35, 0x20000
    s_mov_b32 s38, 0x100
    s_mov_b32 s39, 0x20000
    s_mov_b32 s42, 0x4000
    s_mov_b32 s43, 0x20000
    s_getpc_b64 s[86:87]
L_pcB:
    s_add_u32 s86, s86, L_mainB-L_pcB
    s_addc_u32 s87, s87, 0
    s_bfe_u32 s83, s2, 0x40003
    s_lshl_b32 s83, s83, 2
    s_add_u32 s83, s83, s44
    s_lshl_b32 s83, s83, 9
    v_and_b32 v76, 3, v197
    v_lshl_add_u32 v76, v76, 7, s83
    v_min_u32 v76, L_endB-L_mainB-4, v76
    v_mov_b32 v77, s87
    v_add_co_u32 v76, vcc, s86, v76
    s_nop 1
    v_addc_co_u32 v77, vcc, 0, v77, vcc
    global_load_dword v78, v[76:77], off
    s_mov_b64 exec, 0
    s_cmp_eq_u32 s44, 0
    s_cbranch_scc1 L_padB0_0
    s_cmp_eq_u32 s44, 1
    s_cbranch_scc1 L_padB0_1
    s_cmp_eq_u32 s44, 2
    s_cbranch_scc1 L_padB0_2
    s_branch L_padB0_3
L_retB0:
    s_mov_b64 exec, -1
    s_lshl_b32 s83, s51, 2
    s_lshl_b32 s84, s46, 1
    s_add_u32 s83, s83, s84
    s_lshl_b32 s83, s83, 9
    v_bfe_u32 v240, v197, 4, 1
    v_lshlrev_b32 v240, 9, v240
    v_lshrrev_b32 v241, 5, v197
    v_lshl_add_u32 v240, v241, 7, v240
    v_and_b32 v241, 15, v197
    v_lshl_add_u32 v240, v241, 1, v240
    v_add_u32 v240, s83, v240
    buffer_load_ushort v80, v240, s[40:43], 0 offen offset:0
    buffer_load_ushort v81, v240, s[40:43], 0 offen offset:32
    buffer_load_ushort v82, v240, s[40:43], 0 offen offset:64
    buffer_load_ushort v83, v240, s[40:43], 0 offen offset:96
    buffer_load_ushort v84, v240, s[40:43], 0 offen offset:256
    buffer_load_ushort v85, v240, s[40:43], 0 offen offset:288
    buffer_load_ushort v86, v240, s[40:43], 0 offen offset:320
    buffer_load_ushort v87, v240, s[40:43], 0 offen offset:352
    s_add_u32 m0, s80, 16448
    s_nop 0
    buffer_load_dwordx4 v182, s[4:7], s57 offen lds
    buffer_load_dwordx4 v183, s[4:7], s57 offen offset:1024 lds
    buffer_load_dwordx4 v184, s[4:7], s57 offen offset:2048 lds
    buffer_load_dwordx4 v185, s[4:7], s57 offen offset:3072 lds
    s_add_u32 m0, s81, 82240
    s_nop 0
    buffer_load_dwordx4 v188, s[12:15], s73 offen lds
    buffer_load_dwordx4 v189, s[12:15], s73 offen offset:1024 lds
    s_add_u32 m0, s81, 90464
    s_nop 0
    buffer_load_dwordx4 v188, s[16:19], s73 offen lds
    buffer_load_dwordx4 v189, s[16:19], s73 offen offset:1024 lds
    s_branch L_mainB
L_exit:
    s_endpgm
.p2align 12
L_mainA:
    s_add_u32 s84, s85, 2
    s_sub_u32 s83, s84, 7
    s_cmp_gt_u32 s84, 7
    s_cselect_b32 s84, s83, s84
    s_lshl_b32 s58, s84, 7
    s_mul_i32 s66, s84, 196608
    s_mul_i32 s74, s84, 229376
    s_add_u32 s84, s85, 3
    s_sub_u32 s83, s84, 7
    s_cmp_gt_u32 s84, 7
    s_cselect_b32 s84, s83, s84
    s_lshl_b32 s59, s84, 7
    s_mul_i32 s67, s84, 196608
    s_mul_i32 s75, s84, 229376
    s_add_u32 s84, s85, 4
    s_sub_u32 s83, s84, 7
    s_cmp_gt_u32 s84, 7
    s_cselect_b32 s84, s83, s84
    s_lshl_b32 s60, s84, 7
    s_mul_i32 s68, s84, 196608
    s_mul_i32 s76, s84, 229376
    s_add_u32 s84, s85, 5
    s_sub_u32 s83, s84, 7
    s_cmp_gt_u32 s84, 7
    s_cselect_b32 s84, s83, s84
    s_lshl_b32 s61, s84, 7
    s_mul_i32 s69, s84, 196608
    s_mul_i32 s77, s84, 229376
    s_add_u32 s84, s85, 6
    s_sub_u32 s83, s84, 7
    s_cmp_gt_u32 s84, 7
    s_cselect_b32 s84, s83, s84
    s_lshl_b32 s62, s84, 7
    s_mul_i32 s70, s84, 196608
    s_mul_i32 s78, s84, 229376
    s_add_u32 s84, s85, 7
    s_sub_u32 s83, s84, 7
    s_cmp_gt_u32 s84, 7
    s_cselect_b32 s84, s83, s84
    s_lshl_b32 s63, s84, 7
    s_mul_i32 s71, s84, 196608
    s_mul_i32 s79, s84, 229376
    v_lshrrev_b32 v240, 5, v197
    v_bfe_u32 v241, v197, 1, 3
    v_xor_b32 v240, v240, v241
    v_lshlrev_b32 v240, 4, v240
    v_and_b32 v241, 31, v197
    v_lshl_add_u32 v240, v241, 7, v240
    s_lshl_b32 s83, s3, 6
    v_xor_b32 v240, s83, v240
    s_mul_i32 s84, s45, 8224
    v_add_u32 v174, s84, v240
    v_xor_b32 v241, 32, v240
    v_add_u32 v175, s84, v241
    v_xor_b32 v241, 64, v240
    v_add_u32 v176, s84, v241
    v_xor_b32 v241, 0x60, v240
    v_add_u32 v177, s84, v241
    v_and_b32 v240, 31, v197
    v_mov_b32 v241, 0x3f803f80
    v_cmp_eq_u32 vcc, 0, v240
    s_nop 1
    v_cndmask_b32 v144, 0, v241, vcc
    v_cmp_eq_u32 vcc, 20, v240
    s_nop 1
    v_cndmask_b32 v144, v144, v241, vcc
    v_cmp_eq_u32 vcc, 8, v240
    s_nop 1
    v_cndmask_b32 v148, 0, v241, vcc
    v_cmp_eq_u32 vcc, 28, v240
    s_nop 1
    v_cndmask_b32 v148, v148, v241, vcc
    v_mov_b32 v145, v144
    v_mov_b32 v149, v148
    v_mov_b32 v146, v144
    v_mov_b32 v150, v148
    v_mov_b32 v147, v144
    v_mov_b32 v151, v148
    v_lshrrev_b32 v240, 5, v197
    v_lshlrev_b32 v240, 10, v240
    v_bfe_u32 v241, v197, 2, 2
    v_lshl_add_u32 v240, v241, 7, v240
    v_and_b32 v241, 3, v197
    v_lshl_add_u32 v240, v241, 3, v240
    v_bfe_u32 v241, v197, 3, 1
    v_xor_b32 v241, s46, v241
    v_lshl_add_u32 v240, v241, 6, v240
    v_bfe_u32 v241, v197, 4, 1
    v_xor_b32 v241, s45, v241
    v_lshl_add_u32 v240, v241, 5, v240
    s_lshl_b32 s83, s3, 12
    s_xor_b32 s84, s83, 4096
    v_add_u32 v240, 65792, v240
    v_add_u32 v178, s83, v240
    v_add_u32 v179, s84, v240
    s_mul_i32 s83, s48, 896
    s_lshl_b32 s84, s50, 7
    s_add_u32 s83, s83, s84
    s_add_u32 s83, s83, 512
    s_mul_i32 s84, s44, 57344
    s_add_u32 s84, s84, s83
    v_lshrrev_b32 v240, 3, v197
    v_mul_u32_u24 v240, 3584, v240
    v_bfe_u32 v241, v197, 4, 1
    v_lshlrev_b32 v241, 2, v241
    v_xor_b32 v241, v241, v197
    v_and_b32 v241, 7, v241
    v_lshl_add_u32 v240, v241, 4, v240
    v_add_u32 v188, s84, v240
    v_add_u32 v189, 27648, v188
    s_lshl_b32 s83, s47, 1
    s_add_u32 s83, s83, s45
    s_lshl_b32 s84, s83, 2
    s_add_u32 s84, s84, s48
    s_lshl_b32 s84, s84, 5
    s_add_u32 s84, s84, s49
    s_lshl_b32 s84, s84, 1
    s_add_u32 s84, s84, s46
    s_lshl_b32 s84, s84, 2
    s_add_u32 s84, s84, 10747904
    v_mov_b32 v252, 1073741824
    v_writelane_b32 v252, s84, 0
    v_mov_b32 v96, 0
    s_lshl_b32 s83, s51, 2
    s_lshl_b32 s84, s46, 1
    s_add_u32 s83, s83, s84
    s_add_u32 s83, s83, s45
    s_lshl_b32 s83, s83, 4
    s_add_u32 s83, s83, s47
    s_mul_i32 s83, s83, 2176
    s_add_u32 s83, s83, 12582912
    v_and_b32 v240, 31, v197
    v_lshrrev_b32 v241, 5, v197
    v_lshl_add_u32 v242, v241, 4, v240
    v_add_u32 v241, 32, v241
    v_cmp_gt_u32 vcc, 16, v240
    s_nop 1
    v_cndmask_b32 v242, v241, v242, vcc
    v_lshl_add_u32 v254, v242, 4, s83
    v_mov_b32 v241, 1073741824
    v_cmp_gt_u32 vcc, 17, v240
    s_nop 1
    v_cndmask_b32 v254, v241, v254, vcc
    v_mov_b32 v98, -1
    v_mov_b32 v99, -1
    v_mov_b32 v100, -1
    v_mov_b32 v101, -1
    s_mov_b32 s54, 0
    s_mov_b32 s55, -1
    v_mov_b32 v170, 0
    v_mov_b32 v171, 0
    v_and_b32 v240, 3, v197
    v_cmp_eq_u32 s[86:87], 1, v240
    v_cmp_eq_u32 s[88:89], 2, v240
    v_cmp_eq_u32 s[90:91], 3, v240
    v_and_b32 v240, 4, v197
    v_cmp_eq_u32 s[92:93], 4, v240
    s_mul_i32 s94, s44, 458752
    s_lshl_b32 s95, s44, 17
    s_mov_b32 s96, 0x3b000000
    s_lshl_b32 s83, s47, 1
    s_add_u32 s83, s83, s45
    s_mul_i32 s83, s83, 144
    s_mul_i32 s84, s48, 36
    s_add_u32 s83, s83, s84
    s_lshl_b32 s84, s50, 2
    s_add_u32 s83, s83, s84
    s_lshl_b32 s84, s46, 1
    s_add_u32 s83, s83, s84
    s_lshl_b32 s83, s83, 11
    v_lshl_add_u32 v196, v197, 4, s83
    v_lshrrev_b32 v240, 3, v197
    v_lshlrev_b32 v240, 10, v240
    v_bfe_u32 v241, v197, 4, 1
    v_lshlrev_b32 v241, 2, v241
    v_xor_b32 v241, v241, v197
    v_and_b32 v241, 7, v241
    v_lshl_add_u32 v240, v241, 4, v240
    s_lshl_b32 s83, s53, 7
    v_add_u32 v198, s83, v240
    v_add_u32 v199, 7168, v198
    s_and_b32 s83, s2, 63
    s_lshl_b32 s83, s83, 2
    s_add_u32 s83, s83, 0
    s_cmp_eq_u32 s44, 0
    s_cselect_b32 s83, s83, 1073741824
    v_mov_b32 v208, 1073741824
    v_writelane_b32 v208, s83, 0
    s_lshl_b32 s83, s46, 8
    s_lshl_b32 s84, s45, 7
    s_add_u32 s83, s83, s84
    s_add_u32 s83, s83, 156416
    v_and_b32 v240, 31, v197
    s_lshl_b32 s84, s45, 4
    v_xor_b32 v240, s84, v240
    v_lshl_add_u32 v191, v240, 2, s83
    v_lshrrev_b32 v240, 5, v197
    v_lshl_add_u32 v191, v240, 9, v191
    v_lshrrev_b32 v240, 2, v197
    v_mul_u32_u24 v240, 3584, v240
    v_and_b32 v241, 3, v197
    v_lshl_add_u32 v240, v241, 4, v240
    s_mul_i32 s83, s48, 896
    s_lshl_b32 s84, s50, 6
    s_add_u32 s83, s83, s84
    s_add_u32 s83, s83, 768
    s_mul_i32 s84, s44, 57344
    s_add_u32 s83, s83, s84
    v_add_u32 v190, s83, v240
    s_lshl_b32 s83, s50, 1
    s_add_u32 s83, s83, s46
    s_sub_u32 s97, 24, s83
    s_lshl_b32 s97, s97, 11
    s_mul_i32 s83, s44, 5632
    s_add_u32 s83, s83, 131584
    v_and_b32 v240, 31, v197
    v_lshrrev_b32 v241, 5, v197
    v_mul_u32_u24 v242, 72, v240
    v_lshl_add_u32 v242, v241, 3, v242
    v_add_u32 v152, s83, v242
    v_mul_u32_u24 v242, 104, v240
    v_lshl_add_u32 v242, v241, 3, v242
    s_add_u32 s84, s83, 2304
    v_add_u32 v154, s84, v242
    v_lshl_add_u32 v242, v241, 3, v154
    v_bfe_u32 v240, v197, 2, 2
    v_lshl_add_u32 v240, v241, 3, v240
    v_and_b32 v241, 3, v197
    v_mul_u32_u24 v242, 72, v240
    v_lshl_add_u32 v242, v241, 3, v242
    v_bfe_u32 v248, v197, 4, 1
    v_lshl_add_u32 v242, v248, 5, v242
    v_add_u32 v153, s83, v242
    v_mul_u32_u24 v242, 104, v240
    v_lshl_add_u32 v242, v241, 3, v242
    v_add_u32 v242, s84, v242
    v_lshl_add_u32 v155, v248, 6, v242
    v_add_u32 v248, 1, v248
    v_lshl_add_u32 v253, v248, 5, v242
    s_waitcnt vmcnt(17)
    s_barrier
    ds_read_b128 a[0:3], v174 offset:0
    ds_read_b128 a[4:7], v174 offset:4096
    ds_read_b64_tr_b16 v[128:129], v178 offset:0
    ds_read_b64_tr_b16 v[130:131], v178 offset:512
    ds_read_b64_tr_b16 v[132:133], v178 offset:8224
    ds_read_b64_tr_b16 v[134:135], v178 offset:8736
    s_waitcnt lgkmcnt(2)
    v_mfma_f32_32x32x16_bf16 v[0:15], v[128:131], a[0:3], 0
    ds_read_b64_tr_b16 v[136:137], v178 offset:2048
    ds_read_b64_tr_b16 v[138:139], v178 offset:2560
    ds_read_b128 a[8:11], v175 offset:0
    v_mfma_f32_32x32x16_bf16 v[16:31], v[128:131], a[4:7], 0
    ds_read_b128 a[12:15], v175 offset:4096
    ds_read_b64_tr_b16 v[140:141], v178 offset:10272
    ds_read_b64_tr_b16 v[142:143], v178 offset:10784
    s_waitcnt lgkmcnt(6)
    v_mfma_f32_32x32x16_bf16 v[32:47], v[132:135], a[0:3], 0
    s_add_u32 m0, s80, 32896
    ds_read_b128 a[16:19], v176 offset:0
    buffer_load_dwordx4 v182, s[4:7], s58 offen lds
    v_mfma_f32_32x32x16_bf16 v[48:63], v[132:135], a[4:7], 0
    ds_read_b128 a[20:23], v176 offset:4096
    buffer_load_dwordx4 v183, s[4:7], s58 offen offset:1024 lds
    v_mfma_f32_4x4x4_16b_bf16 v[68:71], a[0:1], a[0:1], 0
    v_mfma_f32_4x4x4_16b_bf16 v[72:75], a[4:5], a[4:5], 0
    v_mfma_f32_4x4x4_16b_bf16 v[88:91], a[2:3], a[2:3], 0
    v_mfma_f32_4x4x4_16b_bf16 v[92:95], a[6:7], a[6:7], 0
    v_mfma_f32_16x16x32_bf16 v[64:67], v[144:147], a[0:3], 0
    v_mfma_f32_16x16x32_bf16 v[64:67], v[148:151], a[4:7], v[64:67]
    v_mfma_f32_16x16x32_bf16 v[156:159], v[144:147], v[128:131], 0
    v_mfma_f32_16x16x32_bf16 v[156:159], v[148:151], v[132:135], v[156:159]
    s_waitcnt lgkmcnt(2)
    v_mfma_f32_32x32x16_bf16 v[0:15], v[136:139], a[8:11], v[0:15]
    ds_read_b64_tr_b16 v[128:129], v179 offset:0
    ds_read_b64_tr_b16 v[130:131], v179 offset:512
    v_mfma_f32_32x32x16_bf16 v[16:31], v[136:139], a[12:15], v[16:31]
    ds_read_b64_tr_b16 v[132:133], v179 offset:8224
    ds_read_b64_tr_b16 v[134:135], v179 offset:8736
    v_mfma_f32_32x32x16_bf16 v[32:47], v[140:143], a[8:11], v[32:47]
    ds_read_b128 a[24:27], v177 offset:0
    buffer_load_dwordx4 v184, s[4:7], s58 offen offset:2048 lds
    v_mfma_f32_32x32x16_bf16 v[48:63], v[140:143], a[12:15], v[48:63]
    ds_read_b128 a[28:31], v177 offset:4096
    buffer_load_dwordx4 v185, s[4:7], s58 offen offset:3072 lds
    v_mfma_f32_4x4x4_16b_bf16 v[68:71], a[8:9], a[8:9], v[68:71]
    v_mfma_f32_4x4x4_16b_bf16 v[72:75], a[12:13], a[12:13], v[72:75]
    v_mfma_f32_4x4x4_16b_bf16 v[88:91], a[10:11], a[10:11], v[88:91]
    v_mfma_f32_4x4x4_16b_bf16 v[92:95], a[14:15], a[14:15], v[92:95]
    v_mfma_f32_16x16x32_bf16 v[64:67], v[144:147], a[8:11], v[64:67]
    v_mfma_f32_16x16x32_bf16 v[64:67], v[148:151], a[12:15], v[64:67]
    v_mfma_f32_16x16x32_bf16 v[156:159], v[144:147], v[136:139], v[156:159]
    v_mfma_f32_16x16x32_bf16 v[156:159], v[148:151], v[140:143], v[156:159]
    s_waitcnt lgkmcnt(2)
    v_mfma_f32_32x32x16_bf16 v[0:15], v[128:131], a[16:19], v[0:15]
    ds_read_b64_tr_b16 v[136:137], v179 offset:2048
    ds_read_b64_tr_b16 v[138:139], v179 offset:2560
    v_mfma_f32_32x32x16_bf16 v[16:31], v[128:131], a[20:23], v[16:31]
    ds_read_b64_tr_b16 v[140:141], v179 offset:10272
    ds_read_b64_tr_b16 v[142:143], v179 offset:10784
    s_add_u32 m0, s81, 98688
    v_mfma_f32_32x32x16_bf16 v[32:47], v[132:135], a[16:19], v[32:47]
    buffer_load_dwordx4 v186, s[8:11], s66 offen lds
    buffer_load_dwordx4 v187, s[8:11], s66 offen offset:1024 lds
    v_mfma_f32_32x32x16_bf16 v[48:63], v[132:135], a[20:23], v[48:63]
    s_add_u32 m0, s81, 106912
    s_add_u32 s83, s66, 1024
    buffer_load_dwordx4 v186, s[8:11], s83 offen lds
    buffer_load_dwordx4 v187, s[8:11], s83 offen offset:1024 lds
    s_mov_b64 exec, 0
    s_cmp_eq_u32 s44, 0
    s_cbranch_scc1 L_padA1_0
    s_cmp_eq_u32 s44, 1
    s_cbranch_scc1 L_padA1_1
    s_cmp_eq_u32 s44, 2
    s_cbranch_scc1 L_padA1_2
    s_branch L_padA1_3
L_retA1:
    s_mov_b64 exec, -1
    s_waitcnt vmcnt(8) lgkmcnt(0)
    s_barrier
    v_mfma_f32_32x32x16_bf16 v[0:15], v[136:139], a[24:27], v[0:15]
    ds_read_b64_tr_b16 v[128:129], v178 offset:16448
    ds_read_b64_tr_b16 v[130:131], v178 offset:16960
    ds_read_b128 a[32:35], v174 offset:16448
    v_mfma_f32_32x32x16_bf16 v[16:31], v[136:139], a[28:31], v[16:31]
    ds_read_b128 a[36:39], v174 offset:20544
    ds_read_b64_tr_b16 v[132:133], v178 offset:24672
    ds_read_b64_tr_b16 v[134:135], v178 offset:25184
    s_add_u32 m0, s80, 49344
    v_mfma_f32_32x32x16_bf16 v[32:47], v[140:143], a[24:27], v[32:47]
    buffer_load_dwordx4 v182, s[4:7], s59 offen lds
    v_mfma_f32_32x32x16_bf16 v[48:63], v[140:143], a[28:31], v[48:63]
    buffer_load_dwordx4 v183, s[4:7], s59 offen offset:1024 lds
    buffer_load_dwordx4 v184, s[4:7], s59 offen offset:2048 lds
    s_waitcnt lgkmcnt(0)
    v_mfma_f32_32x32x16_bf16 v[0:15], v[128:131], a[32:35], v[0:15]
    ds_read_b64_tr_b16 v[136:137], v178 offset:18496
    ds_read_b64_tr_b16 v[138:139], v178 offset:19008
    ds_read_b128 a[40:43], v175 offset:16448
    v_mfma_f32_32x32x16_bf16 v[16:31], v[128:131], a[36:39], v[16:31]
    ds_read_b128 a[44:47], v175 offset:20544
    ds_read_b64_tr_b16 v[140:141], v178 offset:26720
    ds_read_b64_tr_b16 v[142:143], v178 offset:27232
    v_mfma_f32_32x32x16_bf16 v[32:47], v[132:135], a[32:35], v[32:47]
    ds_read_b128 a[48:51], v176 offset:16448
    buffer_load_dwordx4 v185, s[4:7], s59 offen offset:3072 lds
L_padA1_0:
    s_cbranch_execz L_padA1_4
    buffer_store_dword v96, v252, s[28:31], 0 offen sc1
    v_mfma_f32_32x32x16_bf16 v[48:63], v[132:135], a[36:39], v[48:63]
    s_add_u32 m0, s81, 115136
    ds_read_b128 a[52:55], v176 offset:20544
    buffer_load_dwordx4 v186, s[8:11], s67 offen lds
    buffer_load_dwordx4 v187, s[8:11], s67 offen offset:1024 lds
    v_mfma_f32_4x4x4_16b_bf16 v[68:71], a[32:33], a[32:33], v[68:71]
    v_mfma_f32_4x4x4_16b_bf16 v[72:75], a[36:37], a[36:37], v[72:75]
    v_mfma_f32_4x4x4_16b_bf16 v[88:91], a[34:35], a[34:35], v[88:91]
    v_mfma_f32_4x4x4_16b_bf16 v[92:95], a[38:39], a[38:39], v[92:95]
    v_mfma_f32_16x16x32_bf16 v[64:67], v[144:147], a[32:35], v[64:67]
    v_mfma_f32_16x16x32_bf16 v[64:67], v[148:151], a[36:39], v[64:67]
    v_mfma_f32_16x16x32_bf16 v[156:159], v[144:147], v[128:131], v[156:159]
    v_mfma_f32_16x16x32_bf16 v[156:159], v[148:151], v[132:135], v[156:159]
    s_waitcnt lgkmcnt(2)
    v_mfma_f32_32x32x16_bf16 v[0:15], v[136:139], a[40:43], v[0:15]
    ds_read_b64_tr_b16 v[128:129], v179 offset:16448
    ds_read_b64_tr_b16 v[130:131], v179 offset:16960
    v_mfma_f32_32x32x16_bf16 v[16:31], v[136:139], a[44:47], v[16:31]
    ds_read_b64_tr_b16 v[132:133], v179 offset:24672
    ds_read_b64_tr_b16 v[134:135], v179 offset:25184
    v_mfma_f32_32x32x16_bf16 v[32:47], v[140:143], a[40:43], v[32:47]
    ds_read_b128 a[56:59], v177 offset:16448
    buffer_store_dwordx4 v[98:101], v254, s[28:31], 0 offen offset:0 sc1
    buffer_store_dwordx4 v[98:101], v254, s[28:31], 0 offen offset:544 sc1
    v_mfma_f32_32x32x16_bf16 v[48:63], v[140:143], a[44:47], v[48:63]
    ds_read_b128 a[60:63], v177 offset:20544
    buffer_store_dwordx4 v[98:101], v254, s[28:31], 0 offen offset:1088 sc1
    v_mfma_f32_4x4x4_16b_bf16 v[68:71], a[40:41], a[40:41], v[68:71]
    v_mfma_f32_4x4x4_16b_bf16 v[72:75], a[44:45], a[44:45], v[72:75]
    v_mfma_f32_4x4x4_16b_bf16 v[88:91], a[42:43], a[42:43], v[88:91]
    v_mfma_f32_4x4x4_16b_bf16 v[92:95], a[46:47], a[46:47], v[92:95]
    v_mfma_f32_16x16x32_bf16 v[64:67], v[144:147], a[40:43], v[64:67]
    v_mfma_f32_16x16x32_bf16 v[64:67], v[148:151], a[44:47], v[64:67]
    v_mfma_f32_16x16x32_bf16 v[156:159], v[144:147], v[136:139], v[156:159]
    v_mfma_f32_16x16x32_bf16 v[156:159], v[148:151], v[140:143], v[156:159]
    s_waitcnt lgkmcnt(2)
    v_mfma_f32_32x32x16_bf16 v[0:15], v[128:131], a[48:51], v[0:15]
    ds_read_b64_tr_b16 v[136:137], v179 offset:18496
    ds_read_b64_tr_b16 v[138:139], v179 offset:19008
    v_mfma_f32_32x32x16_bf16 v[16:31], v[128:131], a[52:55], v[16:31]
    ds_read_b64_tr_b16 v[140:141], v179 offset:26720
    ds_read_b64_tr_b16 v[142:143], v179 offset:27232
    buffer_store_dwordx4 v[98:101], v254, s[28:31], 0 offen offset:1632 sc1
    v_mfma_f32_32x32x16_bf16 v[32:47], v[132:135], a[48:51], v[32:47]
    s_add_u32 m0, s81, 123360
    s_add_u32 s83, s67, 1024
    buffer_load_dwordx4 v186, s[8:11], s83 offen lds
    buffer_load_dwordx4 v187, s[8:11], s83 offen offset:1024 lds
    v_mfma_f32_32x32x16_bf16 v[48:63], v[132:135], a[52:55], v[48:63]
    s_waitcnt vmcnt(13) lgkmcnt(0)
    s_barrier
    v_mfma_f32_32x32x16_bf16 v[0:15], v[136:139], a[56:59], v[0:15]
    ds_read_b64_tr_b16 v[128:129], v178 offset:32896
    ds_read_b64_tr_b16 v[130:131], v178 offset:33408
    ds_read_b128 a[64:67], v174 offset:32896
    v_mfma_f32_32x32x16_bf16 v[16:31], v[136:139], a[60:63], v[16:31]
    ds_read_b128 a[68:71], v174 offset:36992
    ds_read_b64_tr_b16 v[132:133], v178 offset:41120
    ds_read_b64_tr_b16 v[134:135], v178 offset:41632
    s_add_u32 m0, s80, 0
    v_mfma_f32_32x32x16_bf16 v[32:47], v[140:143], a[56:59], v[32:47]
    buffer_load_dwordx4 v182, s[4:7], s60 offen lds
    v_mfma_f32_32x32x16_bf16 v[48:63], v[140:143], a[60:63], v[48:63]
    buffer_load_dwordx4 v183, s[4:7], s60 offen offset:1024 lds
    buffer_load_dwordx4 v184, s[4:7], s60 offen offset:2048 lds
    s_waitcnt lgkmcnt(0)
    v_mfma_f32_32x32x16_bf16 v[0:15], v[128:131], a[64:67], v[0:15]
    ds_read_b64_tr_b16 v[136:137], v178 offset:34944
    ds_read_b64_tr_b16 v[138:139], v178 offset:35456
    ds_read_b128 a[72:75], v175 offset:32896
    v_mfma_f32_32x32x16_bf16 v[16:31], v[128:131], a[68:71], v[16:31]
    ds_read_b128 a[76:79], v175 offset:36992
    ds_read_b64_tr_b16 v[140:141], v178 offset:43168
    ds_read_b64_tr_b16 v[142:143], v178 offset:43680
    v_mfma_f32_32x32x16_bf16 v[32:47], v[132:135], a[64:67], v[32:47]
    ds_read_b128 a[80:83], v176 offset:32896
    buffer_load_dwordx4 v185, s[4:7], s60 offen offset:3072 lds
    v_mfma_f32_32x32x16_bf16 v[48:63], v[132:135], a[68:71], v[48:63]
    s_add_u32 m0, s81, 65792
    ds_read_b128 a[84:87], v176 offset:36992
    buffer_load_dwordx4 v186, s[8:11], s68 offen lds
    buffer_load_dwordx4 v187, s[8:11], s68 offen offset:1024 lds
    v_mfma_f32_4x4x4_16b_bf16 v[68:71], a[64:65], a[64:65], v[68:71]
    v_mfma_f32_4x4x4_16b_bf16 v[72:75], a[68:69], a[68:69], v[72:75]
    v_mfma_f32_4x4x4_16b_bf16 v[88:91], a[66:67], a[66:67], v[88:91]
    v_mfma_f32_4x4x4_16b_bf16 v[92:95], a[70:71], a[70:71], v[92:95]
    v_mfma_f32_16x16x32_bf16 v[64:67], v[144:147], a[64:67], v[64:67]
    v_mfma_f32_16x16x32_bf16 v[64:67], v[148:151], a[68:71], v[64:67]
    v_mfma_f32_16x16x32_bf16 v[156:159], v[144:147], v[128:131], v[156:159]
    v_mfma_f32_16x16x32_bf16 v[156:159], v[148:151], v[132:135], v[156:159]
    s_waitcnt lgkmcnt(2)
    v_mfma_f32_32x32x16_bf16 v[0:15], v[136:139], a[72:75], v[0:15]
    ds_read_b64_tr_b16 v[128:129], v179 offset:32896
    ds_read_b64_tr_b16 v[130:131], v179 offset:33408
    s_lshl_b32 s83, s52, 2
    s_add_u32 s83, s83, s44
    s_lshl_b32 s83, s83, 14
    s_lshl_b32 s84, s53, 7
    s_add_u32 s83, s83, s84
    v_and_b32 v103, 3, v197
    v_lshlrev_b32 v103, 12, v103
    v_add_u32 v103, s83, v103
    buffer_store_dword v197, v103, s[32:35], 0 offen sc1
    v_mfma_f32_32x32x16_bf16 v[16:31], v[136:139], a[76:79], v[16:31]
    ds_read_b64_tr_b16 v[132:133], v179 offset:41120
    ds_read_b64_tr_b16 v[134:135], v179 offset:41632
    v_mfma_f32_32x32x16_bf16 v[32:47], v[140:143], a[72:75], v[32:47]
    ds_read_b128 a[88:91], v177 offset:32896
    v_mfma_f32_32x32x16_bf16 v[48:63], v[140:143], a[76:79], v[48:63]
    ds_read_b128 a[92:95], v177 offset:36992
    v_mfma_f32_4x4x4_16b_bf16 v[68:71], a[72:73], a[72:73], v[68:71]
    v_mfma_f32_4x4x4_16b_bf16 v[72:75], a[76:77], a[76:77], v[72:75]
    v_mfma_f32_4x4x4_16b_bf16 v[88:91], a[74:75], a[74:75], v[88:91]
    v_mfma_f32_4x4x4_16b_bf16 v[92:95], a[78:79], a[78:79], v[92:95]
    v_mfma_f32_16x16x32_bf16 v[64:67], v[144:147], a[72:75], v[64:67]
    v_mfma_f32_16x16x32_bf16 v[64:67], v[148:151], a[76:79], v[64:67]
    v_mfma_f32_16x16x32_bf16 v[156:159], v[144:147], v[136:139], v[156:159]
    v_mfma_f32_16x16x32_bf16 v[156:159], v[148:151], v[140:143], v[156:159]
    s_waitcnt lgkmcnt(2)
    v_mfma_f32_32x32x16_bf16 v[0:15], v[128:131], a[80:83], v[0:15]
    ds_read_b64_tr_b16 v[136:137], v179 offset:34944
    ds_read_b64_tr_b16 v[138:139], v179 offset:35456
    v_mfma_f32_32x32x16_bf16 v[16:31], v[128:131], a[84:87], v[16:31]
    ds_read_b64_tr_b16 v[140:141], v179 offset:43168
    ds_read_b64_tr_b16 v[142:143], v179 offset:43680
    v_mfma_f32_32x32x16_bf16 v[32:47], v[132:135], a[80:83], v[32:47]
    s_add_u32 m0, s81, 74016
    s_add_u32 s83, s68, 1024
    buffer_load_dwordx4 v186, s[8:11], s83 offen lds
    buffer_load_dwordx4 v187, s[8:11], s83 offen offset:1024 lds
    v_mfma_f32_32x32x16_bf16 v[48:63], v[132:135], a[84:87], v[48:63]
    s_waitcnt vmcnt(9) lgkmcnt(0)
    s_barrier
    v_mfma_f32_32x32x16_bf16 v[0:15], v[136:139], a[88:91], v[0:15]
    ds_read_b64_tr_b16 v[128:129], v178 offset:49344
    ds_read_b64_tr_b16 v[130:131], v178 offset:49856
L_padA1_1:
    s_cbranch_execz L_padA1_5
    ds_read_b128 a[96:99], v174 offset:49344
    s_lshl_b32 s83, s2, 2
    s_add_u32 s83, s83, s44
    s_mul_i32 s84, s83, 1792
    v_min_u32 v120, 13, v197
    v_lshl_add_u32 v120, v120, 7, s84
    buffer_load_dword v121, v120, s[20:23], 0 offen
    s_mul_i32 s84, s83, 512
    v_min_u32 v120, 3, v197
    v_lshl_add_u32 v120, v120, 7, s84
    buffer_load_dword v122, v120, s[24:27], 0 offen
    v_mfma_f32_32x32x16_bf16 v[16:31], v[136:139], a[92:95], v[16:31]
    ds_read_b128 a[100:103], v174 offset:53440
    ds_read_b64_tr_b16 v[132:133], v178 offset:57568
    ds_read_b64_tr_b16 v[134:135], v178 offset:58080
    s_add_u32 m0, s80, 16448
    v_mfma_f32_32x32x16_bf16 v[32:47], v[140:143], a[88:91], v[32:47]
    buffer_load_dwordx4 v182, s[4:7], s61 offen lds
    v_mfma_f32_32x32x16_bf16 v[48:63], v[140:143], a[92:95], v[48:63]
    buffer_load_dwordx4 v183, s[4:7], s61 offen offset:1024 lds
    buffer_load_dwordx4 v184, s[4:7], s61 offen offset:2048 lds
    s_waitcnt lgkmcnt(0)
    v_mfma_f32_32x32x16_bf16 v[0:15], v[128:131], a[96:99], v[0:15]
    ds_read_b64_tr_b16 v[136:137], v178 offset:51392
    ds_read_b64_tr_b16 v[138:139], v178 offset:51904
    ds_read_b128 a[104:107], v175 offset:49344
    v_mfma_f32_32x32x16_bf16 v[16:31], v[128:131], a[100:103], v[16:31]
    ds_read_b128 a[108:111], v175 offset:53440
    ds_read_b64_tr_b16 v[140:141], v178 offset:59616
    ds_read_b64_tr_b16 v[142:143], v178 offset:60128
    v_mfma_f32_32x32x16_bf16 v[32:47], v[132:135], a[96:99], v[32:47]
    ds_read_b128 a[112:115], v176 offset:49344
    buffer_load_dwordx4 v185, s[4:7], s61 offen offset:3072 lds
    v_mfma_f32_32x32x16_bf16 v[48:63], v[132:135], a[100:103], v[48:63]
    s_add_u32 m0, s81, 82240
    ds_read_b128 a[116:119], v176 offset:53440
    buffer_load_dwordx4 v186, s[8:11], s69 offen lds
    buffer_load_dwordx4 v187, s[8:11], s69 offen offset:1024 lds
    v_mfma_f32_4x4x4_16b_bf16 v[68:71], a[96:97], a[96:97], v[68:71]
    v_mfma_f32_4x4x4_16b_bf16 v[72:75], a[100:101], a[100:101], v[72:75]
    v_mfma_f32_4x4x4_16b_bf16 v[88:91], a[98:99], a[98:99], v[88:91]
    v_mfma_f32_4x4x4_16b_bf16 v[92:95], a[102:103], a[102:103], v[92:95]
    v_mfma_f32_16x16x32_bf16 v[64:67], v[144:147], a[96:99], v[64:67]
    v_mfma_f32_16x16x32_bf16 v[64:67], v[148:151], a[100:103], v[64:67]
    v_mfma_f32_16x16x32_bf16 v[156:159], v[144:147], v[128:131], v[156:159]
    v_mfma_f32_16x16x32_bf16 v[156:159], v[148:151], v[132:135], v[156:159]
    s_waitcnt lgkmcnt(2)
    v_mfma_f32_32x32x16_bf16 v[0:15], v[136:139], a[104:107], v[0:15]
    ds_read_b64_tr_b16 v[128:129], v179 offset:49344
    ds_read_b64_tr_b16 v[130:131], v179 offset:49856
    v_mfma_f32_32x32x16_bf16 v[16:31], v[136:139], a[108:111], v[16:31]
    ds_read_b64_tr_b16 v[132:133], v179 offset:57568
    ds_read_b64_tr_b16 v[134:135], v179 offset:58080
    v_mfma_f32_32x32x16_bf16 v[32:47], v[140:143], a[104:107], v[32:47]
    ds_read_b128 a[120:123], v177 offset:49344
    v_mfma_f32_32x32x16_bf16 v[48:63], v[140:143], a[108:111], v[48:63]
    ds_read_b128 a[124:127], v177 offset:53440
    v_mfma_f32_4x4x4_16b_bf16 v[68:71], a[104:105], a[104:105], v[68:71]
    v_mfma_f32_4x4x4_16b_bf16 v[72:75], a[108:109], a[108:109], v[72:75]
    v_mfma_f32_4x4x4_16b_bf16 v[88:91], a[106:107], a[106:107], v[88:91]
    v_mfma_f32_4x4x4_16b_bf16 v[92:95], a[110:111], a[110:111], v[92:95]
    v_mfma_f32_16x16x32_bf16 v[64:67], v[144:147], a[104:107], v[64:67]
    v_mfma_f32_16x16x32_bf16 v[64:67], v[148:151], a[108:111], v[64:67]
    v_mfma_f32_16x16x32_bf16 v[156:159], v[144:147], v[136:139], v[156:159]
    v_mfma_f32_16x16x32_bf16 v[156:159], v[148:151], v[140:143], v[156:159]
    s_waitcnt lgkmcnt(2)
    v_mfma_f32_32x32x16_bf16 v[0:15], v[128:131], a[112:115], v[0:15]
    ds_read_b64_tr_b16 v[136:137], v179 offset:51392
    ds_read_b64_tr_b16 v[138:139], v179 offset:51904
    v_mfma_f32_32x32x16_bf16 v[16:31], v[128:131], a[116:119], v[16:31]
    ds_read_b64_tr_b16 v[140:141], v179 offset:59616
    ds_read_b64_tr_b16 v[142:143], v179 offset:60128
    v_mfma_f32_32x32x16_bf16 v[32:47], v[132:135], a[112:115], v[32:47]
    s_add_u32 m0, s81, 90464
    s_add_u32 s83, s69, 1024
    buffer_load_dwordx4 v186, s[8:11], s83 offen lds
    buffer_load_dwordx4 v187, s[8:11], s83 offen offset:1024 lds
    v_mfma_f32_32x32x16_bf16 v[48:63], v[132:135], a[116:119], v[48:63]
    s_waitcnt vmcnt(10) lgkmcnt(0)
    s_barrier
    v_mfma_f32_32x32x16_bf16 v[0:15], v[136:139], a[120:123], v[0:15]
    ds_read_b64_tr_b16 v[128:129], v178 offset:0
    ds_read_b64_tr_b16 v[130:131], v178 offset:512
    ds_read_b128 a[128:131], v174 offset:0
    v_mfma_f32_32x32x16_bf16 v[16:31], v[136:139], a[124:127], v[16:31]
    ds_read_b128 a[132:135], v174 offset:4096
    ds_read_b64_tr_b16 v[132:133], v178 offset:8224
    ds_read_b64_tr_b16 v[134:135], v178 offset:8736
    s_add_u32 m0, s80, 32896
    v_mfma_f32_32x32x16_bf16 v[32:47], v[140:143], a[120:123], v[32:47]
    buffer_load_dwordx4 v182, s[4:7], s62 offen lds
    v_mfma_f32_32x32x16_bf16 v[48:63], v[140:143], a[124:127], v[48:63]
    buffer_load_dwordx4 v183, s[4:7], s62 offen offset:1024 lds
    buffer_load_dwordx4 v184, s[4:7], s62 offen offset:2048 lds
    s_waitcnt lgkmcnt(0)
    v_mfma_f32_32x32x16_bf16 v[0:15], v[128:131], a[128:131], v[0:15]
    ds_read_b64_tr_b16 v[136:137], v178 offset:2048
    ds_read_b64_tr_b16 v[138:139], v178 offset:2560
    ds_read_b128 a[136:139], v175 offset:0
    v_mfma_f32_32x32x16_bf16 v[16:31], v[128:131], a[132:135], v[16:31]
    ds_read_b128 a[140:143], v175 offset:4096
    ds_read_b64_tr_b16 v[140:141], v178 offset:10272
    ds_read_b64_tr_b16 v[142:143], v178 offset:10784
    v_mfma_f32_32x32x16_bf16 v[32:47], v[132:135], a[128:131], v[32:47]
    ds_read_b128 a[144:147], v176 offset:0
    buffer_load_dwordx4 v185, s[4:7], s62 offen offset:3072 lds
    v_mfma_f32_32x32x16_bf16 v[48:63], v[132:135], a[132:135], v[48:63]
    s_add_u32 m0, s81, 98688
    ds_read_b128 a[148:151], v176 offset:4096
    buffer_load_dwordx4 v186, s[8:11], s70 offen lds
    buffer_load_dwordx4 v187, s[8:11], s70 offen offset:1024 lds
    v_mfma_f32_4x4x4_16b_bf16 v[68:71], a[128:129], a[128:129], v[68:71]
    v_mfma_f32_4x4x4_16b_bf16 v[72:75], a[132:133], a[132:133], v[72:75]
    v_mfma_f32_4x4x4_16b_bf16 v[88:91], a[130:131], a[130:131], v[88:91]
    v_mfma_f32_4x4x4_16b_bf16 v[92:95], a[134:135], a[134:135], v[92:95]
    v_mfma_f32_16x16x32_bf16 v[64:67], v[144:147], a[128:131], v[64:67]
    v_mfma_f32_16x16x32_bf16 v[64:67], v[148:151], a[132:135], v[64:67]
    v_mfma_f32_16x16x32_bf16 v[156:159], v[144:147], v[128:131], v[156:159]
    v_mfma_f32_16x16x32_bf16 v[156:159], v[148:151], v[132:135], v[156:159]
    s_waitcnt lgkmcnt(2)
    v_mfma_f32_32x32x16_bf16 v[0:15], v[136:139], a[136:139], v[0:15]
    ds_read_b64_tr_b16 v[128:129], v179 offset:0
    ds_read_b64_tr_b16 v[130:131], v179 offset:512
    v_mfma_f32_32x32x16_bf16 v[16:31], v[136:139], a[140:143], v[16:31]
    ds_read_b64_tr_b16 v[132:133], v179 offset:8224
    ds_read_b64_tr_b16 v[134:135], v179 offset:8736
    v_mfma_f32_32x32x16_bf16 v[32:47], v[140:143], a[136:139], v[32:47]
    ds_read_b128 a[152:155], v177 offset:0
    v_mfma_f32_32x32x16_bf16 v[48:63], v[140:143], a[140:143], v[48:63]
    ds_read_b128 a[156:159], v177 offset:4096
    v_mfma_f32_4x4x4_16b_bf16 v[68:71], a[136:137], a[136:137], v[68:71]
    v_mfma_f32_4x4x4_16b_bf16 v[72:75], a[140:141], a[140:141], v[72:75]
    v_mfma_f32_4x4x4_16b_bf16 v[88:91], a[138:139], a[138:139], v[88:91]
L_padA0_0:
    s_cbranch_execz L_padA0_4
    v_mfma_f32_4x4x4_16b_bf16 v[92:95], a[142:143], a[142:143], v[92:95]
    v_mfma_f32_16x16x32_bf16 v[64:67], v[144:147], a[136:139], v[64:67]
    v_mfma_f32_16x16x32_bf16 v[64:67], v[148:151], a[140:143], v[64:67]
    v_mfma_f32_16x16x32_bf16 v[156:159], v[144:147], v[136:139], v[156:159]
    v_mfma_f32_16x16x32_bf16 v[156:159], v[148:151], v[140:143], v[156:159]
    s_waitcnt lgkmcnt(2)
    v_mfma_f32_32x32x16_bf16 v[0:15], v[128:131], a[144:147], v[0:15]
    ds_read_b64_tr_b16 v[136:137], v179 offset:2048
    ds_read_b64_tr_b16 v[138:139], v179 offset:2560
    v_mfma_f32_32x32x16_bf16 v[16:31], v[128:131], a[148:151], v[16:31]
    ds_read_b64_tr_b16 v[140:141], v179 offset:10272
    ds_read_b64_tr_b16 v[142:143], v179 offset:10784
    v_mfma_f32_32x32x16_bf16 v[32:47], v[132:135], a[144:147], v[32:47]
    s_add_u32 m0, s81, 106912
    s_add_u32 s83, s70, 1024
    buffer_load_dwordx4 v186, s[8:11], s83 offen lds
    buffer_load_dwordx4 v187, s[8:11], s83 offen offset:1024 lds
    v_mfma_f32_32x32x16_bf16 v[48:63], v[132:135], a[148:151], v[48:63]
    s_waitcnt vmcnt(8) lgkmcnt(0)
    s_barrier
    v_mfma_f32_32x32x16_bf16 v[0:15], v[136:139], a[152:155], v[0:15]
    ds_read_b64_tr_b16 v[128:129], v178 offset:16448
    ds_read_b64_tr_b16 v[130:131], v178 offset:16960
    ds_read_b128 a[160:163], v174 offset:16448
    v_mov_b32 v209, 1
    buffer_atomic_add v209, v208, s[36:39], 0 offen
    v_mfma_f32_32x32x16_bf16 v[16:31], v[136:139], a[156:159], v[16:31]
    ds_read_b128 a[164:167], v174 offset:20544
    ds_read_b64_tr_b16 v[132:133], v178 offset:24672
    ds_read_b64_tr_b16 v[134:135], v178 offset:25184
    s_add_u32 m0, s80, 49344
    v_mfma_f32_32x32x16_bf16 v[32:47], v[140:143], a[152:155], v[32:47]
    buffer_load_dwordx4 v182, s[4:7], s63 offen lds
    v_mfma_f32_32x32x16_bf16 v[48:63], v[140:143], a[156:159], v[48:63]
    buffer_load_dwordx4 v183, s[4:7], s63 offen offset:1024 lds
    buffer_load_dwordx4 v184, s[4:7], s63 offen offset:2048 lds
    s_waitcnt lgkmcnt(0)
    v_mfma_f32_32x32x16_bf16 v[0:15], v[128:131], a[160:163], v[0:15]
    ds_read_b64_tr_b16 v[136:137], v178 offset:18496
    ds_read_b64_tr_b16 v[138:139], v178 offset:19008
    ds_read_b128 a[168:171], v175 offset:16448
    v_mfma_f32_32x32x16_bf16 v[16:31], v[128:131], a[164:167], v[16:31]
    ds_read_b128 a[172:175], v175 offset:20544
    ds_read_b64_tr_b16 v[140:141], v178 offset:26720
    ds_read_b64_tr_b16 v[142:143], v178 offset:27232
    v_mfma_f32_32x32x16_bf16 v[32:47], v[132:135], a[160:163], v[32:47]
    ds_read_b128 a[176:179], v176 offset:16448
    buffer_load_dwordx4 v185, s[4:7], s63 offen offset:3072 lds
    v_mfma_f32_32x32x16_bf16 v[48:63], v[132:135], a[164:167], v[48:63]
    s_add_u32 m0, s81, 115136
    ds_read_b128 a[180:183], v176 offset:20544
    buffer_load_dwordx4 v186, s[8:11], s71 offen lds
    buffer_load_dwordx4 v187, s[8:11], s71 offen offset:1024 lds
    v_mfma_f32_4x4x4_16b_bf16 v[68:71], a[160:161], a[160:161], v[68:71]
    v_mfma_f32_4x4x4_16b_bf16 v[72:75], a[164:165], a[164:165], v[72:75]
    v_mfma_f32_4x4x4_16b_bf16 v[88:91], a[162:163], a[162:163], v[88:91]
    v_mfma_f32_4x4x4_16b_bf16 v[92:95], a[166:167], a[166:167], v[92:95]
    v_mfma_f32_16x16x32_bf16 v[64:67], v[144:147], a[160:163], v[64:67]
    v_mfma_f32_16x16x32_bf16 v[64:67], v[148:151], a[164:167], v[64:67]
    v_mfma_f32_16x16x32_bf16 v[156:159], v[144:147], v[128:131], v[156:159]
    v_mfma_f32_16x16x32_bf16 v[156:159], v[148:151], v[132:135], v[156:159]
    s_waitcnt lgkmcnt(2)
    v_mfma_f32_32x32x16_bf16 v[0:15], v[136:139], a[168:171], v[0:15]
    ds_read_b64_tr_b16 v[128:129], v179 offset:16448
    ds_read_b64_tr_b16 v[130:131], v179 offset:16960
    v_and_b32 v248, 16, v197
    v_cmp_eq_u32 vcc, 0, v248
    v_lshl_or_b32 v80, v81, 16, v80
    s_nop 0
    v_cndmask_b32 v200, 0, v80, vcc
    v_cndmask_b32 v204, v80, 0, vcc
    v_lshl_or_b32 v82, v83, 16, v82
    v_cndmask_b32 v201, 0, v82, vcc
    v_cndmask_b32 v205, v82, 0, vcc
    v_lshl_or_b32 v84, v85, 16, v84
    v_cndmask_b32 v202, 0, v84, vcc
    v_cndmask_b32 v206, v84, 0, vcc
    v_lshl_or_b32 v86, v87, 16, v86
    v_cndmask_b32 v203, 0, v86, vcc
    v_cndmask_b32 v207, v86, 0, vcc
    v_mfma_f32_32x32x16_bf16 v[16:31], v[136:139], a[172:175], v[16:31]
    ds_read_b64_tr_b16 v[132:133], v179 offset:24672
    ds_read_b64_tr_b16 v[134:135], v179 offset:25184
    v_mfma_f32_32x32x16_bf16 v[32:47], v[140:143], a[168:171], v[32:47]
    ds_read_b128 a[184:187], v177 offset:16448
    v_mfma_f32_32x32x16_bf16 v[48:63], v[140:143], a[172:175], v[48:63]
    ds_read_b128 a[188:191], v177 offset:20544
    v_mfma_f32_4x4x4_16b_bf16 v[68:71], a[168:169], a[168:169], v[68:71]
    v_mfma_f32_4x4x4_16b_bf16 v[72:75], a[172:173], a[172:173], v[72:75]
    v_mfma_f32_4x4x4_16b_bf16 v[88:91], a[170:171], a[170:171], v[88:91]
    v_mfma_f32_4x4x4_16b_bf16 v[92:95], a[174:175], a[174:175], v[92:95]
    v_mfma_f32_16x16x32_bf16 v[64:67], v[144:147], a[168:171], v[64:67]
    v_mfma_f32_16x16x32_bf16 v[64:67], v[148:151], a[172:175], v[64:67]
    v_mfma_f32_16x16x32_bf16 v[156:159], v[144:147], v[136:139], v[156:159]
    v_mfma_f32_16x16x32_bf16 v[156:159], v[148:151], v[140:143], v[156:159]
    s_waitcnt lgkmcnt(2)
    v_mfma_f32_32x32x16_bf16 v[0:15], v[128:131], a[176:179], v[0:15]
    ds_read_b64_tr_b16 v[136:137], v179 offset:18496
    ds_read_b64_tr_b16 v[138:139], v179 offset:19008
    v_mfma_f32_32x32x16_bf16 v[16:31], v[128:131], a[180:183], v[16:31]
    ds_read_b64_tr_b16 v[140:141], v179 offset:26720
    ds_read_b64_tr_b16 v[142:143], v179 offset:27232
    v_mfma_f32_32x32x16_bf16 v[32:47], v[132:135], a[176:179], v[32:47]
    s_add_u32 m0, s81, 123360
    s_add_u32 s83, s71, 1024
    buffer_load_dwordx4 v186, s[8:11], s83 offen lds
    buffer_load_dwordx4 v187, s[8:11], s83 offen offset:1024 lds
    v_mfma_f32_32x32x16_bf16 v[48:63], v[132:135], a[180:183], v[48:63]
    s_waitcnt vmcnt(9) lgkmcnt(0)
    s_barrier
    v_mfma_f32_32x32x16_bf16 v[0:15], v[136:139], a[184:187], v[0:15]
    ds_read_b64_tr_b16 v[128:129], v178 offset:32896
    ds_read_b64_tr_b16 v[130:131], v178 offset:33408
    ds_read_b128 a[192:195], v174 offset:32896
    v_mfma_f32_32x32x16_bf16 v[16:31], v[136:139], a[188:191], v[16:31]
    ds_read_b128 a[196:199], v174 offset:36992
    ds_read_b64_tr_b16 v[132:133], v178 offset:41120
    ds_read_b64_tr_b16 v[134:135], v178 offset:41632
    s_and_b32 s56, s53, 3
    s_lshl_b32 s56, s56, 1
    s_add_u32 s56, s56, s52
    s_and_b32 s56, s56, 7
    s_lshl_b32 s56, s56, 11
    s_add_u32 m0, s81, 0
    v_mfma_f32_32x32x16_bf16 v[32:47], v[140:143], a[184:187], v[32:47]
    buffer_load_dwordx4 v188, s[12:15], s72 offen lds
    buffer_load_dwordx4 v189, s[12:15], s72 offen offset:1024 lds
    s_add_u32 m0, s81, 8224
    v_mfma_f32_32x32x16_bf16 v[48:63], v[140:143], a[188:191], v[48:63]
    buffer_load_dwordx4 v188, s[16:19], s72 offen lds
    buffer_load_dwordx4 v189, s[16:19], s72 offen offset:1024 lds
    s_waitcnt lgkmcnt(0)
    v_mfma_f32_32x32x16_bf16 v[0:15], v[128:131], a[192:195], v[0:15]
    ds_read_b64_tr_b16 v[136:137], v178 offset:34944
    ds_read_b64_tr_b16 v[138:139], v178 offset:35456
    ds_read_b128 a[200:203], v175 offset:32896
    v_mfma_f32_32x32x16_bf16 v[16:31], v[128:131], a[196:199], v[16:31]
    ds_read_b128 a[204:207], v175 offset:36992
    ds_read_b64_tr_b16 v[140:141], v178 offset:43168
L_padA1_2:
    s_cbranch_execz L_padA1_6
    ds_read_b64_tr_b16 v[142:143], v178 offset:43680
    v_mfma_f32_32x32x16_bf16 v[32:47], v[132:135], a[192:195], v[32:47]
    ds_read_b128 a[208:211], v176 offset:32896
    v_lshrrev_b32 v248, 5, v197
    v_lshlrev_b32 v248, 10, v248
    v_mfma_f32_32x32x16_bf16 v[48:63], v[132:135], a[196:199], v[48:63]
    ds_read_b128 a[212:215], v176 offset:36992
    v_bfe_u32 v249, v197, 2, 2
    s_add_u32 s57, s56, 2048
    s_and_b32 s57, s57, 0x3800
    v_mfma_f32_4x4x4_16b_bf16 v[68:71], a[192:193], a[192:193], v[68:71]
    v_mfma_f32_4x4x4_16b_bf16 v[72:75], a[196:197], a[196:197], v[72:75]
    v_mfma_f32_4x4x4_16b_bf16 v[88:91], a[194:195], a[194:195], v[88:91]
    v_mfma_f32_4x4x4_16b_bf16 v[92:95], a[198:199], a[198:199], v[92:95]
    v_mfma_f32_16x16x32_bf16 v[64:67], v[144:147], a[192:195], v[64:67]
    v_mfma_f32_16x16x32_bf16 v[64:67], v[148:151], a[196:199], v[64:67]
    v_mfma_f32_16x16x32_bf16 v[156:159], v[144:147], v[128:131], v[156:159]
    v_mfma_f32_16x16x32_bf16 v[156:159], v[148:151], v[132:135], v[156:159]
    s_waitcnt lgkmcnt(2)
    v_mfma_f32_32x32x16_bf16 v[0:15], v[136:139], a[200:203], v[0:15]
    ds_read_b64_tr_b16 v[128:129], v179 offset:32896
    ds_read_b64_tr_b16 v[130:131], v179 offset:33408
    s_add_u32 s58, s57, 2048
    s_and_b32 s58, s58, 0x3800
    v_mfma_f32_32x32x16_bf16 v[16:31], v[136:139], a[204:207], v[16:31]
    ds_read_b64_tr_b16 v[132:133], v179 offset:41120
    ds_read_b64_tr_b16 v[134:135], v179 offset:41632
    v_lshl_add_u32 v248, v249, 7, v248
    v_mfma_f32_32x32x16_bf16 v[32:47], v[140:143], a[200:203], v[32:47]
    s_add_u32 m0, s81, 16448
    ds_read_b128 a[216:219], v177 offset:32896
    buffer_load_dwordx4 v188, s[12:15], s73 offen lds
    buffer_load_dwordx4 v189, s[12:15], s73 offen offset:1024 lds
    v_mfma_f32_32x32x16_bf16 v[48:63], v[140:143], a[204:207], v[48:63]
    ds_read_b128 a[220:223], v177 offset:36992
    v_and_b32 v249, 3, v197
    s_add_u32 s59, s58, 2048
    s_and_b32 s59, s59, 0x3800
    v_mfma_f32_4x4x4_16b_bf16 v[68:71], a[200:201], a[200:201], v[68:71]
    v_mfma_f32_4x4x4_16b_bf16 v[72:75], a[204:205], a[204:205], v[72:75]
    v_mfma_f32_4x4x4_16b_bf16 v[88:91], a[202:203], a[202:203], v[88:91]
    v_mfma_f32_4x4x4_16b_bf16 v[92:95], a[206:207], a[206:207], v[92:95]
    v_mfma_f32_16x16x32_bf16 v[64:67], v[144:147], a[200:203], v[64:67]
    v_mfma_f32_16x16x32_bf16 v[64:67], v[148:151], a[204:207], v[64:67]
    v_mfma_f32_16x16x32_bf16 v[156:159], v[144:147], v[136:139], v[156:159]
    v_mfma_f32_16x16x32_bf16 v[156:159], v[148:151], v[140:143], v[156:159]
    s_waitcnt lgkmcnt(2)
    v_mfma_f32_32x32x16_bf16 v[0:15], v[128:131], a[208:211], v[0:15]
    ds_read_b64_tr_b16 v[136:137], v179 offset:34944
    ds_read_b64_tr_b16 v[138:139], v179 offset:35456
    s_add_u32 s60, s59, 2048
    s_and_b32 s60, s60, 0x3800
    v_mfma_f32_32x32x16_bf16 v[16:31], v[128:131], a[212:215], v[16:31]
    ds_read_b64_tr_b16 v[140:141], v179 offset:43168
    ds_read_b64_tr_b16 v[142:143], v179 offset:43680
    v_lshl_add_u32 v248, v249, 3, v248
    s_lshl_b32 s83, s45, 10
    s_add_u32 s83, s83, 154112
    v_and_b32 v241, 31, v197
    v_lshl_add_u32 v241, v241, 4, s83
    s_lshl_b32 s84, s46, 3
    s_add_u32 s83, s83, s84
    v_lshl_add_u32 v240, v197, 4, s83
    s_add_u32 m0, s81, 24672
    v_mfma_f32_32x32x16_bf16 v[32:47], v[132:135], a[208:211], v[32:47]
    buffer_load_dwordx4 v188, s[16:19], s73 offen lds
    buffer_load_dwordx4 v189, s[16:19], s73 offen offset:1024 lds
    s_add_u32 s61, s60, 2048
    s_and_b32 s61, s61, 0x3800
    v_mfma_f32_32x32x16_bf16 v[48:63], v[132:135], a[212:215], v[48:63]
    v_bfe_u32 v249, v197, 3, 1
    v_xor_b32 v249, s46, v249
    s_add_u32 s62, s61, 2048
    s_and_b32 s62, s62, 0x3800
    s_waitcnt vmcnt(8) lgkmcnt(0)
    s_barrier
    v_mfma_f32_32x32x16_bf16 v[0:15], v[136:139], a[216:219], v[0:15]
    ds_read_b64_tr_b16 v[128:129], v178 offset:49344
    ds_read_b64_tr_b16 v[130:131], v178 offset:49856
    ds_read_b128 a[224:227], v174 offset:49344
    v_mfma_f32_32x32x16_bf16 v[16:31], v[136:139], a[220:223], v[16:31]
    ds_read_b128 a[228:231], v174 offset:53440
    ds_read_b64_tr_b16 v[132:133], v178 offset:57568
    ds_read_b64_tr_b16 v[134:135], v178 offset:58080
    s_add_u32 m0, s81, 32896
    v_mfma_f32_32x32x16_bf16 v[32:47], v[140:143], a[216:219], v[32:47]
    buffer_load_dwordx4 v188, s[12:15], s74 offen lds
    buffer_load_dwordx4 v189, s[12:15], s74 offen offset:1024 lds
    s_add_u32 s63, s62, 2048
    s_and_b32 s63, s63, 0x3800
    s_add_u32 m0, s81, 41120
    v_mfma_f32_32x32x16_bf16 v[48:63], v[140:143], a[220:223], v[48:63]
    buffer_load_dwordx4 v188, s[16:19], s74 offen lds
    buffer_load_dwordx4 v189, s[16:19], s74 offen offset:1024 lds
    s_waitcnt lgkmcnt(0)
    v_mfma_f32_32x32x16_bf16 v[0:15], v[128:131], a[224:227], v[0:15]
    ds_read_b64_tr_b16 v[136:137], v178 offset:51392
    ds_read_b64_tr_b16 v[138:139], v178 offset:51904
    ds_read_b128 a[232:235], v175 offset:49344
    v_mfma_f32_32x32x16_bf16 v[16:31], v[128:131], a[228:231], v[16:31]
    ds_read_b128 a[236:239], v175 offset:53440
    ds_read_b64_tr_b16 v[140:141], v178 offset:59616
    ds_read_b64_tr_b16 v[142:143], v178 offset:60128
    v_mfma_f32_32x32x16_bf16 v[32:47], v[132:135], a[224:227], v[32:47]
    ds_read_b128 a[240:243], v176 offset:49344
    v_lshl_add_u32 v248, v249, 6, v248
    v_bfe_u32 v249, v197, 4, 1
    v_mfma_f32_32x32x16_bf16 v[48:63], v[132:135], a[228:231], v[48:63]
    ds_read_b128 a[244:247], v176 offset:53440
    v_mul_u32_u24 v249, 8224, v249
    v_mfma_f32_4x4x4_16b_bf16 v[68:71], a[224:225], a[224:225], v[68:71]
    v_mfma_f32_4x4x4_16b_bf16 v[72:75], a[228:229], a[228:229], v[72:75]
    v_mfma_f32_4x4x4_16b_bf16 v[88:91], a[226:227], a[226:227], v[88:91]
    v_mfma_f32_4x4x4_16b_bf16 v[92:95], a[230:231], a[230:231], v[92:95]
    v_mfma_f32_16x16x32_bf16 v[64:67], v[144:147], a[224:227], v[64:67]
    v_mfma_f32_16x16x32_bf16 v[64:67], v[148:151], a[228:231], v[64:67]
    s_waitcnt lgkmcnt(5)
    v_mfma_f32_4x4x4_16b_bf16 v[68:71], a[232:233], a[232:233], v[68:71]
    s_waitcnt lgkmcnt(4)
    v_mfma_f32_4x4x4_16b_bf16 v[72:75], a[236:237], a[236:237], v[72:75]
    v_mfma_f32_4x4x4_16b_bf16 v[88:91], a[234:235], a[234:235], v[88:91]
    v_mfma_f32_4x4x4_16b_bf16 v[92:95], a[238:239], a[238:239], v[92:95]
    v_mfma_f32_16x16x32_bf16 v[64:67], v[144:147], a[232:235], v[64:67]
    v_mfma_f32_16x16x32_bf16 v[64:67], v[148:151], a[236:239], v[64:67]
    v_mfma_f32_16x16x32_bf16 v[156:159], v[144:147], v[128:131], v[156:159]
    v_mfma_f32_16x16x32_bf16 v[156:159], v[148:151], v[132:135], v[156:159]
    s_waitcnt lgkmcnt(2)
    v_mfma_f32_16x16x32_bf16 v[156:159], v[144:147], v[136:139], v[156:159]
    ds_read_b64_tr_b16 v[128:129], v179 offset:49344
    ds_read_b64_tr_b16 v[130:131], v179 offset:49856
    v_mfma_f32_16x16x32_bf16 v[156:159], v[148:151], v[140:143], v[156:159]
    ds_read_b64_tr_b16 v[132:133], v179 offset:57568
    ds_read_b64_tr_b16 v[134:135], v179 offset:58080
    v_mfma_f32_32x32x16_bf16 v[0:15], v[136:139], a[232:235], v[0:15]
    s_add_u32 m0, s81, 65792
L_padA1_3:
    s_cbranch_execz L_padA1_7
    ds_read_b128 a[248:251], v177 offset:49344
    buffer_load_dwordx4 v188, s[12:15], s75 offen lds
    buffer_load_dwordx4 v189, s[12:15], s75 offen offset:1024 lds
    v_add_f32 v68, v68, v88
    v_add_f32 v69, v69, v89
    v_add_f32 v70, v70, v90
    v_mfma_f32_32x32x16_bf16 v[16:31], v[136:139], a[236:239], v[16:31]
    ds_read_b128 a[252:255], v177 offset:53440
    v_add_u32 v248, v248, v249
    v_add_f32 v71, v71, v91
    v_add_f32 v72, v72, v92
    v_add_f32 v73, v73, v93
    v_add_f32 v74, v74, v94
    v_add_f32 v75, v75, v95
    s_add_u32 m0, s81, 74016
    v_mfma_f32_32x32x16_bf16 v[32:47], v[140:143], a[232:235], v[32:47]
    buffer_load_dwordx4 v188, s[16:19], s75 offen lds
    buffer_load_dwordx4 v189, s[16:19], s75 offen offset:1024 lds
    v_cndmask_b32 v68, v68, v69, s[86:87]
    v_cndmask_b32 v72, v72, v73, s[86:87]
    v_cndmask_b32 v68, v68, v70, s[88:89]
    v_cndmask_b32 v72, v72, v74, s[88:89]
    v_mfma_f32_32x32x16_bf16 v[48:63], v[140:143], a[236:239], v[48:63]
    s_lshl_b32 s83, s3, 12
    s_xor_b32 s84, s83, 4096
    v_add_u32 v182, s83, v248
    v_add_u32 v183, s84, v248
    v_add_u32 v184, 65792, v182
    v_add_u32 v185, 65792, v183
    v_cndmask_b32 v68, v68, v71, s[90:91]
    s_waitcnt lgkmcnt(2)
    v_mfma_f32_32x32x16_bf16 v[0:15], v[128:131], a[240:243], v[0:15]
    ds_read_b64_tr_b16 v[136:137], v179 offset:51392
    ds_read_b64_tr_b16 v[138:139], v179 offset:51904
    v_cndmask_b32 v72, v72, v75, s[90:91]
    s_nop 1
    v_permlane32_swap_b32 v68, v72
    v_add_f32 v65, v68, v72
    ds_write_b64 v240, v[64:65]
    ds_write_b32 v191, v156 offset:0
    v_mfma_f32_32x32x16_bf16 v[16:31], v[128:131], a[244:247], v[16:31]
    ds_read_b64_tr_b16 v[140:141], v179 offset:59616
    ds_read_b64_tr_b16 v[142:143], v179 offset:60128
    v_mfma_f32_32x32x16_bf16 v[32:47], v[132:135], a[240:243], v[32:47]
    v_mfma_f32_32x32x16_bf16 v[48:63], v[132:135], a[244:247], v[48:63]
    s_waitcnt vmcnt(12) lgkmcnt(0)
    s_barrier
    v_mfma_f32_32x32x16_bf16 v[0:15], v[136:139], a[248:251], v[0:15]
    ds_read_b64_tr_b16 v[128:129], v182 offset:0
    ds_read_b64_tr_b16 v[130:131], v182 offset:512
    v_xor_b32 v242, 0x80, v191
    ds_read_b32 v242, v242 offset:0
    ds_read_b128 v[244:247], v241
    ds_read_b128 v[248:251], v241 offset:512
    v_mfma_f32_32x32x16_bf16 v[16:31], v[136:139], a[252:255], v[16:31]
    ds_read_b64_tr_b16 v[132:133], v182 offset:32
    ds_read_b64_tr_b16 v[134:135], v182 offset:544
    s_add_u32 m0, s81, 49344
    v_mfma_f32_32x32x16_bf16 v[32:47], v[140:143], a[248:251], v[32:47]
    buffer_load_dwordx4 v188, s[12:15], s76 offen lds
    buffer_load_dwordx4 v189, s[12:15], s76 offen offset:1024 lds
    s_waitcnt lgkmcnt(4)
    v_add_f32 v242, v242, v156
    s_waitcnt lgkmcnt(3)
    v_add_f32 v244, v244, v246
    v_mul_f32 v244, 0xbb000000, v244
    v_cvt_pk_bf16_f32 v161, v244, 0
    v_lshlrev_b32 v246, 16, v161
    v_sub_f32 v246, v244, v246
    v_cvt_pk_bf16_f32 v160, v244, v246
    v_cndmask_b32 v162, 0, v160, s[54:55]
    v_cndmask_b32 v163, 0, v161, s[54:55]
    v_cndmask_b32 v160, v160, 0, s[54:55]
    v_cndmask_b32 v161, v161, 0, s[54:55]
    v_mfma_f32_32x32x16_bf16 v[48:63], v[140:143], a[252:255], v[48:63]
    v_cvt_pk_bf16_f32 v168, v242, v242
    v_lshlrev_b32 v169, 16, v168
    v_sub_f32 v242, v242, v169
    v_cvt_pk_bf16_f32 v169, v242, 0
    s_waitcnt lgkmcnt(2)
    v_add_f32 v248, v248, v250
    v_mul_f32 v248, 0xbb000000, v248
    v_cvt_pk_bf16_f32 v165, v248, 0
    v_lshlrev_b32 v250, 16, v165
    v_sub_f32 v250, v248, v250
    v_cvt_pk_bf16_f32 v164, v248, v250
    v_cndmask_b32 v166, 0, v164, s[54:55]
    v_cndmask_b32 v167, 0, v165, s[54:55]
    v_cndmask_b32 v164, v164, 0, s[54:55]
    v_cndmask_b32 v165, v165, 0, s[54:55]
    s_waitcnt lgkmcnt(0)
    v_mfma_f32_32x32x16_bf16 v[64:79], v[128:131], a[0:3], 0
    ds_read_b64_tr_b16 v[136:137], v182 offset:2048
    ds_read_b64_tr_b16 v[138:139], v182 offset:2560
    v_mfma_f32_32x32x16_bf16 v[0:15], v[168:171], v[160:163], v[0:15]
    v_mfma_f32_32x32x16_bf16 v[80:95], v[128:131], a[4:7], 0
    ds_read_b64_tr_b16 v[140:141], v182 offset:2080
    ds_read_b64_tr_b16 v[142:143], v182 offset:2592
    v_mfma_f32_32x32x16_bf16 v[16:31], v[168:171], v[164:167], v[16:31]
    s_add_u32 m0, s81, 57568
    v_mfma_f32_32x32x16_bf16 v[96:111], v[132:135], a[0:3], 0
    buffer_load_dwordx4 v188, s[16:19], s76 offen lds
    buffer_load_dwordx4 v189, s[16:19], s76 offen offset:1024 lds
    v_mfma_f32_32x32x16_bf16 v[32:47], v[168:171], v[162:165], v[32:47]
    v_mfma_f32_32x32x16_bf16 v[112:127], v[132:135], a[4:7], 0
    v_mfma_f32_32x32x16_bf16 v[48:63], v[168:171], v[166:169], v[48:63]
    v_add_f32 v245, v245, v247
    v_mfma_f32_16x16x32_bf16 v[156:159], v[144:147], v[128:131], 0
    v_mul_f32 v246, v244, v244
    v_fma_f32 v245, v245, s96, -v246
    v_max_f32 v245, 0, v245
    v_add_f32 v245, 0x3727c5ac, v245
    v_mfma_f32_16x16x32_bf16 v[156:159], v[148:151], v[132:135], v[156:159]
    v_rsq_f32 v192, v245
    v_rcp_f32 v194, v245
    s_waitcnt lgkmcnt(0)
    v_mfma_f32_32x32x16_bf16 v[64:79], v[136:139], a[8:11], v[64:79]
    ds_read_b64_tr_b16 v[128:129], v183 offset:0
    ds_read_b64_tr_b16 v[130:131], v183 offset:512
    v_mul_f32 v172, 0x3fb8aa3b, v192
    v_add_f32 v249, v249, v251
    v_mul_f32 v250, v248, v248
    v_fma_f32 v249, v249, s96, -v250
    v_max_f32 v249, 0, v249
    v_mfma_f32_32x32x16_bf16 v[80:95], v[136:139], a[12:15], v[80:95]
    ds_read_b64_tr_b16 v[132:133], v183 offset:32
    ds_read_b64_tr_b16 v[134:135], v183 offset:544
    v_add_f32 v249, 0x3727c5ac, v249
    v_rsq_f32 v193, v249
    v_rcp_f32 v195, v249
    v_mul_f32 v173, 0x3fb8aa3b, v193
    v_mfma_f32_32x32x16_bf16 v[96:111], v[140:143], a[8:11], v[96:111]
    v_cvt_pk_bf16_f32 v240, v0, v1
    v_cvt_pk_bf16_f32 v241, v2, v3
    v_cvt_pk_bf16_f32 v242, v4, v5
    v_cvt_pk_bf16_f32 v243, v6, v7
    v_cvt_pk_bf16_f32 v244, v8, v9
    v_cvt_pk_bf16_f32 v245, v10, v11
    v_cvt_pk_bf16_f32 v246, v12, v13
    v_cvt_pk_bf16_f32 v247, v14, v15
    s_add_u32 m0, s81, 82240
    v_mfma_f32_32x32x16_bf16 v[112:127], v[140:143], a[12:15], v[112:127]
    buffer_load_dwordx4 v188, s[12:15], s77 offen lds
    buffer_load_dwordx4 v189, s[12:15], s77 offen offset:1024 lds
    v_mfma_f32_32x32x16_bf16 v[0:15], v[200:203], v[240:243], 0
    v_mfma_f32_16x16x32_bf16 v[156:159], v[144:147], v[136:139], v[156:159]
    v_mfma_f32_32x32x16_bf16 v[0:15], v[204:207], v[244:247], v[0:15]
    v_mfma_f32_16x16x32_bf16 v[156:159], v[148:151], v[140:143], v[156:159]
    v_rcp_f32 v248, v192
L_padA1_4:
    s_cbranch_execz L_padA1_8
    s_waitcnt lgkmcnt(0)
    v_mfma_f32_32x32x16_bf16 v[64:79], v[128:131], a[16:19], v[64:79]
    ds_read_b64_tr_b16 v[136:137], v183 offset:2048
    ds_read_b64_tr_b16 v[138:139], v183 offset:2560
    v_cvt_pk_bf16_f32 v248, v248, v248
    ds_write_b32 v154, v248 offset:64
    v_cvt_pk_bf16_f32 v32, v32, v33
    v_cvt_pk_bf16_f32 v33, v34, v35
    ds_write_b64 v154, v[32:33] offset:0
    v_mfma_f32_32x32x16_bf16 v[80:95], v[128:131], a[20:23], v[80:95]
    ds_read_b64_tr_b16 v[140:141], v183 offset:2080
    ds_read_b64_tr_b16 v[142:143], v183 offset:2592
    v_cvt_pk_bf16_f32 v34, v36, v37
    v_cvt_pk_bf16_f32 v35, v38, v39
    ds_write_b64 v154, v[34:35] offset:16
    v_cvt_pk_bf16_f32 v36, v40, v41
    v_cvt_pk_bf16_f32 v37, v42, v43
    ds_write_b64 v154, v[36:37] offset:32
    v_mfma_f32_32x32x16_bf16 v[96:111], v[132:135], a[16:19], v[96:111]
    v_cvt_pk_bf16_f32 v38, v44, v45
    v_cvt_pk_bf16_f32 v39, v46, v47
    ds_write_b64 v154, v[38:39] offset:48
    v_max3_f32 v248, v0, v1, v2
    v_min3_f32 v249, v0, v1, v2
    v_max3_f32 v248, v248, v3, v4
    v_min3_f32 v249, v249, v3, v4
    v_max3_f32 v248, v248, v5, v6
    s_add_u32 m0, s81, 90464
    v_mfma_f32_32x32x16_bf16 v[112:127], v[132:135], a[20:23], v[112:127]
    buffer_load_dwordx4 v188, s[16:19], s77 offen lds
    buffer_load_dwordx4 v189, s[16:19], s77 offen offset:1024 lds
    v_min3_f32 v249, v249, v5, v6
    v_max_f32 v248, v248, v7
    v_max_f32_e64 v249, -v249, -v7
    s_nop 1
    v_permlane32_swap_b32 v248, v249
    v_max_f32 v248, v248, v249
    s_waitcnt vmcnt(16) lgkmcnt(3)
    s_barrier
    v_mfma_f32_32x32x16_bf16 v[64:79], v[136:139], a[24:27], v[64:79]
    ds_read_b64_tr_b16 v[128:129], v182 offset:16448
    ds_read_b64_tr_b16 v[130:131], v182 offset:16960
    v_mul_f32_e64 v248, -v248, v172
    v_mov_b32 v249, v248
    s_nop 1
    v_permlane32_swap_b32 v248, v249
    v_fma_f32 v240, v0, v172, v248
    v_fma_f32 v0, -v0, v172, v249
    v_mfma_f32_32x32x16_bf16 v[80:95], v[136:139], a[28:31], v[80:95]
    ds_read_b64_tr_b16 v[132:133], v182 offset:16480
    ds_read_b64_tr_b16 v[134:135], v182 offset:16992
    v_exp_f32 v240, v240
    v_exp_f32 v0, v0
    v_fma_f32 v241, v1, v172, v248
    v_fma_f32 v1, -v1, v172, v249
    s_add_u32 m0, s81, 0
    v_mfma_f32_32x32x16_bf16 v[96:111], v[140:143], a[24:27], v[96:111]
    buffer_load_dwordx4 v188, s[12:15], s78 offen lds
    buffer_load_dwordx4 v189, s[12:15], s78 offen offset:1024 lds
    v_exp_f32 v241, v241
    v_exp_f32 v1, v1
    v_fma_f32 v242, v2, v172, v248
    v_mfma_f32_32x32x16_bf16 v[112:127], v[140:143], a[28:31], v[112:127]
    v_fma_f32 v2, -v2, v172, v249
    v_add_f32 v250, v240, v241
    v_exp_f32 v242, v242
    v_add_f32 v251, v0, v1
    v_exp_f32 v2, v2
    v_fma_f32 v243, v3, v172, v248
    s_waitcnt lgkmcnt(0)
    v_mfma_f32_32x32x16_bf16 v[64:79], v[128:131], a[32:35], v[64:79]
    ds_read_b64_tr_b16 v[136:137], v182 offset:18496
    ds_read_b64_tr_b16 v[138:139], v182 offset:19008
    v_fma_f32 v3, -v3, v172, v249
    v_add_f32 v250, v250, v242
    v_exp_f32 v243, v243
    v_add_f32 v251, v251, v2
    v_mfma_f32_32x32x16_bf16 v[80:95], v[128:131], a[36:39], v[80:95]
    ds_read_b64_tr_b16 v[140:141], v182 offset:18528
    ds_read_b64_tr_b16 v[142:143], v182 offset:19040
    v_exp_f32 v3, v3
    v_fma_f32 v244, v4, v172, v248
    v_fma_f32 v4, -v4, v172, v249
    v_add_f32 v250, v250, v243
    v_exp_f32 v244, v244
    s_add_u32 m0, s81, 8224
    v_mfma_f32_32x32x16_bf16 v[96:111], v[132:135], a[32:35], v[96:111]
    buffer_load_dwordx4 v188, s[16:19], s78 offen lds
    buffer_load_dwordx4 v189, s[16:19], s78 offen offset:1024 lds
    v_add_f32 v251, v251, v3
    v_exp_f32 v4, v4
    v_fma_f32 v245, v5, v172, v248
    v_mfma_f32_32x32x16_bf16 v[112:127], v[132:135], a[36:39], v[112:127]
    v_fma_f32 v5, -v5, v172, v249
    v_add_f32 v250, v250, v244
    v_exp_f32 v245, v245
    v_add_f32 v251, v251, v4
    v_exp_f32 v5, v5
    v_fma_f32 v246, v6, v172, v248
    v_mfma_f32_16x16x32_bf16 v[156:159], v[144:147], v[128:131], v[156:159]
    v_fma_f32 v6, -v6, v172, v249
    v_add_f32 v250, v250, v245
    v_exp_f32 v246, v246
    v_mfma_f32_16x16x32_bf16 v[156:159], v[148:151], v[132:135], v[156:159]
    v_add_f32 v251, v251, v5
    v_exp_f32 v6, v6
    v_fma_f32 v247, v7, v172, v248
    s_waitcnt lgkmcnt(0)
    v_mfma_f32_32x32x16_bf16 v[64:79], v[136:139], a[40:43], v[64:79]
    ds_read_b64_tr_b16 v[128:129], v183 offset:16448
    ds_read_b64_tr_b16 v[130:131], v183 offset:16960
    v_fma_f32 v7, -v7, v172, v249
    v_add_f32 v250, v250, v246
    v_exp_f32 v247, v247
    v_add_f32 v251, v251, v6
    v_mfma_f32_32x32x16_bf16 v[80:95], v[136:139], a[44:47], v[80:95]
    ds_read_b64_tr_b16 v[132:133], v183 offset:16480
    ds_read_b64_tr_b16 v[134:135], v183 offset:16992
    v_exp_f32 v7, v7
    v_add_f32 v250, v250, v247
    v_add_f32 v251, v251, v7
    s_nop 1
    v_permlane32_swap_b32 v250, v251
    v_add_f32 v250, v250, v251
    v_mfma_f32_32x32x16_bf16 v[96:111], v[140:143], a[40:43], v[96:111]
    v_rcp_f32 v250, v250
    s_nop 0
    v_mul_f32 v250, v192, v250
    v_mov_b32 v251, v250
    s_nop 1
    v_permlane32_swap_b32 v250, v251
    v_mul_f32 v0, v251, v0
    v_mul_f32 v1, v251, v1
    v_cvt_pk_bf16_f32 v0, v0, v1
    s_add_u32 m0, s81, 98688
    v_mfma_f32_32x32x16_bf16 v[112:127], v[140:143], a[44:47], v[112:127]
    buffer_load_dwordx4 v188, s[12:15], s79 offen lds
    buffer_load_dwordx4 v189, s[12:15], s79 offen offset:1024 lds
    v_mul_f32 v2, v251, v2
    v_mul_f32 v3, v251, v3
    v_cvt_pk_bf16_f32 v1, v2, v3
    v_mul_f32 v4, v251, v4
    ds_write_b64 v152, v[0:1] offset:32
    v_mfma_f32_16x16x32_bf16 v[156:159], v[144:147], v[136:139], v[156:159]
    v_mul_f32 v5, v251, v5
    v_cvt_pk_bf16_f32 v2, v4, v5
    v_mul_f32 v6, v251, v6
    v_mul_f32 v7, v251, v7
    v_mfma_f32_16x16x32_bf16 v[156:159], v[148:151], v[140:143], v[156:159]
    v_cvt_pk_bf16_f32 v3, v6, v7
    v_mul_f32 v240, v250, v240
    ds_write_b64 v152, v[2:3] offset:48
    v_mul_f32 v241, v250, v241
    s_waitcnt lgkmcnt(2)
    v_mfma_f32_32x32x16_bf16 v[64:79], v[128:131], a[48:51], v[64:79]
    ds_read_b64_tr_b16 v[136:137], v183 offset:18496
    ds_read_b64_tr_b16 v[138:139], v183 offset:19008
    v_cvt_pk_bf16_f32 v4, v240, v241
    v_mul_f32 v242, v250, v242
    v_mul_f32 v243, v250, v243
L_padA0_1:
    s_cbranch_execz L_retA0
    v_cvt_pk_bf16_f32 v5, v242, v243
    v_mul_f32 v244, v250, v244
    ds_write_b64 v152, v[4:5] offset:0
    v_mfma_f32_32x32x16_bf16 v[80:95], v[128:131], a[52:55], v[80:95]
    ds_read_b64_tr_b16 v[140:141], v183 offset:18528
    ds_read_b64_tr_b16 v[142:143], v183 offset:19040
    v_mul_f32 v245, v250, v245
    v_cvt_pk_bf16_f32 v6, v244, v245
    v_mul_f32 v246, v250, v246
    v_mul_f32 v247, v250, v247
    v_cvt_pk_bf16_f32 v7, v246, v247
    ds_write_b64 v152, v[6:7] offset:16
    v_mfma_f32_32x32x16_bf16 v[96:111], v[132:135], a[48:51], v[96:111]
    v_max3_f32 v248, v8, v9, v10
    v_min3_f32 v249, v8, v9, v10
    ds_read_b64_tr_b16 v[36:37], v155 offset:0
    v_max3_f32 v248, v248, v11, v12
    v_min3_f32 v249, v249, v11, v12
    v_max3_f32 v248, v248, v13, v14
    ds_read_b64_tr_b16 v[38:39], v155 offset:416
    v_min3_f32 v249, v249, v13, v14
    s_add_u32 m0, s81, 106912
    v_mfma_f32_32x32x16_bf16 v[112:127], v[132:135], a[52:55], v[112:127]
    buffer_load_dwordx4 v188, s[16:19], s79 offen lds
    buffer_load_dwordx4 v189, s[16:19], s79 offen offset:1024 lds
    v_max_f32 v248, v248, v15
    v_max_f32_e64 v249, -v249, -v15
    ds_read_b64_tr_b16 v[32:33], v153 offset:0
    ds_read_b64_tr_b16 v[34:35], v153 offset:288
    v_permlane32_swap_b32 v248, v249
    s_waitcnt vmcnt(20) lgkmcnt(5)
    s_barrier
    v_mfma_f32_32x32x16_bf16 v[64:79], v[136:139], a[56:59], v[64:79]
    ds_read_b64_tr_b16 v[128:129], v182 offset:32896
    ds_read_b64_tr_b16 v[130:131], v182 offset:33408
    v_max_f32 v248, v248, v249
    v_mul_f32_e64 v248, -v248, v172
    v_mov_b32 v249, v248
    ds_read_b64_tr_b16 v[44:45], v155 offset:1664
    ds_read_b64_tr_b16 v[46:47], v155 offset:2080
    v_mfma_f32_32x32x16_bf16 v[80:95], v[136:139], a[60:63], v[80:95]
    ds_read_b64_tr_b16 v[132:133], v182 offset:32928
    ds_read_b64_tr_b16 v[134:135], v182 offset:33440
    v_permlane32_swap_b32 v248, v249
    v_fma_f32 v240, v8, v172, v248
    v_fma_f32 v8, -v8, v172, v249
    v_exp_f32 v240, v240
    ds_read_b64_tr_b16 v[40:41], v153 offset:1152
    s_add_u32 m0, s82, 16448
    v_mfma_f32_32x32x16_bf16 v[96:111], v[140:143], a[56:59], v[96:111]
    buffer_load_dwordx4 v190, s[12:15], s72 offen lds
    v_exp_f32 v8, v8
    v_fma_f32 v241, v9, v172, v248
    v_fma_f32 v9, -v9, v172, v249
    v_exp_f32 v241, v241
    v_mfma_f32_32x32x16_bf16 v[112:127], v[140:143], a[60:63], v[112:127]
    ds_read_b64_tr_b16 v[42:43], v153 offset:1440
    v_exp_f32 v9, v9
    v_fma_f32 v242, v10, v172, v248
    v_fma_f32 v10, -v10, v172, v249
    v_add_f32 v250, v240, v241
    v_exp_f32 v242, v242
    s_waitcnt lgkmcnt(2)
    v_mfma_f32_32x32x16_bf16 v[64:79], v[128:131], a[64:67], v[64:79]
    ds_read_b64_tr_b16 v[136:137], v182 offset:34944
    ds_read_b64_tr_b16 v[138:139], v182 offset:35456
    v_lshlrev_b32 v174, 2, v197
    buffer_load_dword v175, v174, s[36:39], 0 offen sc1
    v_add_f32 v251, v8, v9
    v_exp_f32 v10, v10
    v_fma_f32 v243, v11, v172, v248
    v_mfma_f32_32x32x16_bf16 v[80:95], v[128:131], a[68:71], v[80:95]
    ds_read_b64_tr_b16 v[140:141], v182 offset:34976
    ds_read_b64_tr_b16 v[142:143], v182 offset:35488
    v_fma_f32 v11, -v11, v172, v249
    v_add_f32 v250, v250, v242
    v_exp_f32 v243, v243
    v_add_f32 v251, v251, v10
    s_add_u32 m0, s82, 20576
    v_mfma_f32_32x32x16_bf16 v[96:111], v[132:135], a[64:67], v[96:111]
    buffer_load_dwordx4 v190, s[16:19], s72 offen lds
    v_exp_f32 v11, v11
    v_fma_f32 v244, v12, v172, v248
    v_fma_f32 v12, -v12, v172, v249
    v_add_f32 v250, v250, v243
    v_exp_f32 v244, v244
    v_mfma_f32_32x32x16_bf16 v[112:127], v[132:135], a[68:71], v[112:127]
    v_add_f32 v251, v251, v11
    v_exp_f32 v12, v12
    v_fma_f32 v245, v13, v172, v248
    v_fma_f32 v13, -v13, v172, v249
    v_add_f32 v250, v250, v244
    v_exp_f32 v245, v245
    v_mfma_f32_16x16x32_bf16 v[156:159], v[144:147], v[128:131], v[156:159]
    v_add_f32 v251, v251, v12
    v_mfma_f32_32x32x16_bf16 v[208:223], v[32:35], v[36:39], 0
    v_mfma_f32_16x16x32_bf16 v[156:159], v[148:151], v[132:135], v[156:159]
    s_waitcnt lgkmcnt(0)
    v_mfma_f32_32x32x16_bf16 v[64:79], v[136:139], a[72:75], v[64:79]
    ds_read_b64_tr_b16 v[128:129], v183 offset:32896
    ds_read_b64_tr_b16 v[130:131], v183 offset:33408
    v_exp_f32 v13, v13
    v_fma_f32 v246, v14, v172, v248
    v_fma_f32 v14, -v14, v172, v249
    v_add_f32 v250, v250, v245
    v_mfma_f32_32x32x16_bf16 v[80:95], v[136:139], a[76:79], v[80:95]
    ds_read_b64_tr_b16 v[132:133], v183 offset:32928
    ds_read_b64_tr_b16 v[134:135], v183 offset:33440
    v_exp_f32 v246, v246
    v_add_f32 v251, v251, v13
    v_exp_f32 v14, v14
    v_fma_f32 v247, v15, v172, v248
    v_mfma_f32_32x32x16_bf16 v[96:111], v[140:143], a[72:75], v[96:111]
    s_add_u32 m0, s81, 24672
    s_lshl3_add_u32 s83, s56, s94
    buffer_load_dwordx4 v198, s[20:23], s83 offen lds
    buffer_load_dwordx4 v199, s[20:23], s83 offen offset:1024 lds
    v_fma_f32 v15, -v15, v172, v249
    v_add_f32 v250, v250, v246
    v_exp_f32 v247, v247
    v_mfma_f32_32x32x16_bf16 v[112:127], v[140:143], a[76:79], v[112:127]
    v_add_f32 v251, v251, v14
    v_mfma_f32_32x32x16_bf16 v[208:223], v[40:43], v[44:47], v[208:223]
    v_exp_f32 v15, v15
    v_mfma_f32_16x16x32_bf16 v[156:159], v[144:147], v[136:139], v[156:159]
    v_add_f32 v250, v250, v247
    v_add_f32 v251, v251, v15
    s_nop 1
    v_permlane32_swap_b32 v250, v251
    v_mfma_f32_16x16x32_bf16 v[156:159], v[148:151], v[140:143], v[156:159]
    v_add_f32 v250, v250, v251
    v_rcp_f32 v250, v250
    s_nop 0
    v_mul_f32 v250, v192, v250
    s_waitcnt lgkmcnt(0)
    v_mfma_f32_32x32x16_bf16 v[64:79], v[128:131], a[80:83], v[64:79]
    ds_read_b64_tr_b16 v[136:137], v183 offset:34944
    ds_read_b64_tr_b16 v[138:139], v183 offset:35456
    v_mov_b32 v251, v250
    s_nop 1
    v_permlane32_swap_b32 v250, v251
    v_mul_f32 v8, v251, v8
    v_mul_f32 v9, v251, v9
    v_cvt_pk_bf16_f32 v8, v8, v9
    v_mul_f32 v10, v251, v10
    v_mfma_f32_32x32x16_bf16 v[80:95], v[128:131], a[84:87], v[80:95]
    ds_read_b64_tr_b16 v[140:141], v183 offset:34976
    ds_read_b64_tr_b16 v[142:143], v183 offset:35488
    v_mul_f32 v11, v251, v11
    v_cvt_pk_bf16_f32 v9, v10, v11
    v_mul_f32 v12, v251, v12
    ds_write_b64 v152, v[8:9] offset:32
    v_mul_f32 v13, v251, v13
    v_cvt_pk_bf16_f32 v10, v12, v13
    v_mfma_f32_32x32x16_bf16 v[96:111], v[132:135], a[80:83], v[96:111]
    v_mul_f32 v14, v251, v14
    v_mul_f32 v15, v251, v15
    v_cvt_pk_bf16_f32 v11, v14, v15
    v_mul_f32 v240, v250, v240
    ds_write_b64 v152, v[10:11] offset:48
L_padA1_5:
    s_cbranch_execz L_padA1_9
    v_mul_f32 v241, v250, v241
    v_cvt_pk_bf16_f32 v12, v240, v241
    v_mul_f32 v242, v250, v242
    v_mfma_f32_32x32x16_bf16 v[112:127], v[132:135], a[84:87], v[112:127]
    v_mul_f32 v243, v250, v243
    v_cvt_pk_bf16_f32 v13, v242, v243
    v_mul_f32 v244, v250, v244
    ds_write_b64 v152, v[12:13] offset:0
    v_mul_f32 v245, v250, v245
    v_cvt_pk_bf16_f32 v14, v244, v245
    v_mul_f32 v246, v250, v246
    v_mul_f32 v247, v250, v247
    s_waitcnt vmcnt(21) lgkmcnt(3)
    s_barrier
    v_mfma_f32_32x32x16_bf16 v[64:79], v[136:139], a[88:91], v[64:79]
    ds_read_b64_tr_b16 v[128:129], v184 offset:0
    ds_read_b64_tr_b16 v[130:131], v184 offset:512
    v_cvt_pk_bf16_f32 v15, v246, v247
    ds_write_b64 v152, v[14:15] offset:16
    ds_read_b64_tr_b16 v[36:37], v253 offset:0
    v_cvt_pk_bf16_f32 v240, v16, v17
    ds_read_b64_tr_b16 v[38:39], v253 offset:416
    v_mfma_f32_32x32x16_bf16 v[80:95], v[136:139], a[92:95], v[80:95]
    ds_read_b64_tr_b16 v[132:133], v184 offset:32
    ds_read_b64_tr_b16 v[134:135], v184 offset:544
    v_cvt_pk_bf16_f32 v241, v18, v19
    ds_read_b64_tr_b16 v[32:33], v153 offset:0
    v_cvt_pk_bf16_f32 v242, v20, v21
    ds_read_b64_tr_b16 v[34:35], v153 offset:288
    v_cvt_pk_bf16_f32 v243, v22, v23
    ds_read_b64_tr_b16 v[44:45], v253 offset:1664
    s_add_u32 m0, s82, 32896
    v_mfma_f32_32x32x16_bf16 v[96:111], v[140:143], a[88:91], v[96:111]
    buffer_load_dwordx4 v190, s[12:15], s73 offen lds
    v_cvt_pk_bf16_f32 v244, v24, v25
    ds_read_b64_tr_b16 v[46:47], v253 offset:2080
    v_cvt_pk_bf16_f32 v245, v26, v27
    ds_read_b64_tr_b16 v[40:41], v153 offset:1152
    v_cvt_pk_bf16_f32 v246, v28, v29
    ds_read_b64_tr_b16 v[42:43], v153 offset:1440
    v_mfma_f32_32x32x16_bf16 v[112:127], v[140:143], a[92:95], v[112:127]
    v_cvt_pk_bf16_f32 v247, v30, v31
    v_mfma_f32_32x32x16_bf16 v[16:31], v[200:203], v[240:243], 0
    s_nop 0
    v_mfma_f32_32x32x16_bf16 v[16:31], v[204:207], v[244:247], v[16:31]
    s_waitcnt lgkmcnt(6)
    v_mfma_f32_32x32x16_bf16 v[64:79], v[128:131], a[96:99], v[64:79]
    ds_read_b64_tr_b16 v[136:137], v184 offset:2048
    ds_read_b64_tr_b16 v[138:139], v184 offset:2560
    v_mfma_f32_32x32x16_bf16 v[80:95], v[128:131], a[100:103], v[80:95]
    ds_read_b64_tr_b16 v[140:141], v184 offset:2080
    ds_read_b64_tr_b16 v[142:143], v184 offset:2592
    v_rcp_f32 v248, v193
    s_nop 0
    v_cvt_pk_bf16_f32 v248, v248, v248
    ds_write_b32 v154, v248 offset:64
    v_cvt_pk_bf16_f32 v48, v48, v49
    v_cvt_pk_bf16_f32 v49, v50, v51
    s_add_u32 m0, s82, 37024
    v_mfma_f32_32x32x16_bf16 v[96:111], v[132:135], a[96:99], v[96:111]
    buffer_load_dwordx4 v190, s[16:19], s73 offen lds
    ds_write_b64 v154, v[48:49] offset:0
    s_waitcnt lgkmcnt(10)
    v_mfma_f32_32x32x16_bf16 v[224:239], v[32:35], v[36:39], 0
    v_mfma_f32_32x32x16_bf16 v[112:127], v[132:135], a[100:103], v[112:127]
    v_cvt_pk_bf16_f32 v50, v52, v53
    v_cvt_pk_bf16_f32 v51, v54, v55
    ds_write_b64 v154, v[50:51] offset:16
    v_cvt_pk_bf16_f32 v52, v56, v57
    v_cvt_pk_bf16_f32 v53, v58, v59
    ds_write_b64 v154, v[52:53] offset:32
    s_waitcnt lgkmcnt(8)
    v_mfma_f32_32x32x16_bf16 v[224:239], v[40:43], v[44:47], v[224:239]
    v_mfma_f32_16x16x32_bf16 v[156:159], v[144:147], v[128:131], v[156:159]
    v_mfma_f32_16x16x32_bf16 v[156:159], v[148:151], v[132:135], v[156:159]
    v_cvt_pk_bf16_f32 v54, v60, v61
    v_cvt_pk_bf16_f32 v55, v62, v63
    ds_write_b64 v154, v[54:55] offset:48
    s_waitcnt lgkmcnt(5)
    v_mfma_f32_32x32x16_bf16 v[64:79], v[136:139], a[104:107], v[64:79]
    ds_read_b64_tr_b16 v[128:129], v185 offset:0
    ds_read_b64_tr_b16 v[130:131], v185 offset:512
    v_max3_f32 v248, v16, v17, v18
    v_min3_f32 v249, v16, v17, v18
    v_max3_f32 v248, v248, v19, v20
    v_min3_f32 v249, v249, v19, v20
    v_max3_f32 v248, v248, v21, v22
    v_min3_f32 v249, v249, v21, v22
    v_mfma_f32_32x32x16_bf16 v[80:95], v[136:139], a[108:111], v[80:95]
    ds_read_b64_tr_b16 v[132:133], v185 offset:32
    ds_read_b64_tr_b16 v[134:135], v185 offset:544
    v_max_f32 v248, v248, v23
    v_max_f32_e64 v249, -v249, -v23
    s_nop 1
    v_permlane32_swap_b32 v248, v249
    v_max_f32 v248, v248, v249
    v_mul_f32_e64 v248, -v248, v173
    v_mov_b32 v249, v248
    v_mfma_f32_32x32x16_bf16 v[96:111], v[140:143], a[104:107], v[96:111]
    s_add_u32 m0, s81, 41120
    s_lshl3_add_u32 s83, s57, s94
    buffer_load_dwordx4 v198, s[20:23], s83 offen lds
    buffer_load_dwordx4 v199, s[20:23], s83 offen offset:1024 lds
    v_permlane32_swap_b32 v248, v249
    v_fma_f32 v240, v16, v173, v248
    v_fma_f32 v16, -v16, v173, v249
    v_mfma_f32_32x32x16_bf16 v[112:127], v[140:143], a[108:111], v[112:127]
    v_exp_f32 v240, v240
    v_exp_f32 v16, v16
    v_fma_f32 v241, v17, v173, v248
    v_fma_f32 v17, -v17, v173, v249
    v_exp_f32 v241, v241
    v_mfma_f32_16x16x32_bf16 v[156:159], v[144:147], v[136:139], v[156:159]
    v_exp_f32 v17, v17
    v_fma_f32 v242, v18, v173, v248
    v_fma_f32 v18, -v18, v173, v249
    v_mfma_f32_16x16x32_bf16 v[156:159], v[148:151], v[140:143], v[156:159]
    v_add_f32 v250, v240, v241
    v_exp_f32 v242, v242
    v_add_f32 v251, v16, v17
    s_waitcnt lgkmcnt(0)
    v_mfma_f32_32x32x16_bf16 v[64:79], v[128:131], a[112:115], v[64:79]
    ds_read_b64_tr_b16 v[136:137], v185 offset:2048
    ds_read_b64_tr_b16 v[138:139], v185 offset:2560
    v_exp_f32 v18, v18
    v_fma_f32 v243, v19, v173, v248
    v_fma_f32 v19, -v19, v173, v249
    v_add_f32 v250, v250, v242
    v_mfma_f32_32x32x16_bf16 v[80:95], v[128:131], a[116:119], v[80:95]
    ds_read_b64_tr_b16 v[140:141], v185 offset:2080
    ds_read_b64_tr_b16 v[142:143], v185 offset:2592
    v_exp_f32 v243, v243
    v_add_f32 v251, v251, v18
    v_exp_f32 v19, v19
    v_fma_f32 v244, v20, v173, v248
    v_mfma_f32_32x32x16_bf16 v[96:111], v[132:135], a[112:115], v[96:111]
    v_fma_f32 v20, -v20, v173, v249
    v_add_f32 v250, v250, v243
    v_exp_f32 v244, v244
    v_add_f32 v251, v251, v19
    v_exp_f32 v20, v20
    v_fma_f32 v245, v21, v173, v248
    v_mfma_f32_32x32x16_bf16 v[112:127], v[132:135], a[116:119], v[112:127]
    v_fma_f32 v21, -v21, v173, v249
    v_add_f32 v250, v250, v244
    v_exp_f32 v245, v245
    v_add_f32 v251, v251, v20
    v_exp_f32 v21, v21
    v_fma_f32 v246, v22, v173, v248
L_padA1_6:
    s_cbranch_execz L_padA1_10
    s_waitcnt vmcnt(21) lgkmcnt(0)
    s_barrier
    v_mfma_f32_32x32x16_bf16 v[64:79], v[136:139], a[120:123], v[64:79]
    ds_read_b64_tr_b16 v[128:129], v182 offset:49344
    ds_read_b64_tr_b16 v[130:131], v182 offset:49856
    v_fma_f32 v22, -v22, v173, v249
    v_add_f32 v250, v250, v245
    v_exp_f32 v246, v246
    v_add_f32 v251, v251, v21
    v_mfma_f32_32x32x16_bf16 v[80:95], v[136:139], a[124:127], v[80:95]
    ds_read_b64_tr_b16 v[132:133], v182 offset:49376
    ds_read_b64_tr_b16 v[134:135], v182 offset:49888
    v_exp_f32 v22, v22
    v_fma_f32 v247, v23, v173, v248
    v_fma_f32 v23, -v23, v173, v249
    v_add_f32 v250, v250, v246
    v_exp_f32 v247, v247
    s_add_u32 m0, s82, 65792
    v_mfma_f32_32x32x16_bf16 v[96:111], v[140:143], a[120:123], v[96:111]
    buffer_load_dwordx4 v190, s[12:15], s74 offen lds
    v_add_f32 v251, v251, v22
    v_exp_f32 v23, v23
    v_add_f32 v250, v250, v247
    v_add_f32 v251, v251, v23
    v_mfma_f32_32x32x16_bf16 v[112:127], v[140:143], a[124:127], v[112:127]
    s_nop 0
    v_permlane32_swap_b32 v250, v251
    v_add_f32 v250, v250, v251
    v_rcp_f32 v250, v250
    s_nop 0
    v_mul_f32 v250, v193, v250
    v_mov_b32 v251, v250
    s_nop 1
    v_permlane32_swap_b32 v250, v251
    v_mul_f32 v16, v251, v16
    s_waitcnt lgkmcnt(0)
    v_mfma_f32_32x32x16_bf16 v[64:79], v[128:131], a[128:131], v[64:79]
    ds_read_b64_tr_b16 v[136:137], v182 offset:51392
    ds_read_b64_tr_b16 v[138:139], v182 offset:51904
    v_mul_f32 v17, v251, v17
    v_cvt_pk_bf16_f32 v16, v16, v17
    v_mul_f32 v18, v251, v18
    v_mul_f32 v19, v251, v19
    v_cvt_pk_bf16_f32 v17, v18, v19
    v_mul_f32 v20, v251, v20
    v_mfma_f32_32x32x16_bf16 v[80:95], v[128:131], a[132:135], v[80:95]
    ds_read_b64_tr_b16 v[140:141], v182 offset:51424
    ds_read_b64_tr_b16 v[142:143], v182 offset:51936
    ds_write_b64 v152, v[16:17] offset:32
    v_mul_f32 v21, v251, v21
    v_cvt_pk_bf16_f32 v18, v20, v21
    v_mul_f32 v22, v251, v22
    v_mul_f32 v23, v251, v23
    v_cvt_pk_bf16_f32 v19, v22, v23
    s_add_u32 m0, s82, 69920
    v_mfma_f32_32x32x16_bf16 v[96:111], v[132:135], a[128:131], v[96:111]
    buffer_load_dwordx4 v190, s[16:19], s74 offen lds
    v_mul_f32 v240, v250, v240
    ds_write_b64 v152, v[18:19] offset:48
    v_mul_f32 v241, v250, v241
    v_cvt_pk_bf16_f32 v20, v240, v241
    v_mul_f32 v242, v250, v242
    v_mul_f32 v243, v250, v243
    v_mfma_f32_32x32x16_bf16 v[112:127], v[132:135], a[132:135], v[112:127]
    v_cvt_pk_bf16_f32 v21, v242, v243
    v_mul_f32 v244, v250, v244
    ds_write_b64 v152, v[20:21] offset:0
    v_mul_f32 v245, v250, v245
    v_cvt_pk_bf16_f32 v22, v244, v245
    v_mul_f32 v246, v250, v246
    v_mul_f32 v247, v250, v247
    v_cvt_pk_bf16_f32 v23, v246, v247
    v_mfma_f32_16x16x32_bf16 v[156:159], v[144:147], v[128:131], v[156:159]
    ds_write_b64 v152, v[22:23] offset:16
    v_max3_f32 v248, v24, v25, v26
    v_min3_f32 v249, v24, v25, v26
    ds_read_b64_tr_b16 v[36:37], v155 offset:0
    v_mfma_f32_16x16x32_bf16 v[156:159], v[148:151], v[132:135], v[156:159]
    v_max3_f32 v248, v248, v27, v28
    v_min3_f32 v249, v249, v27, v28
    v_max3_f32 v248, v248, v29, v30
    ds_read_b64_tr_b16 v[38:39], v155 offset:416
    s_waitcnt lgkmcnt(6)
    v_mfma_f32_32x32x16_bf16 v[64:79], v[136:139], a[136:139], v[64:79]
    ds_read_b64_tr_b16 v[128:129], v183 offset:49344
    ds_read_b64_tr_b16 v[130:131], v183 offset:49856
    v_min3_f32 v249, v249, v29, v30
    v_max_f32 v248, v248, v31
    v_max_f32_e64 v249, -v249, -v31
    ds_read_b64_tr_b16 v[32:33], v153 offset:0
    ds_read_b64_tr_b16 v[34:35], v153 offset:288
    v_mfma_f32_32x32x16_bf16 v[80:95], v[136:139], a[140:143], v[80:95]
    ds_read_b64_tr_b16 v[132:133], v183 offset:49376
    ds_read_b64_tr_b16 v[134:135], v183 offset:49888
    v_permlane32_swap_b32 v248, v249
    v_max_f32 v248, v248, v249
    v_mul_f32_e64 v248, -v248, v173
    v_mov_b32 v249, v248
    ds_read_b64_tr_b16 v[44:45], v155 offset:1664
    ds_read_b64_tr_b16 v[46:47], v155 offset:2080
    v_mfma_f32_32x32x16_bf16 v[96:111], v[140:143], a[136:139], v[96:111]
    s_add_u32 m0, s81, 74016
    s_lshl3_add_u32 s83, s58, s94
    buffer_load_dwordx4 v198, s[20:23], s83 offen lds
    buffer_load_dwordx4 v199, s[20:23], s83 offen offset:1024 lds
    v_permlane32_swap_b32 v248, v249
    v_fma_f32 v240, v24, v173, v248
    v_fma_f32 v24, -v24, v173, v249
    v_exp_f32 v240, v240
    v_mfma_f32_32x32x16_bf16 v[112:127], v[140:143], a[140:143], v[112:127]
    ds_read_b64_tr_b16 v[40:41], v153 offset:1152
    v_exp_f32 v24, v24
    v_fma_f32 v241, v25, v173, v248
    v_fma_f32 v25, -v25, v173, v249
    v_exp_f32 v241, v241
    v_mfma_f32_16x16x32_bf16 v[156:159], v[144:147], v[136:139], v[156:159]
    ds_read_b64_tr_b16 v[42:43], v153 offset:1440
    v_exp_f32 v25, v25
    v_fma_f32 v242, v26, v173, v248
    v_mfma_f32_16x16x32_bf16 v[156:159], v[148:151], v[140:143], v[156:159]
    v_fma_f32 v26, -v26, v173, v249
    v_add_f32 v250, v240, v241
    v_exp_f32 v242, v242
    s_waitcnt lgkmcnt(4)
    v_mfma_f32_32x32x16_bf16 v[64:79], v[128:131], a[144:147], v[64:79]
    ds_read_b64_tr_b16 v[136:137], v183 offset:51392
    ds_read_b64_tr_b16 v[138:139], v183 offset:51904
    v_add_f32 v251, v24, v25
    v_exp_f32 v26, v26
    v_fma_f32 v243, v27, v173, v248
    v_fma_f32 v27, -v27, v173, v249
    v_add_f32 v250, v250, v242
    v_mfma_f32_32x32x16_bf16 v[80:95], v[128:131], a[148:151], v[80:95]
    ds_read_b64_tr_b16 v[140:141], v183 offset:51424
    ds_read_b64_tr_b16 v[142:143], v183 offset:51936
    v_exp_f32 v243, v243
    v_add_f32 v251, v251, v26
    v_exp_f32 v27, v27
    v_fma_f32 v244, v28, v173, v248
    v_mfma_f32_32x32x16_bf16 v[96:111], v[132:135], a[144:147], v[96:111]
    v_fma_f32 v28, -v28, v173, v249
    v_add_f32 v250, v250, v243
    v_exp_f32 v244, v244
    v_add_f32 v251, v251, v27
    v_exp_f32 v28, v28
    v_fma_f32 v245, v29, v173, v248
    v_mfma_f32_32x32x16_bf16 v[112:127], v[132:135], a[148:151], v[112:127]
    v_fma_f32 v29, -v29, v173, v249
    v_add_f32 v250, v250, v244
    v_exp_f32 v245, v245
    v_add_f32 v251, v251, v28
    v_mfma_f32_32x32x16_bf16 v[208:223], v[32:35], v[36:39], v[208:223]
    s_waitcnt vmcnt(21) lgkmcnt(0)
    s_barrier
    v_mfma_f32_32x32x16_bf16 v[64:79], v[136:139], a[152:155], v[64:79]
    ds_read_b64_tr_b16 v[128:129], v184 offset:16448
    ds_read_b64_tr_b16 v[130:131], v184 offset:16960
    v_exp_f32 v29, v29
    v_mfma_f32_32x32x16_bf16 v[80:95], v[136:139], a[156:159], v[80:95]
    ds_read_b64_tr_b16 v[132:133], v184 offset:16480
    ds_read_b64_tr_b16 v[134:135], v184 offset:16992
    v_fma_f32 v246, v30, v173, v248
L_padA1_7:
    s_cbranch_execz L_padA1_11
    v_fma_f32 v30, -v30, v173, v249
    v_add_f32 v250, v250, v245
    v_exp_f32 v246, v246
    v_add_f32 v251, v251, v29
    s_add_u32 m0, s82, 49344
    v_mfma_f32_32x32x16_bf16 v[96:111], v[140:143], a[152:155], v[96:111]
    buffer_load_dwordx4 v190, s[12:15], s75 offen lds
    v_exp_f32 v30, v30
    v_fma_f32 v247, v31, v173, v248
    v_fma_f32 v31, -v31, v173, v249
    v_add_f32 v250, v250, v246
    v_exp_f32 v247, v247
    v_mfma_f32_32x32x16_bf16 v[112:127], v[140:143], a[156:159], v[112:127]
    v_add_f32 v251, v251, v30
    v_mfma_f32_32x32x16_bf16 v[208:223], v[40:43], v[44:47], v[208:223]
    s_waitcnt lgkmcnt(0)
    v_mfma_f32_32x32x16_bf16 v[64:79], v[128:131], a[160:163], v[64:79]
    ds_read_b64_tr_b16 v[136:137], v184 offset:18496
    ds_read_b64_tr_b16 v[138:139], v184 offset:19008
    v_exp_f32 v31, v31
    v_add_f32 v250, v250, v247
    v_add_f32 v251, v251, v31
    s_nop 1
    v_permlane32_swap_b32 v250, v251
    v_add_f32 v250, v250, v251
    v_mfma_f32_32x32x16_bf16 v[80:95], v[128:131], a[164:167], v[80:95]
    ds_read_b64_tr_b16 v[140:141], v184 offset:18528
    ds_read_b64_tr_b16 v[142:143], v184 offset:19040
    v_rcp_f32 v250, v250
    s_nop 0
    v_mul_f32 v250, v193, v250
    v_mov_b32 v251, v250
    s_nop 1
    v_permlane32_swap_b32 v250, v251
    v_mul_f32 v24, v251, v24
    s_add_u32 m0, s82, 53472
    v_mfma_f32_32x32x16_bf16 v[96:111], v[132:135], a[160:163], v[96:111]
    buffer_load_dwordx4 v190, s[16:19], s75 offen lds
    v_mul_f32 v25, v251, v25
    v_cvt_pk_bf16_f32 v24, v24, v25
    v_mul_f32 v26, v251, v26
    v_mul_f32 v27, v251, v27
    v_cvt_pk_bf16_f32 v25, v26, v27
    v_mul_f32 v28, v251, v28
    v_mfma_f32_32x32x16_bf16 v[112:127], v[132:135], a[164:167], v[112:127]
    v_lshrrev_b32 v176, 5, v197
    v_lshlrev_b32 v176, 9, v176
    ds_write_b64 v152, v[24:25] offset:32
    v_mul_f32 v29, v251, v29
    v_cvt_pk_bf16_f32 v26, v28, v29
    v_mul_f32 v30, v251, v30
    v_mul_f32 v31, v251, v31
    v_cvt_pk_bf16_f32 v27, v30, v31
    v_mfma_f32_16x16x32_bf16 v[156:159], v[144:147], v[128:131], v[156:159]
    v_mul_f32 v240, v250, v240
    ds_write_b64 v152, v[26:27] offset:48
    v_mul_f32 v241, v250, v241
    v_cvt_pk_bf16_f32 v28, v240, v241
    v_mfma_f32_16x16x32_bf16 v[156:159], v[148:151], v[132:135], v[156:159]
    v_mul_f32 v242, v250, v242
    v_mul_f32 v243, v250, v243
    v_cvt_pk_bf16_f32 v29, v242, v243
    v_mul_f32 v244, v250, v244
    s_waitcnt lgkmcnt(2)
    v_mfma_f32_32x32x16_bf16 v[64:79], v[136:139], a[168:171], v[64:79]
    ds_read_b64_tr_b16 v[128:129], v185 offset:16448
    ds_read_b64_tr_b16 v[130:131], v185 offset:16960
    ds_write_b64 v152, v[28:29] offset:0
    v_mul_f32 v245, v250, v245
    v_cvt_pk_bf16_f32 v30, v244, v245
    v_mul_f32 v246, v250, v246
    v_mul_f32 v247, v250, v247
    v_mfma_f32_32x32x16_bf16 v[80:95], v[136:139], a[172:175], v[80:95]
    ds_read_b64_tr_b16 v[132:133], v185 offset:16480
    ds_read_b64_tr_b16 v[134:135], v185 offset:16992
    v_cvt_pk_bf16_f32 v31, v246, v247
    ds_write_b64 v152, v[30:31] offset:16
    ds_read_b64_tr_b16 v[36:37], v253 offset:0
    ds_read_b64_tr_b16 v[38:39], v253 offset:416
    v_mfma_f32_32x32x16_bf16 v[96:111], v[140:143], a[168:171], v[96:111]
    s_add_u32 m0, s81, 57568
    s_lshl3_add_u32 s83, s59, s94
    buffer_load_dwordx4 v198, s[20:23], s83 offen lds
    buffer_load_dwordx4 v199, s[20:23], s83 offen offset:1024 lds
    ds_read_b64_tr_b16 v[32:33], v153 offset:0
    ds_read_b64_tr_b16 v[34:35], v153 offset:288
    v_mfma_f32_32x32x16_bf16 v[112:127], v[140:143], a[172:175], v[112:127]
    v_bfe_u32 v177, v197, 2, 2
    v_lshl_add_u32 v176, v177, 6, v176
    ds_read_b64_tr_b16 v[44:45], v253 offset:1664
    ds_read_b64_tr_b16 v[46:47], v253 offset:2080
    ds_read_b64_tr_b16 v[40:41], v153 offset:1152
    v_mfma_f32_16x16x32_bf16 v[156:159], v[144:147], v[136:139], v[156:159]
    ds_read_b64_tr_b16 v[42:43], v153 offset:1440
    s_mul_i32 s83, s44, 5632
    s_add_u32 s83, s83, 131584
    v_lshl_add_u32 v240, v197, 4, s83
    s_xor_b32 s83, s44, 1
    s_mul_i32 s83, s83, 5632
    s_add_u32 s83, s83, 131584
    v_lshl_add_u32 v241, v197, 4, s83
    v_mfma_f32_16x16x32_bf16 v[156:159], v[148:151], v[140:143], v[156:159]
    s_waitcnt lgkmcnt(9)
    v_mfma_f32_32x32x16_bf16 v[64:79], v[128:131], a[176:179], v[64:79]
    ds_read_b64_tr_b16 v[136:137], v185 offset:18496
    ds_read_b64_tr_b16 v[138:139], v185 offset:19008
    v_mfma_f32_32x32x16_bf16 v[80:95], v[128:131], a[180:183], v[80:95]
    ds_read_b64_tr_b16 v[140:141], v185 offset:18528
    ds_read_b64_tr_b16 v[142:143], v185 offset:19040
    s_waitcnt lgkmcnt(8)
    v_mfma_f32_32x32x16_bf16 v[224:239], v[32:35], v[36:39], v[224:239]
    v_mfma_f32_32x32x16_bf16 v[96:111], v[132:135], a[176:179], v[96:111]
    v_and_b32 v177, 3, v197
    v_lshl_add_u32 v176, v177, 3, v176
    s_waitcnt lgkmcnt(4)
    v_mfma_f32_32x32x16_bf16 v[224:239], v[40:43], v[44:47], v[224:239]
    v_mfma_f32_32x32x16_bf16 v[112:127], v[132:135], a[180:183], v[112:127]
    v_bfe_u32 v177, v197, 4, 1
    s_nop 9
    ds_write_b128 v240, v[224:227] offset:0
    ds_write_b128 v240, v[228:231] offset:1024
    ds_write_b128 v240, v[232:235] offset:2048
    ds_write_b128 v240, v[236:239] offset:3072
    s_waitcnt vmcnt(21) lgkmcnt(0)
    s_barrier
    v_mfma_f32_32x32x16_bf16 v[64:79], v[136:139], a[184:187], v[64:79]
    ds_read_b64_tr_b16 v[128:129], v182 offset:0
    ds_read_b64_tr_b16 v[130:131], v182 offset:512
    ds_read_b128 v[224:227], v241 offset:0
    ds_read_b128 v[228:231], v241 offset:1024
    ds_read_b128 v[232:235], v241 offset:2048
    ds_read_b128 v[236:239], v241 offset:3072
    v_mfma_f32_32x32x16_bf16 v[80:95], v[136:139], a[188:191], v[80:95]
    ds_read_b64_tr_b16 v[132:133], v182 offset:32
    ds_read_b64_tr_b16 v[134:135], v182 offset:544
    s_add_u32 m0, s82, 82240
    v_mfma_f32_32x32x16_bf16 v[96:111], v[140:143], a[184:187], v[96:111]
    buffer_load_dwordx4 v190, s[12:15], s76 offen lds
    s_waitcnt lgkmcnt(5)
    v_add_f32 v208, v208, v224
    v_add_f32 v209, v209, v225
    v_add_f32 v210, v210, v226
    v_add_f32 v211, v211, v227
    v_mfma_f32_32x32x16_bf16 v[112:127], v[140:143], a[188:191], v[112:127]
    v_mul_u32_u24 v177, 4128, v177
    v_add_u32 v176, v176, v177
    buffer_store_dwordx4 v[208:211], v254, s[28:31], 0 offen offset:0 sc1
    s_waitcnt lgkmcnt(4)
    v_add_f32 v212, v212, v228
    v_add_f32 v213, v213, v229
    v_add_f32 v214, v214, v230
    s_waitcnt lgkmcnt(0)
    v_mfma_f32_32x32x16_bf16 v[64:79], v[128:131], a[192:195], v[64:79]
    ds_read_b64_tr_b16 v[136:137], v182 offset:2048
    ds_read_b64_tr_b16 v[138:139], v182 offset:2560
    v_add_f32 v215, v215, v231
    buffer_store_dwordx4 v[212:215], v254, s[28:31], 0 offen offset:544 sc1
L_padA0_2:
    s_cbranch_execz L_retA0
    v_add_f32 v216, v216, v232
    v_mfma_f32_32x32x16_bf16 v[80:95], v[128:131], a[196:199], v[80:95]
    ds_read_b64_tr_b16 v[140:141], v182 offset:2080
    ds_read_b64_tr_b16 v[142:143], v182 offset:2592
    v_add_f32 v217, v217, v233
    v_add_f32 v218, v218, v234
    v_add_f32 v219, v219, v235
    buffer_store_dwordx4 v[216:219], v254, s[28:31], 0 offen offset:1088 sc1
    s_add_u32 m0, s82, 86368
    v_mfma_f32_32x32x16_bf16 v[96:111], v[132:135], a[192:195], v[96:111]
    buffer_load_dwordx4 v190, s[16:19], s76 offen lds
    v_add_f32 v220, v220, v236
    v_add_f32 v221, v221, v237
    v_add_f32 v222, v222, v238
    v_add_f32 v223, v223, v239
    v_mfma_f32_32x32x16_bf16 v[112:127], v[132:135], a[196:199], v[112:127]
    v_mov_b32 v177, s46
    v_lshl_add_u32 v176, v177, 5, v176
    buffer_store_dwordx4 v[220:223], v254, s[28:31], 0 offen offset:1632 sc1
    v_mfma_f32_16x16x32_bf16 v[156:159], v[144:147], v[128:131], v[156:159]
    v_mfma_f32_16x16x32_bf16 v[156:159], v[148:151], v[132:135], v[156:159]
    s_waitcnt lgkmcnt(0)
    v_mfma_f32_32x32x16_bf16 v[64:79], v[136:139], a[200:203], v[64:79]
    ds_read_b64_tr_b16 v[128:129], v183 offset:0
    ds_read_b64_tr_b16 v[130:131], v183 offset:512
    v_mfma_f32_32x32x16_bf16 v[80:95], v[136:139], a[204:207], v[80:95]
    ds_read_b64_tr_b16 v[132:133], v183 offset:32
    ds_read_b64_tr_b16 v[134:135], v183 offset:544
    v_mfma_f32_32x32x16_bf16 v[96:111], v[140:143], a[200:203], v[96:111]
    s_add_u32 m0, s81, 90464
    s_lshl3_add_u32 s83, s60, s94
    buffer_load_dwordx4 v198, s[20:23], s83 offen lds
    buffer_load_dwordx4 v199, s[20:23], s83 offen offset:1024 lds
    v_mfma_f32_32x32x16_bf16 v[112:127], v[140:143], a[204:207], v[112:127]
    s_lshl_b32 s83, s3, 11
    s_xor_b32 s84, s83, 2048
    v_add_u32 v178, s83, v176
    v_add_u32 v179, s84, v176
    v_add_u32 v180, 65792, v178
    v_add_u32 v181, 65792, v179
    v_mfma_f32_16x16x32_bf16 v[156:159], v[144:147], v[136:139], v[156:159]
    v_mfma_f32_16x16x32_bf16 v[156:159], v[148:151], v[140:143], v[156:159]
    s_waitcnt lgkmcnt(0)
    v_mfma_f32_32x32x16_bf16 v[64:79], v[128:131], a[208:211], v[64:79]
    ds_read_b64_tr_b16 v[136:137], v183 offset:2048
    ds_read_b64_tr_b16 v[138:139], v183 offset:2560
    v_mfma_f32_32x32x16_bf16 v[80:95], v[128:131], a[212:215], v[80:95]
    ds_read_b64_tr_b16 v[140:141], v183 offset:2080
    ds_read_b64_tr_b16 v[142:143], v183 offset:2592
    v_mfma_f32_32x32x16_bf16 v[96:111], v[132:135], a[208:211], v[96:111]
    v_mfma_f32_32x32x16_bf16 v[112:127], v[132:135], a[212:215], v[112:127]
    s_waitcnt vmcnt(25) lgkmcnt(0)
    s_barrier
    v_mfma_f32_32x32x16_bf16 v[64:79], v[136:139], a[216:219], v[64:79]
    ds_read_b64_tr_b16 v[128:129], v184 offset:32896
    ds_read_b64_tr_b16 v[130:131], v184 offset:33408
    v_mfma_f32_32x32x16_bf16 v[80:95], v[136:139], a[220:223], v[80:95]
    ds_read_b64_tr_b16 v[132:133], v184 offset:32928
    ds_read_b64_tr_b16 v[134:135], v184 offset:33440
    v_mfma_f32_32x32x16_bf16 v[96:111], v[140:143], a[216:219], v[96:111]
    s_add_u32 m0, s81, 131584
    s_lshl3_add_u32 s83, s61, s94
    buffer_load_dwordx4 v198, s[20:23], s83 offen lds
    buffer_load_dwordx4 v199, s[20:23], s83 offen offset:1024 lds
    v_mfma_f32_32x32x16_bf16 v[112:127], v[140:143], a[220:223], v[112:127]
    s_lshl_b32 s83, s46, 8
    s_lshl_b32 s84, s45, 7
    s_add_u32 s83, s83, s84
    s_add_u32 s83, s83, 156416
    v_and_b32 v176, 31, v197
    v_lshl_add_u32 v191, v176, 2, s83
    v_lshrrev_b32 v176, 5, v197
    v_lshl_add_u32 v191, v176, 9, v191
    s_waitcnt lgkmcnt(0)
    v_mfma_f32_32x32x16_bf16 v[64:79], v[128:131], a[224:227], v[64:79]
    ds_read_b64_tr_b16 v[136:137], v184 offset:34944
    ds_read_b64_tr_b16 v[138:139], v184 offset:35456
    v_mfma_f32_32x32x16_bf16 v[80:95], v[128:131], a[228:231], v[80:95]
    ds_read_b64_tr_b16 v[140:141], v184 offset:34976
    ds_read_b64_tr_b16 v[142:143], v184 offset:35488
    v_mfma_f32_32x32x16_bf16 v[96:111], v[132:135], a[224:227], v[96:111]
    s_add_u32 m0, s82, 0
    v_mfma_f32_32x32x16_bf16 v[112:127], v[132:135], a[228:231], v[112:127]
    buffer_load_dwordx4 v190, s[12:15], s77 offen lds
    v_mfma_f32_16x16x32_bf16 v[156:159], v[144:147], v[128:131], v[156:159]
    v_mfma_f32_16x16x32_bf16 v[156:159], v[148:151], v[132:135], v[156:159]
    s_waitcnt lgkmcnt(0)
    v_mfma_f32_16x16x32_bf16 v[156:159], v[144:147], v[136:139], v[156:159]
    ds_read_b64_tr_b16 v[128:129], v185 offset:32896
    ds_read_b64_tr_b16 v[130:131], v185 offset:33408
    v_mfma_f32_16x16x32_bf16 v[156:159], v[148:151], v[140:143], v[156:159]
    ds_read_b64_tr_b16 v[132:133], v185 offset:32928
    ds_read_b64_tr_b16 v[134:135], v185 offset:33440
    s_add_u32 m0, s82, 4128
    v_mfma_f32_32x32x16_bf16 v[64:79], v[136:139], a[232:235], v[64:79]
    buffer_load_dwordx4 v190, s[16:19], s77 offen lds
    v_mfma_f32_32x32x16_bf16 v[80:95], v[136:139], a[236:239], v[80:95]
    s_add_u32 m0, s82, 8224
    v_mfma_f32_32x32x16_bf16 v[96:111], v[140:143], a[232:235], v[96:111]
    buffer_load_dwordx4 v190, s[12:15], s78 offen lds
    ds_write_b32 v191, v156 offset:1024
    s_add_u32 m0, s82, 12352
    v_mfma_f32_32x32x16_bf16 v[112:127], v[140:143], a[236:239], v[112:127]
    buffer_load_dwordx4 v190, s[16:19], s78 offen lds
    s_waitcnt lgkmcnt(1)
    v_mfma_f32_32x32x16_bf16 v[64:79], v[128:131], a[240:243], v[64:79]
    ds_read_b64_tr_b16 v[136:137], v185 offset:34944
    ds_read_b64_tr_b16 v[138:139], v185 offset:35456
    s_mul_i32 s83, s52, 294912
    s_mul_i32 s84, s44, 73728
    s_add_u32 s83, s83, s84
    v_lshl_add_u32 v186, v197, 4, s83
    v_mfma_f32_32x32x16_bf16 v[80:95], v[128:131], a[244:247], v[80:95]
    ds_read_b64_tr_b16 v[140:141], v185 offset:34976
    ds_read_b64_tr_b16 v[142:143], v185 offset:35488
    v_mfma_f32_32x32x16_bf16 v[96:111], v[132:135], a[240:243], v[96:111]
    s_lshl_b32 s83, s52, 2
    s_add_u32 s83, s83, s44
    s_lshl_b32 s83, s83, 8
    s_add_u32 s83, s83, 10747904
    v_and_b32 v176, 7, v197
    v_lshl_add_u32 v187, v176, 2, s83
    v_mfma_f32_32x32x16_bf16 v[112:127], v[132:135], a[244:247], v[112:127]
    s_add_u32 m0, s81, 115136
    s_lshl3_add_u32 s83, s62, s94
    buffer_load_dwordx4 v198, s[20:23], s83 offen lds
    buffer_load_dwordx4 v199, s[20:23], s83 offen offset:1024 lds
    s_waitcnt vmcnt(28) lgkmcnt(0)
    s_barrier
    v_mfma_f32_32x32x16_bf16 v[64:79], v[136:139], a[248:251], v[64:79]
    ds_read_b64_tr_b16 v[128:129], v178 offset:16448
    ds_read_b64_tr_b16 v[130:131], v178 offset:16704
    v_cmp_gt_u32 vcc, 4, v175
    s_nop 4
    s_cbranch_vccz L_ok1
    s_mov_b32 s85, 200000
L_re1:
    s_sleep 1
    buffer_load_dword v175, v174, s[36:39], 0 offen sc1
    s_waitcnt vmcnt(0)
    v_cmp_gt_u32 vcc, 4, v175
    s_sub_u32 s85, s85, 1
    s_cbranch_scc1 L_ok1
    s_nop 2
    s_cbranch_vccnz L_re1
L_ok1:
    v_mfma_f32_32x32x16_bf16 v[80:95], v[136:139], a[252:255], v[80:95]
    ds_read_b64_tr_b16 v[132:133], v178 offset:17472
    ds_read_b64_tr_b16 v[134:135], v178 offset:17728
    v_xor_b32 v176, 0x80, v191
    ds_read_b32 v176, v176 offset:1024
    v_mfma_f32_32x32x16_bf16 v[96:111], v[140:143], a[248:251], v[96:111]
L_padA1_8:
    s_cbranch_execz L_padA1_12
    s_add_u32 m0, s81, 139808
    s_lshl3_add_u32 s83, s63, s94
    buffer_load_dwordx4 v198, s[20:23], s83 offen lds
    buffer_load_dwordx4 v199, s[20:23], s83 offen offset:1024 lds
    s_add_u32 s94, s94, 131072
    v_mfma_f32_32x32x16_bf16 v[112:127], v[140:143], a[252:255], v[112:127]
    s_waitcnt lgkmcnt(0)
    v_add_f32 v176, v176, v156
    v_cvt_pk_bf16_f32 v168, v176, v176
    v_lshlrev_b32 v169, 16, v168
    v_sub_f32 v176, v176, v169
    v_cvt_pk_bf16_f32 v169, v176, 0
    v_mfma_f32_32x32x16_bf16 v[0:15], v[128:131], a[0:3], 0
    s_add_u32 m0, s82, 98688
    ds_read_b64_tr_b16 v[136:137], v179 offset:16448
    buffer_load_dwordx4 v190, s[12:15], s79 offen lds
    v_mfma_f32_32x32x16_bf16 v[64:79], v[168:171], v[160:163], v[64:79]
    buffer_load_dword v188, v187, s[28:31], 0 offen sc1
    v_mfma_f32_32x32x16_bf16 v[48:63], v[128:131], a[4:7], 0
    ds_read_b64_tr_b16 v[138:139], v179 offset:16704
    v_mfma_f32_32x32x16_bf16 v[80:95], v[168:171], v[164:167], v[80:95]
    v_mfma_f32_16x16x32_bf16 v[156:159], v[144:147], v[128:131], 0
    v_mfma_f32_32x32x16_bf16 v[0:15], v[132:135], a[8:11], v[0:15]
    s_add_u32 m0, s82, 102816
    ds_read_b64_tr_b16 v[140:141], v179 offset:17472
    buffer_load_dwordx4 v190, s[16:19], s79 offen lds
    v_mfma_f32_32x32x16_bf16 v[96:111], v[168:171], v[162:165], v[96:111]
    v_mfma_f32_32x32x16_bf16 v[48:63], v[132:135], a[12:15], v[48:63]
    ds_read_b64_tr_b16 v[142:143], v179 offset:17728
    s_add_u32 m0, s81, 106912
    s_lshl3_add_u32 s83, s56, s94
    buffer_load_dwordx4 v198, s[20:23], s83 offen lds
    buffer_load_dwordx4 v199, s[20:23], s83 offen offset:1024 lds
    v_mfma_f32_16x16x32_bf16 v[156:159], v[144:147], v[132:135], v[156:159]
    v_mfma_f32_32x32x16_bf16 v[112:127], v[168:171], v[166:169], v[112:127]
    s_waitcnt vmcnt(31)
    s_barrier
    s_waitcnt lgkmcnt(2)
    v_mfma_f32_32x32x16_bf16 v[0:15], v[136:139], a[16:19], v[0:15]
    ds_read_b64_tr_b16 v[128:129], v178 offset:32896
    s_add_u32 m0, s81, 148032
    s_lshl3_add_u32 s83, s57, s94
    buffer_load_dwordx4 v198, s[20:23], s83 offen lds
    buffer_load_dwordx4 v199, s[20:23], s83 offen offset:1024 lds
    v_mfma_f32_32x32x16_bf16 v[48:63], v[136:139], a[20:23], v[48:63]
    ds_read_b64_tr_b16 v[130:131], v178 offset:33152
    v_mul_f32 v64, v194, v64
    v_mul_f32 v65, v194, v65
    v_mul_f32 v64, v64, v72
    v_mul_f32 v65, v65, v73
    s_waitcnt lgkmcnt(2)
    v_mfma_f32_32x32x16_bf16 v[0:15], v[140:143], a[24:27], v[0:15]
    ds_read_b64_tr_b16 v[132:133], v178 offset:33920
    v_cvt_pk_bf16_f32 v64, v64, v65
    v_mul_f32 v66, v194, v66
    v_mul_f32 v67, v194, v67
    v_mul_f32 v66, v66, v74
    v_mul_f32 v67, v67, v75
    v_cvt_pk_bf16_f32 v65, v66, v67
    v_mfma_f32_32x32x16_bf16 v[48:63], v[140:143], a[28:31], v[48:63]
    ds_read_b64_tr_b16 v[134:135], v178 offset:34176
    v_mul_f32 v68, v194, v68
    v_mul_f32 v69, v194, v69
    v_mul_f32 v68, v68, v76
    v_mul_f32 v69, v69, v77
    v_cvt_pk_bf16_f32 v66, v68, v69
    v_mul_f32 v70, v194, v70
    s_waitcnt lgkmcnt(2)
    v_mfma_f32_32x32x16_bf16 v[0:15], v[128:131], a[32:35], v[0:15]
    ds_read_b64_tr_b16 v[136:137], v179 offset:32896
    s_add_u32 m0, s81, 123360
    s_lshl3_add_u32 s83, s58, s94
    buffer_load_dwordx4 v198, s[20:23], s83 offen lds
    buffer_load_dwordx4 v199, s[20:23], s83 offen offset:1024 lds
    v_mul_f32 v71, v194, v71
    v_mul_f32 v70, v70, v78
    v_mfma_f32_32x32x16_bf16 v[48:63], v[128:131], a[36:39], v[48:63]
    ds_read_b64_tr_b16 v[138:139], v179 offset:33152
    v_mul_f32 v71, v71, v79
    v_cvt_pk_bf16_f32 v67, v70, v71
    s_mov_b32 s84, 32768
    buffer_store_dwordx4 v[64:67], v196, s[28:31], s84 offen offset:0 sc1
    v_mul_f32 v80, v195, v80
    v_mul_f32 v81, v195, v81
    v_mfma_f32_16x16x32_bf16 v[156:159], v[144:147], v[128:131], v[156:159]
    v_mul_f32 v80, v80, v88
    v_mul_f32 v81, v81, v89
    s_waitcnt lgkmcnt(2)
    v_mfma_f32_32x32x16_bf16 v[0:15], v[132:135], a[40:43], v[0:15]
    ds_read_b64_tr_b16 v[140:141], v179 offset:33920
    v_cvt_pk_bf16_f32 v80, v80, v81
    v_mul_f32 v82, v195, v82
    v_mul_f32 v83, v195, v83
    v_mul_f32 v82, v82, v90
    v_mul_f32 v83, v83, v91
    v_cvt_pk_bf16_f32 v81, v82, v83
    v_mfma_f32_32x32x16_bf16 v[48:63], v[132:135], a[44:47], v[48:63]
    ds_read_b64_tr_b16 v[142:143], v179 offset:34176
    v_mul_f32 v84, v195, v84
    v_mul_f32 v85, v195, v85
    v_mul_f32 v84, v84, v92
    v_mul_f32 v85, v85, v93
    v_cvt_pk_bf16_f32 v82, v84, v85
    v_mul_f32 v86, v195, v86
    v_mfma_f32_16x16x32_bf16 v[156:159], v[144:147], v[132:135], v[156:159]
    v_mul_f32 v87, v195, v87
    v_mul_f32 v86, v86, v94
    v_mul_f32 v87, v87, v95
    s_waitcnt vmcnt(32)
    s_barrier
    s_waitcnt lgkmcnt(2)
    v_mfma_f32_32x32x16_bf16 v[0:15], v[136:139], a[48:51], v[0:15]
    ds_read_b64_tr_b16 v[128:129], v180 offset:0
    s_add_u32 m0, s81, 16448
    s_lshl3_add_u32 s83, s59, s94
    buffer_load_dwordx4 v198, s[20:23], s83 offen lds
    buffer_load_dwordx4 v199, s[20:23], s83 offen offset:1024 lds
    v_cvt_pk_bf16_f32 v83, v86, v87
    v_cndmask_b32 v189, 0, 1, s[92:93]
    s_waitcnt vmcnt(10)
    v_cmp_gt_u32 vcc, v189, v188
    s_nop 4
    s_cbranch_vccz L_ok2
    s_mov_b32 s85, 200000
L_re2:
    s_sleep 1
    buffer_load_dword v188, v187, s[28:31], 0 offen sc1
    s_waitcnt vmcnt(0)
    v_cmp_gt_u32 vcc, v189, v188
    s_sub_u32 s85, s85, 1
    s_cbranch_scc1 L_ok2
    s_nop 2
    s_cbranch_vccnz L_re2
L_ok2:
    s_add_u32 s84, s56, 0
    buffer_load_dwordx4 a[0:3], v186, s[28:31], s84 offen sc1
    buffer_load_dwordx4 a[4:7], v186, s[28:31], s84 offen offset:1024 sc1
    v_mfma_f32_32x32x16_bf16 v[48:63], v[136:139], a[52:55], v[48:63]
    ds_read_b64_tr_b16 v[130:131], v180 offset:256
    s_mov_b32 s84, 32768
    buffer_store_dwordx4 v[80:83], v196, s[28:31], s84 offen offset:1024 sc1
    v_mul_f32 v96, v194, v96
    v_mul_f32 v97, v194, v97
    v_mul_f32 v96, v96, v104
    v_mul_f32 v97, v97, v105
    s_waitcnt lgkmcnt(2)
    v_mfma_f32_32x32x16_bf16 v[0:15], v[140:143], a[56:59], v[0:15]
    ds_read_b64_tr_b16 v[132:133], v180 offset:1024
    v_cvt_pk_bf16_f32 v96, v96, v97
    v_mul_f32 v98, v194, v98
    v_mul_f32 v99, v194, v99
    v_mul_f32 v98, v98, v106
    v_mul_f32 v99, v99, v107
    v_cvt_pk_bf16_f32 v97, v98, v99
    v_mfma_f32_32x32x16_bf16 v[48:63], v[140:143], a[60:63], v[48:63]
    ds_read_b64_tr_b16 v[134:135], v180 offset:1280
    v_mul_f32 v100, v194, v100
    v_mul_f32 v101, v194, v101
    v_mul_f32 v100, v100, v108
    v_mul_f32 v101, v101, v109
    v_cvt_pk_bf16_f32 v98, v100, v101
    v_mul_f32 v102, v194, v102
    s_waitcnt lgkmcnt(2)
    v_mfma_f32_32x32x16_bf16 v[0:15], v[128:131], a[64:67], v[0:15]
    ds_read_b64_tr_b16 v[136:137], v181 offset:0
    v_mul_f32 v103, v194, v103
    v_mul_f32 v102, v102, v110
    v_mul_f32 v103, v103, v111
    v_cvt_pk_bf16_f32 v99, v102, v103
    s_mov_b32 s84, 32768
L_padA1_9:
    s_cbranch_execz L_padA1_13
    buffer_store_dwordx4 v[96:99], v196, s[28:31], s84 offen offset:2048 sc1
    v_mfma_f32_32x32x16_bf16 v[48:63], v[128:131], a[68:71], v[48:63]
    ds_read_b64_tr_b16 v[138:139], v181 offset:256
    v_mul_f32 v112, v195, v112
    v_mul_f32 v113, v195, v113
    v_mul_f32 v112, v112, v120
    v_mul_f32 v113, v113, v121
    v_cvt_pk_bf16_f32 v112, v112, v113
    s_add_u32 s84, s57, 0
    buffer_load_dwordx4 a[8:11], v186, s[28:31], s84 offen sc1
    buffer_load_dwordx4 a[12:15], v186, s[28:31], s84 offen offset:1024 sc1
    v_mfma_f32_16x16x32_bf16 v[156:159], v[144:147], v[128:131], v[156:159]
    v_mul_f32 v114, v195, v114
    v_mul_f32 v115, v195, v115
    v_mul_f32 v114, v114, v122
    s_waitcnt lgkmcnt(2)
    v_mfma_f32_32x32x16_bf16 v[0:15], v[132:135], a[72:75], v[0:15]
    ds_read_b64_tr_b16 v[140:141], v181 offset:1024
    v_mul_f32 v115, v115, v123
    v_cvt_pk_bf16_f32 v113, v114, v115
    v_mul_f32 v116, v195, v116
    v_mul_f32 v117, v195, v117
    v_mul_f32 v116, v116, v124
    v_mul_f32 v117, v117, v125
    v_mfma_f32_32x32x16_bf16 v[48:63], v[132:135], a[76:79], v[48:63]
    ds_read_b64_tr_b16 v[142:143], v181 offset:1280
    v_cvt_pk_bf16_f32 v114, v116, v117
    v_mul_f32 v118, v195, v118
    v_mul_f32 v119, v195, v119
    v_mul_f32 v118, v118, v126
    v_mul_f32 v119, v119, v127
    v_cvt_pk_bf16_f32 v115, v118, v119
    v_mfma_f32_16x16x32_bf16 v[156:159], v[144:147], v[132:135], v[156:159]
    s_mov_b32 s84, 32768
    buffer_store_dwordx4 v[112:115], v196, s[28:31], s84 offen offset:3072 sc1
    s_barrier
    s_waitcnt lgkmcnt(2)
    v_mfma_f32_32x32x16_bf16 v[0:15], v[136:139], a[80:83], v[0:15]
    ds_read_b64_tr_b16 v[128:129], v178 offset:49344
    s_add_u32 m0, s81, 32896
    s_lshl3_add_u32 s83, s60, s94
    buffer_load_dwordx4 v198, s[20:23], s83 offen lds
    buffer_load_dwordx4 v199, s[20:23], s83 offen offset:1024 lds
    s_add_u32 s84, s58, 0
    buffer_load_dwordx4 a[16:19], v186, s[28:31], s84 offen sc1
    buffer_load_dwordx4 a[20:23], v186, s[28:31], s84 offen offset:1024 sc1
    v_mfma_f32_32x32x16_bf16 v[48:63], v[136:139], a[84:87], v[48:63]
    ds_read_b64_tr_b16 v[130:131], v178 offset:49600
    s_waitcnt lgkmcnt(2)
    v_mfma_f32_32x32x16_bf16 v[0:15], v[140:143], a[88:91], v[0:15]
    ds_read_b64_tr_b16 v[132:133], v178 offset:50368
    v_mfma_f32_32x32x16_bf16 v[48:63], v[140:143], a[92:95], v[48:63]
    ds_read_b64_tr_b16 v[134:135], v178 offset:50624
    s_waitcnt lgkmcnt(2)
    v_mfma_f32_32x32x16_bf16 v[0:15], v[128:131], a[96:99], v[0:15]
    ds_read_b64_tr_b16 v[136:137], v179 offset:49344
    v_lshrrev_b32 v183, 5, v197
    v_mfma_f32_32x32x16_bf16 v[48:63], v[128:131], a[100:103], v[48:63]
    ds_read_b64_tr_b16 v[138:139], v179 offset:49600
    v_lshlrev_b32 v183, 9, v183
    s_add_u32 s84, s59, 0
    buffer_load_dwordx4 a[24:27], v186, s[28:31], s84 offen sc1
    buffer_load_dwordx4 a[28:31], v186, s[28:31], s84 offen offset:1024 sc1
    v_mfma_f32_16x16x32_bf16 v[156:159], v[144:147], v[128:131], v[156:159]
    s_waitcnt lgkmcnt(2)
    v_mfma_f32_32x32x16_bf16 v[0:15], v[132:135], a[104:107], v[0:15]
    ds_read_b64_tr_b16 v[140:141], v179 offset:50368
    v_mfma_f32_32x32x16_bf16 v[48:63], v[132:135], a[108:111], v[48:63]
    ds_read_b64_tr_b16 v[142:143], v179 offset:50624
    v_bfe_u32 v184, v197, 2, 2
    v_mfma_f32_16x16x32_bf16 v[156:159], v[144:147], v[132:135], v[156:159]
    s_barrier
    s_waitcnt lgkmcnt(2)
    v_mfma_f32_32x32x16_bf16 v[0:15], v[136:139], a[112:115], v[0:15]
    ds_read_b64_tr_b16 v[128:129], v180 offset:16448
    s_add_u32 m0, s81, 65792
    s_lshl3_add_u32 s83, s61, s94
    buffer_load_dwordx4 v198, s[20:23], s83 offen lds
    buffer_load_dwordx4 v199, s[20:23], s83 offen offset:1024 lds
    s_add_u32 s84, s60, 0
    buffer_load_dwordx4 a[32:35], v186, s[28:31], s84 offen sc1
    buffer_load_dwordx4 a[36:39], v186, s[28:31], s84 offen offset:1024 sc1
    v_mfma_f32_32x32x16_bf16 v[48:63], v[136:139], a[116:119], v[48:63]
    ds_read_b64_tr_b16 v[130:131], v180 offset:16704
    v_lshl_add_u32 v183, v184, 7, v183
    s_waitcnt lgkmcnt(2)
    v_mfma_f32_32x32x16_bf16 v[0:15], v[140:143], a[120:123], v[0:15]
    ds_read_b64_tr_b16 v[132:133], v180 offset:17472
    v_mfma_f32_32x32x16_bf16 v[48:63], v[140:143], a[124:127], v[48:63]
    ds_read_b64_tr_b16 v[134:135], v180 offset:17728
    v_and_b32 v184, 3, v197
    s_waitcnt lgkmcnt(2)
    v_mfma_f32_32x32x16_bf16 v[0:15], v[128:131], a[128:131], v[0:15]
    ds_read_b64_tr_b16 v[136:137], v181 offset:16448
    v_lshl_add_u32 v183, v184, 3, v183
    v_mfma_f32_32x32x16_bf16 v[48:63], v[128:131], a[132:135], v[48:63]
    ds_read_b64_tr_b16 v[138:139], v181 offset:16704
    s_add_u32 s84, s61, 0
    buffer_load_dwordx4 a[40:43], v186, s[28:31], s84 offen sc1
    buffer_load_dwordx4 a[44:47], v186, s[28:31], s84 offen offset:1024 sc1
    v_mfma_f32_16x16x32_bf16 v[156:159], v[144:147], v[128:131], v[156:159]
    s_waitcnt lgkmcnt(2)
    v_mfma_f32_32x32x16_bf16 v[0:15], v[132:135], a[136:139], v[0:15]
    ds_read_b64_tr_b16 v[140:141], v181 offset:17472
    v_bfe_u32 v184, v197, 3, 1
    v_mfma_f32_32x32x16_bf16 v[48:63], v[132:135], a[140:143], v[48:63]
    ds_read_b64_tr_b16 v[142:143], v181 offset:17728
    v_lshl_add_u32 v183, v184, 6, v183
    v_mfma_f32_16x16x32_bf16 v[156:159], v[144:147], v[132:135], v[156:159]
    s_barrier
    s_waitcnt lgkmcnt(2)
    v_mfma_f32_32x32x16_bf16 v[0:15], v[136:139], a[144:147], v[0:15]
    ds_read_b64_tr_b16 v[128:129], v178 offset:0
    s_add_u32 m0, s81, 49344
    s_lshl3_add_u32 s83, s62, s94
    buffer_load_dwordx4 v198, s[20:23], s83 offen lds
    buffer_load_dwordx4 v199, s[20:23], s83 offen offset:1024 lds
    s_add_u32 s84, s62, 0
    buffer_load_dwordx4 a[48:51], v186, s[28:31], s84 offen sc1
    buffer_load_dwordx4 a[52:55], v186, s[28:31], s84 offen offset:1024 sc1
    v_mfma_f32_32x32x16_bf16 v[48:63], v[136:139], a[148:151], v[48:63]
    ds_read_b64_tr_b16 v[130:131], v178 offset:256
    s_waitcnt lgkmcnt(2)
    v_mfma_f32_32x32x16_bf16 v[0:15], v[140:143], a[152:155], v[0:15]
    ds_read_b64_tr_b16 v[132:133], v178 offset:1024
    v_bfe_u32 v184, v197, 4, 1
    v_mfma_f32_32x32x16_bf16 v[48:63], v[140:143], a[156:159], v[48:63]
    ds_read_b64_tr_b16 v[134:135], v178 offset:1280
    v_lshl_add_u32 v183, v184, 5, v183
    s_waitcnt lgkmcnt(2)
    v_mfma_f32_32x32x16_bf16 v[0:15], v[128:131], a[160:163], v[0:15]
    ds_read_b64_tr_b16 v[136:137], v179 offset:0
    v_mfma_f32_32x32x16_bf16 v[48:63], v[128:131], a[164:167], v[48:63]
    ds_read_b64_tr_b16 v[138:139], v179 offset:256
    v_xor_b32 v184, 64, v183
    s_add_u32 s84, s63, 0
    buffer_load_dwordx4 a[56:59], v186, s[28:31], s84 offen sc1
    buffer_load_dwordx4 a[60:63], v186, s[28:31], s84 offen offset:1024 sc1
    v_mfma_f32_16x16x32_bf16 v[156:159], v[144:147], v[128:131], v[156:159]
    s_waitcnt lgkmcnt(2)
    v_mfma_f32_32x32x16_bf16 v[0:15], v[132:135], a[168:171], v[0:15]
    ds_read_b64_tr_b16 v[140:141], v179 offset:1024
    v_add_u32 v174, s81, v183
    v_mfma_f32_32x32x16_bf16 v[48:63], v[132:135], a[172:175], v[48:63]
    ds_read_b64_tr_b16 v[142:143], v179 offset:1280
    v_mfma_f32_16x16x32_bf16 v[156:159], v[144:147], v[132:135], v[156:159]
    s_barrier
    s_waitcnt lgkmcnt(2)
    v_mfma_f32_32x32x16_bf16 v[0:15], v[136:139], a[176:179], v[0:15]
    ds_read_b64_tr_b16 v[128:129], v178 offset:8224
    s_add_u32 m0, s81, 82240
    s_lshl3_add_u32 s83, s63, s94
L_padA1_10:
    s_cbranch_execz L_retA1
    buffer_load_dwordx4 v198, s[20:23], s83 offen lds
    buffer_load_dwordx4 v199, s[20:23], s83 offen offset:1024 lds
    s_add_u32 s94, s94, 131072
    v_mfma_f32_32x32x16_bf16 v[48:63], v[136:139], a[180:183], v[48:63]
    ds_read_b64_tr_b16 v[130:131], v178 offset:8480
    v_add_u32 v175, s81, v184
    s_waitcnt lgkmcnt(2)
    v_mfma_f32_32x32x16_bf16 v[0:15], v[140:143], a[184:187], v[0:15]
    ds_read_b64_tr_b16 v[132:133], v178 offset:9248
    v_add_u32 v176, 65792, v174
    v_mfma_f32_32x32x16_bf16 v[48:63], v[140:143], a[188:191], v[48:63]
    ds_read_b64_tr_b16 v[134:135], v178 offset:9504
    s_waitcnt lgkmcnt(2)
    v_mfma_f32_32x32x16_bf16 v[0:15], v[128:131], a[192:195], v[0:15]
    ds_read_b64_tr_b16 v[136:137], v179 offset:8224
    v_add_u32 v177, 65792, v175
    v_mfma_f32_32x32x16_bf16 v[48:63], v[128:131], a[196:199], v[48:63]
    ds_read_b64_tr_b16 v[138:139], v179 offset:8480
    v_mfma_f32_16x16x32_bf16 v[156:159], v[144:147], v[128:131], v[156:159]
    s_waitcnt lgkmcnt(2)
    v_mfma_f32_32x32x16_bf16 v[0:15], v[132:135], a[200:203], v[0:15]
    ds_read_b64_tr_b16 v[140:141], v179 offset:9248
    v_mfma_f32_32x32x16_bf16 v[48:63], v[132:135], a[204:207], v[48:63]
    ds_read_b64_tr_b16 v[142:143], v179 offset:9504
    s_waitcnt vmcnt(20)
    v_mov_b32 v185, 1
    buffer_store_dword v185, v252, s[28:31], 0 offen sc1
    v_mfma_f32_16x16x32_bf16 v[156:159], v[144:147], v[132:135], v[156:159]
    s_barrier
    s_waitcnt lgkmcnt(2)
    v_mfma_f32_32x32x16_bf16 v[0:15], v[136:139], a[208:211], v[0:15]
    ds_read_b64_tr_b16 v[128:129], v180 offset:32896
    v_mfma_f32_32x32x16_bf16 v[48:63], v[136:139], a[212:215], v[48:63]
    ds_read_b64_tr_b16 v[130:131], v180 offset:33152
    s_waitcnt lgkmcnt(2)
    v_mfma_f32_32x32x16_bf16 v[0:15], v[140:143], a[216:219], v[0:15]
    ds_read_b64_tr_b16 v[132:133], v180 offset:33920
    v_mfma_f32_32x32x16_bf16 v[48:63], v[140:143], a[220:223], v[48:63]
    ds_read_b64_tr_b16 v[134:135], v180 offset:34176
    s_waitcnt lgkmcnt(2)
    v_mfma_f32_32x32x16_bf16 v[0:15], v[128:131], a[224:227], v[0:15]
    ds_read_b64_tr_b16 v[136:137], v181 offset:32896
    v_mfma_f32_32x32x16_bf16 v[48:63], v[128:131], a[228:231], v[48:63]
    ds_read_b64_tr_b16 v[138:139], v181 offset:33152
    v_mfma_f32_16x16x32_bf16 v[156:159], v[144:147], v[128:131], v[156:159]
    s_waitcnt lgkmcnt(2)
    v_mfma_f32_32x32x16_bf16 v[0:15], v[132:135], a[232:235], v[0:15]
    ds_read_b64_tr_b16 v[140:141], v181 offset:33920
    v_mfma_f32_32x32x16_bf16 v[48:63], v[132:135], a[236:239], v[48:63]
    ds_read_b64_tr_b16 v[142:143], v181 offset:34176
    v_mfma_f32_16x16x32_bf16 v[156:159], v[144:147], v[132:135], v[156:159]
    buffer_load_dword v182, v187, s[28:31], 0 offen sc1
    s_waitcnt lgkmcnt(2)
    v_mfma_f32_32x32x16_bf16 v[0:15], v[136:139], a[240:243], v[0:15]
    s_add_u32 m0, s81, 0
    s_lshl3_add_u32 s83, s56, s94
    buffer_load_dwordx4 v198, s[20:23], s83 offen lds
    buffer_load_dwordx4 v199, s[20:23], s83 offen offset:1024 lds
    v_mfma_f32_32x32x16_bf16 v[48:63], v[136:139], a[244:247], v[48:63]
    ds_write_b32 v191, v156 offset:2048
    v_add_u32 v178, 131584, v174
    v_add_u32 v179, 131584, v175
    s_waitcnt lgkmcnt(0)
    s_barrier
    v_mfma_f32_32x32x16_bf16 v[0:15], v[140:143], a[248:251], v[0:15]
    ds_read_b64_tr_b16 v[128:129], v174 offset:24672
    ds_read_b64_tr_b16 v[130:131], v174 offset:25696
    v_xor_b32 v183, 0x80, v191
    ds_read_b32 v183, v183 offset:2048
    v_mfma_f32_32x32x16_bf16 v[48:63], v[140:143], a[252:255], v[48:63]
    ds_read_b64_tr_b16 v[132:133], v175 offset:24672
    ds_read_b64_tr_b16 v[134:135], v175 offset:25696
    s_waitcnt lgkmcnt(2)
    v_add_f32 v183, v183, v156
    v_cvt_pk_bf16_f32 v168, v183, v183
    v_lshlrev_b32 v169, 16, v168
    v_sub_f32 v183, v183, v169
    v_cvt_pk_bf16_f32 v169, v183, 0
    v_mfma_f32_32x32x16_bf16 v[16:31], v[128:131], a[0:3], 0
    s_add_u32 m0, s81, 8224
    s_lshl3_add_u32 s83, s57, s94
    buffer_load_dwordx4 v198, s[20:23], s83 offen lds
    buffer_load_dwordx4 v199, s[20:23], s83 offen offset:1024 lds
    ds_read_b64_tr_b16 v[136:137], v174 offset:41120
    v_mfma_f32_32x32x16_bf16 v[0:15], v[168:171], v[160:163], v[0:15]
    v_mfma_f32_32x32x16_bf16 v[48:63], v[168:171], v[164:167], v[48:63]
    v_mfma_f32_32x32x16_bf16 v[32:47], v[128:131], a[4:7], 0
    s_add_u32 m0, s81, 98688
    s_lshl3_add_u32 s83, s58, s94
    buffer_load_dwordx4 v198, s[20:23], s83 offen lds
    buffer_load_dwordx4 v199, s[20:23], s83 offen offset:1024 lds
    ds_read_b64_tr_b16 v[138:139], v174 offset:42144
    s_waitcnt lgkmcnt(2)
    v_mfma_f32_32x32x16_bf16 v[208:223], v[132:135], a[0:3], 0
    ds_read_b64_tr_b16 v[140:141], v175 offset:41120
    s_add_u32 m0, s81, 24672
    s_lshl3_add_u32 s83, s59, s94
    buffer_load_dwordx4 v198, s[20:23], s83 offen lds
    buffer_load_dwordx4 v199, s[20:23], s83 offen offset:1024 lds
    v_mul_f32 v0, v194, v0
    v_mul_f32 v1, v194, v1
    v_mul_f32 v0, v0, v8
    v_mul_f32 v1, v1, v9
    v_cvt_pk_bf16_f32 v0, v0, v1
    v_mul_f32 v2, v194, v2
    v_mul_f32 v3, v194, v3
    v_mul_f32 v2, v2, v10
    v_mul_f32 v3, v3, v11
    v_cvt_pk_bf16_f32 v1, v2, v3
    v_mul_f32 v4, v194, v4
    v_mul_f32 v5, v194, v5
    v_mfma_f32_32x32x16_bf16 v[224:239], v[132:135], a[4:7], 0
    ds_read_b64_tr_b16 v[142:143], v175 offset:42144
    v_mul_f32 v4, v4, v12
    v_mul_f32 v5, v5, v13
    v_cvt_pk_bf16_f32 v2, v4, v5
    v_mul_f32 v6, v194, v6
    v_mul_f32 v7, v194, v7
    v_mul_f32 v6, v6, v14
    v_mul_f32 v7, v7, v15
    v_cvt_pk_bf16_f32 v3, v6, v7
    s_mov_b32 s84, s97
    buffer_store_dwordx4 v[0:3], v196, s[28:31], s84 offen offset:0 sc1
    v_mul_f32 v48, v195, v48
    v_mul_f32 v49, v195, v49
    v_mul_f32 v48, v48, v56
    v_mul_f32 v49, v49, v57
    v_cvt_pk_bf16_f32 v48, v48, v49
    v_mul_f32 v50, v195, v50
    s_waitcnt lgkmcnt(2)
    v_mfma_f32_32x32x16_bf16 v[16:31], v[136:139], a[8:11], v[16:31]
    ds_read_b64_tr_b16 v[128:129], v176 offset:8224
    v_mul_f32 v51, v195, v51
    v_mul_f32 v50, v50, v58
    v_mul_f32 v51, v51, v59
    v_cvt_pk_bf16_f32 v49, v50, v51
    v_mul_f32 v52, v195, v52
    v_mul_f32 v53, v195, v53
    v_mul_f32 v52, v52, v60
    v_mul_f32 v53, v53, v61
    v_cvt_pk_bf16_f32 v50, v52, v53
    v_mul_f32 v54, v195, v54
    v_mul_f32 v55, v195, v55
    v_mul_f32 v54, v54, v62
    v_mul_f32 v55, v55, v63
    v_cvt_pk_bf16_f32 v51, v54, v55
    s_mov_b32 s84, s97
    buffer_store_dwordx4 v[48:51], v196, s[28:31], s84 offen offset:1024 sc1
    v_mfma_f32_32x32x16_bf16 v[32:47], v[136:139], a[12:15], v[32:47]
    ds_read_b64_tr_b16 v[130:131], v176 offset:9248
    s_waitcnt lgkmcnt(2)
    v_mfma_f32_32x32x16_bf16 v[208:223], v[140:143], a[8:11], v[208:223]
    ds_read_b64_tr_b16 v[132:133], v177 offset:8224
    s_add_u32 m0, s81, 41120
    s_lshl3_add_u32 s83, s60, s94
    buffer_load_dwordx4 v198, s[20:23], s83 offen lds
    buffer_load_dwordx4 v199, s[20:23], s83 offen offset:1024 lds
    v_mfma_f32_32x32x16_bf16 v[224:239], v[140:143], a[12:15], v[224:239]
L_padA0_3:
    s_cbranch_execz L_retA0
    ds_read_b64_tr_b16 v[134:135], v177 offset:9248
    s_waitcnt vmcnt(31) lgkmcnt(2)
    v_mfma_f32_32x32x16_bf16 v[16:31], v[128:131], a[16:19], v[16:31]
    ds_read_b64_tr_b16 v[136:137], v174 offset:57568
    s_waitcnt vmcnt(30)
    v_mfma_f32_32x32x16_bf16 v[32:47], v[128:131], a[20:23], v[32:47]
    ds_read_b64_tr_b16 v[138:139], v174 offset:58592
    v_cndmask_b32 v189, 0, 2, s[92:93]
    s_waitcnt vmcnt(12)
    v_cmp_gt_u32 vcc, v189, v182
    s_nop 4
    s_cbranch_vccz L_ok3
    s_mov_b32 s85, 200000
L_re3:
    s_sleep 1
    buffer_load_dword v182, v187, s[28:31], 0 offen sc1
    s_waitcnt vmcnt(0)
    v_cmp_gt_u32 vcc, v189, v182
    s_sub_u32 s85, s85, 1
    s_cbranch_scc1 L_ok3
    s_nop 2
    s_cbranch_vccnz L_re3
L_ok3:
    s_add_u32 s84, s56, 16384
    buffer_load_dwordx4 a[64:67], v186, s[28:31], s84 offen sc1
    buffer_load_dwordx4 a[68:71], v186, s[28:31], s84 offen offset:1024 sc1
    s_waitcnt lgkmcnt(2)
    v_mfma_f32_32x32x16_bf16 v[208:223], v[132:135], a[16:19], v[208:223]
    ds_read_b64_tr_b16 v[140:141], v175 offset:57568
    v_mfma_f32_32x32x16_bf16 v[224:239], v[132:135], a[20:23], v[224:239]
    ds_read_b64_tr_b16 v[142:143], v175 offset:58592
    s_waitcnt lgkmcnt(2)
    v_mfma_f32_32x32x16_bf16 v[16:31], v[136:139], a[24:27], v[16:31]
    ds_read_b64_tr_b16 v[128:129], v176 offset:24672
    v_mfma_f32_32x32x16_bf16 v[32:47], v[136:139], a[28:31], v[32:47]
    ds_read_b64_tr_b16 v[130:131], v176 offset:25696
    s_add_u32 s84, s57, 16384
    buffer_load_dwordx4 a[72:75], v186, s[28:31], s84 offen sc1
    buffer_load_dwordx4 a[76:79], v186, s[28:31], s84 offen offset:1024 sc1
    s_waitcnt lgkmcnt(2)
    v_mfma_f32_32x32x16_bf16 v[208:223], v[140:143], a[24:27], v[208:223]
    ds_read_b64_tr_b16 v[132:133], v177 offset:24672
    s_add_u32 m0, s81, 57568
    s_lshl3_add_u32 s83, s61, s94
    buffer_load_dwordx4 v198, s[20:23], s83 offen lds
    buffer_load_dwordx4 v199, s[20:23], s83 offen offset:1024 lds
    v_mfma_f32_32x32x16_bf16 v[224:239], v[140:143], a[28:31], v[224:239]
    ds_read_b64_tr_b16 v[134:135], v177 offset:25696
    s_waitcnt lgkmcnt(2)
    v_mfma_f32_32x32x16_bf16 v[16:31], v[128:131], a[32:35], v[16:31]
    ds_read_b64_tr_b16 v[136:137], v178 offset:0
    v_mfma_f32_32x32x16_bf16 v[32:47], v[128:131], a[36:39], v[32:47]
    ds_read_b64_tr_b16 v[138:139], v178 offset:1024
    s_add_u32 s84, s58, 16384
    buffer_load_dwordx4 a[80:83], v186, s[28:31], s84 offen sc1
    buffer_load_dwordx4 a[84:87], v186, s[28:31], s84 offen offset:1024 sc1
    s_waitcnt lgkmcnt(2)
    v_mfma_f32_32x32x16_bf16 v[208:223], v[132:135], a[32:35], v[208:223]
    ds_read_b64_tr_b16 v[140:141], v179 offset:0
    v_mfma_f32_32x32x16_bf16 v[224:239], v[132:135], a[36:39], v[224:239]
    ds_read_b64_tr_b16 v[142:143], v179 offset:1024
    s_waitcnt lgkmcnt(2)
    v_mfma_f32_32x32x16_bf16 v[16:31], v[136:139], a[40:43], v[16:31]
    ds_read_b64_tr_b16 v[128:129], v176 offset:49344
    s_waitcnt vmcnt(10)
    v_mov_b32 v152, 2
    buffer_store_dword v152, v252, s[28:31], 0 offen sc1
    v_mfma_f32_32x32x16_bf16 v[32:47], v[136:139], a[44:47], v[32:47]
    ds_read_b64_tr_b16 v[130:131], v176 offset:50368
    s_add_u32 s84, s59, 16384
    buffer_load_dwordx4 a[88:91], v186, s[28:31], s84 offen sc1
    buffer_load_dwordx4 a[92:95], v186, s[28:31], s84 offen offset:1024 sc1
    s_waitcnt lgkmcnt(2)
    v_mfma_f32_32x32x16_bf16 v[208:223], v[140:143], a[40:43], v[208:223]
    ds_read_b64_tr_b16 v[132:133], v177 offset:49344
    s_add_u32 m0, s81, 74016
    s_lshl3_add_u32 s83, s62, s94
    buffer_load_dwordx4 v198, s[20:23], s83 offen lds
    buffer_load_dwordx4 v199, s[20:23], s83 offen offset:1024 lds
    v_mfma_f32_32x32x16_bf16 v[224:239], v[140:143], a[44:47], v[224:239]
    ds_read_b64_tr_b16 v[134:135], v177 offset:50368
    s_waitcnt lgkmcnt(2)
    v_mfma_f32_32x32x16_bf16 v[16:31], v[128:131], a[48:51], v[16:31]
    ds_read_b64_tr_b16 v[136:137], v178 offset:8224
    v_mfma_f32_32x32x16_bf16 v[32:47], v[128:131], a[52:55], v[32:47]
    ds_read_b64_tr_b16 v[138:139], v178 offset:9248
    s_add_u32 s84, s60, 16384
    buffer_load_dwordx4 a[96:99], v186, s[28:31], s84 offen sc1
    buffer_load_dwordx4 a[100:103], v186, s[28:31], s84 offen offset:1024 sc1
    s_waitcnt lgkmcnt(2)
    v_mfma_f32_32x32x16_bf16 v[208:223], v[132:135], a[48:51], v[208:223]
    ds_read_b64_tr_b16 v[140:141], v179 offset:8224
    v_mfma_f32_32x32x16_bf16 v[224:239], v[132:135], a[52:55], v[224:239]
    ds_read_b64_tr_b16 v[142:143], v179 offset:9248
    s_waitcnt lgkmcnt(2)
    v_mfma_f32_32x32x16_bf16 v[16:31], v[136:139], a[56:59], v[16:31]
    ds_read_b64_tr_b16 v[128:129], v176 offset:41120
    v_mfma_f32_32x32x16_bf16 v[32:47], v[136:139], a[60:63], v[32:47]
    ds_read_b64_tr_b16 v[130:131], v176 offset:42144
    s_add_u32 s84, s61, 16384
    buffer_load_dwordx4 a[104:107], v186, s[28:31], s84 offen sc1
    buffer_load_dwordx4 a[108:111], v186, s[28:31], s84 offen offset:1024 sc1
    buffer_load_dword v188, v187, s[28:31], 0 offen sc1
    s_waitcnt lgkmcnt(2)
    v_mfma_f32_32x32x16_bf16 v[208:223], v[140:143], a[56:59], v[208:223]
    ds_read_b64_tr_b16 v[132:133], v177 offset:41120
    s_add_u32 m0, s81, 90464
    s_lshl3_add_u32 s83, s63, s94
    buffer_load_dwordx4 v198, s[20:23], s83 offen lds
    buffer_load_dwordx4 v199, s[20:23], s83 offen offset:1024 lds
    s_add_u32 s94, s94, 131072
    v_mfma_f32_32x32x16_bf16 v[224:239], v[140:143], a[60:63], v[224:239]
    ds_read_b64_tr_b16 v[134:135], v177 offset:42144
    s_waitcnt vmcnt(19) lgkmcnt(2)
    v_mfma_f32_32x32x16_bf16 v[16:31], v[128:131], a[64:67], v[16:31]
    ds_read_b64_tr_b16 v[136:137], v178 offset:16448
    s_waitcnt vmcnt(18)
    v_mfma_f32_32x32x16_bf16 v[32:47], v[128:131], a[68:71], v[32:47]
    ds_read_b64_tr_b16 v[138:139], v178 offset:17472
    s_add_u32 s84, s62, 16384
    buffer_load_dwordx4 a[112:115], v186, s[28:31], s84 offen sc1
    buffer_load_dwordx4 a[116:119], v186, s[28:31], s84 offen offset:1024 sc1
    s_waitcnt lgkmcnt(2)
    v_mfma_f32_32x32x16_bf16 v[208:223], v[132:135], a[64:67], v[208:223]
    ds_read_b64_tr_b16 v[140:141], v179 offset:16448
    v_mfma_f32_32x32x16_bf16 v[224:239], v[132:135], a[68:71], v[224:239]
    ds_read_b64_tr_b16 v[142:143], v179 offset:17472
    s_waitcnt vmcnt(19) lgkmcnt(2)
    v_mfma_f32_32x32x16_bf16 v[16:31], v[136:139], a[72:75], v[16:31]
    ds_read_b64_tr_b16 v[128:129], v176 offset:57568
    s_waitcnt vmcnt(18)
    v_mfma_f32_32x32x16_bf16 v[32:47], v[136:139], a[76:79], v[32:47]
    ds_read_b64_tr_b16 v[130:131], v176 offset:58592
    s_add_u32 s84, s63, 16384
    buffer_load_dwordx4 a[120:123], v186, s[28:31], s84 offen sc1
    buffer_load_dwordx4 a[124:127], v186, s[28:31], s84 offen offset:1024 sc1
    s_waitcnt lgkmcnt(2)
    v_mfma_f32_32x32x16_bf16 v[208:223], v[140:143], a[72:75], v[208:223]
    ds_read_b64_tr_b16 v[132:133], v177 offset:57568
    s_add_u32 m0, s81, 106912
    s_and_b32 s83, s56, 0x1800
    s_lshl3_add_u32 s83, s83, s94
    buffer_load_dwordx4 v198, s[20:23], s83 offen lds
    buffer_load_dwordx4 v199, s[20:23], s83 offen offset:1024 lds
    v_mfma_f32_32x32x16_bf16 v[224:239], v[140:143], a[76:79], v[224:239]
    ds_read_b64_tr_b16 v[134:135], v177 offset:58592
    s_waitcnt vmcnt(19) lgkmcnt(2)
    v_mfma_f32_32x32x16_bf16 v[16:31], v[128:131], a[80:83], v[16:31]
L_padA1_11:
    s_cbranch_execz L_retA1
    ds_read_b64_tr_b16 v[136:137], v174 offset:16448
    s_waitcnt vmcnt(18)
    v_mfma_f32_32x32x16_bf16 v[32:47], v[128:131], a[84:87], v[32:47]
    ds_read_b64_tr_b16 v[138:139], v174 offset:17472
    s_waitcnt lgkmcnt(2)
    v_mfma_f32_32x32x16_bf16 v[208:223], v[132:135], a[80:83], v[208:223]
    ds_read_b64_tr_b16 v[140:141], v175 offset:16448
    v_mfma_f32_32x32x16_bf16 v[224:239], v[132:135], a[84:87], v[224:239]
    ds_read_b64_tr_b16 v[142:143], v175 offset:17472
    s_waitcnt vmcnt(16) lgkmcnt(2)
    v_mfma_f32_32x32x16_bf16 v[16:31], v[136:139], a[88:91], v[16:31]
    ds_read_b64_tr_b16 v[128:129], v174 offset:32896
    s_waitcnt vmcnt(15)
    v_mfma_f32_32x32x16_bf16 v[32:47], v[136:139], a[92:95], v[32:47]
    ds_read_b64_tr_b16 v[130:131], v174 offset:33920
    v_cndmask_b32 v189, 1, 2, s[92:93]
    s_waitcnt vmcnt(8)
    v_cmp_gt_u32 vcc, v189, v188
    s_nop 4
    s_cbranch_vccz L_ok4
    s_mov_b32 s85, 200000
L_re4:
    s_sleep 1
    buffer_load_dword v188, v187, s[28:31], 0 offen sc1
    s_waitcnt vmcnt(0)
    v_cmp_gt_u32 vcc, v189, v188
    s_sub_u32 s85, s85, 1
    s_cbranch_scc1 L_ok4
    s_nop 2
    s_cbranch_vccnz L_re4
L_ok4:
    s_add_u32 s84, s56, 32768
    buffer_load_dwordx4 a[128:131], v186, s[28:31], s84 offen sc1
    buffer_load_dwordx4 a[132:135], v186, s[28:31], s84 offen offset:1024 sc1
    s_waitcnt lgkmcnt(2)
    v_mfma_f32_32x32x16_bf16 v[208:223], v[140:143], a[88:91], v[208:223]
    ds_read_b64_tr_b16 v[132:133], v175 offset:32896
    s_add_u32 m0, s81, 16448
    s_and_b32 s83, s57, 0x1800
    s_lshl3_add_u32 s83, s83, s94
    buffer_load_dwordx4 v198, s[20:23], s83 offen lds
    buffer_load_dwordx4 v199, s[20:23], s83 offen offset:1024 lds
    v_mfma_f32_32x32x16_bf16 v[224:239], v[140:143], a[92:95], v[224:239]
    ds_read_b64_tr_b16 v[134:135], v175 offset:33920
    s_waitcnt lgkmcnt(2)
    v_mfma_f32_32x32x16_bf16 v[16:31], v[128:131], a[96:99], v[16:31]
    ds_read_b64_tr_b16 v[136:137], v176 offset:0
    v_mfma_f32_32x32x16_bf16 v[32:47], v[128:131], a[100:103], v[32:47]
    ds_read_b64_tr_b16 v[138:139], v176 offset:1024
    s_add_u32 s84, s57, 32768
    buffer_load_dwordx4 a[136:139], v186, s[28:31], s84 offen sc1
    buffer_load_dwordx4 a[140:143], v186, s[28:31], s84 offen offset:1024 sc1
    s_waitcnt lgkmcnt(2)
    v_mfma_f32_32x32x16_bf16 v[208:223], v[132:135], a[96:99], v[208:223]
    ds_read_b64_tr_b16 v[140:141], v177 offset:0
    v_mfma_f32_32x32x16_bf16 v[224:239], v[132:135], a[100:103], v[224:239]
    ds_read_b64_tr_b16 v[142:143], v177 offset:1024
    s_waitcnt lgkmcnt(2)
    v_mfma_f32_32x32x16_bf16 v[16:31], v[136:139], a[104:107], v[16:31]
    ds_read_b64_tr_b16 v[128:129], v174 offset:49344
    v_mfma_f32_32x32x16_bf16 v[32:47], v[136:139], a[108:111], v[32:47]
    ds_read_b64_tr_b16 v[130:131], v174 offset:50368
    s_add_u32 s84, s58, 32768
    buffer_load_dwordx4 a[144:147], v186, s[28:31], s84 offen sc1
    buffer_load_dwordx4 a[148:151], v186, s[28:31], s84 offen offset:1024 sc1
    s_waitcnt lgkmcnt(2)
    v_mfma_f32_32x32x16_bf16 v[208:223], v[140:143], a[104:107], v[208:223]
    ds_read_b64_tr_b16 v[132:133], v175 offset:49344
    s_add_u32 m0, s81, 32896
    s_and_b32 s83, s58, 0x1800
    s_lshl3_add_u32 s83, s83, s94
    buffer_load_dwordx4 v198, s[20:23], s83 offen lds
    buffer_load_dwordx4 v199, s[20:23], s83 offen offset:1024 lds
    v_mfma_f32_32x32x16_bf16 v[224:239], v[140:143], a[108:111], v[224:239]
    ds_read_b64_tr_b16 v[134:135], v175 offset:50368
    s_waitcnt vmcnt(15) lgkmcnt(2)
    v_mfma_f32_32x32x16_bf16 v[16:31], v[128:131], a[112:115], v[16:31]
    ds_read_b64_tr_b16 v[136:137], v176 offset:16448
    s_waitcnt vmcnt(14)
    v_mfma_f32_32x32x16_bf16 v[32:47], v[128:131], a[116:119], v[32:47]
    ds_read_b64_tr_b16 v[138:139], v176 offset:17472
    s_add_u32 s84, s59, 32768
    buffer_load_dwordx4 a[152:155], v186, s[28:31], s84 offen sc1
    buffer_load_dwordx4 a[156:159], v186, s[28:31], s84 offen offset:1024 sc1
    s_waitcnt lgkmcnt(2)
    v_mfma_f32_32x32x16_bf16 v[208:223], v[132:135], a[112:115], v[208:223]
    ds_read_b64_tr_b16 v[140:141], v177 offset:16448
    v_mfma_f32_32x32x16_bf16 v[224:239], v[132:135], a[116:119], v[224:239]
    ds_read_b64_tr_b16 v[142:143], v177 offset:17472
    s_waitcnt vmcnt(15) lgkmcnt(2)
    v_mfma_f32_32x32x16_bf16 v[16:31], v[136:139], a[120:123], v[16:31]
    ds_read_b64_tr_b16 v[128:129], v174 offset:0
    s_waitcnt vmcnt(14)
    v_mfma_f32_32x32x16_bf16 v[32:47], v[136:139], a[124:127], v[32:47]
    ds_read_b64_tr_b16 v[130:131], v174 offset:1024
    s_add_u32 s84, s60, 32768
    buffer_load_dwordx4 a[160:163], v186, s[28:31], s84 offen sc1
    buffer_load_dwordx4 a[164:167], v186, s[28:31], s84 offen offset:1024 sc1
    buffer_load_dword v182, v187, s[28:31], 0 offen sc1
    s_waitcnt lgkmcnt(2)
    v_mfma_f32_32x32x16_bf16 v[208:223], v[140:143], a[120:123], v[208:223]
    ds_read_b64_tr_b16 v[132:133], v175 offset:0
    s_add_u32 m0, s81, 49344
    s_and_b32 s83, s59, 0x1800
    s_lshl3_add_u32 s83, s83, s94
    buffer_load_dwordx4 v198, s[20:23], s83 offen lds
    buffer_load_dwordx4 v199, s[20:23], s83 offen offset:1024 lds
    v_mfma_f32_32x32x16_bf16 v[224:239], v[140:143], a[124:127], v[224:239]
    ds_read_b64_tr_b16 v[134:135], v175 offset:1024
    s_waitcnt vmcnt(16) lgkmcnt(2)
    v_mfma_f32_32x32x16_bf16 v[16:31], v[128:131], a[128:131], v[16:31]
    ds_read_b64_tr_b16 v[136:137], v174 offset:8224
    s_waitcnt vmcnt(15)
    v_mfma_f32_32x32x16_bf16 v[32:47], v[128:131], a[132:135], v[32:47]
    ds_read_b64_tr_b16 v[138:139], v174 offset:9248
    s_add_u32 s84, s61, 32768
    buffer_load_dwordx4 a[168:171], v186, s[28:31], s84 offen sc1
    buffer_load_dwordx4 a[172:175], v186, s[28:31], s84 offen offset:1024 sc1
    s_waitcnt lgkmcnt(2)
    v_mfma_f32_32x32x16_bf16 v[208:223], v[132:135], a[128:131], v[208:223]
    ds_read_b64_tr_b16 v[140:141], v175 offset:8224
    s_add_u32 m0, s81, 0
    s_lshl3_add_u32 s83, s56, s95
    buffer_load_dwordx4 v198, s[24:27], s83 offen lds
    buffer_load_dwordx4 v199, s[24:27], s83 offen offset:1024 lds
    v_mfma_f32_32x32x16_bf16 v[224:239], v[132:135], a[132:135], v[224:239]
    ds_read_b64_tr_b16 v[142:143], v175 offset:9248
    s_waitcnt vmcnt(16) lgkmcnt(2)
    v_mfma_f32_32x32x16_bf16 v[16:31], v[136:139], a[136:139], v[16:31]
    ds_read_b64_tr_b16 v[128:129], v176 offset:32896
    s_waitcnt vmcnt(15)
    v_mfma_f32_32x32x16_bf16 v[32:47], v[136:139], a[140:143], v[32:47]
    ds_read_b64_tr_b16 v[130:131], v176 offset:33920
    s_add_u32 s84, s62, 32768
    buffer_load_dwordx4 a[176:179], v186, s[28:31], s84 offen sc1
    buffer_load_dwordx4 a[180:183], v186, s[28:31], s84 offen offset:1024 sc1
    s_waitcnt lgkmcnt(2)
    v_mfma_f32_32x32x16_bf16 v[208:223], v[140:143], a[136:139], v[208:223]
    ds_read_b64_tr_b16 v[132:133], v177 offset:32896
    v_mfma_f32_32x32x16_bf16 v[224:239], v[140:143], a[140:143], v[224:239]
    ds_read_b64_tr_b16 v[134:135], v177 offset:33920
    s_waitcnt vmcnt(16) lgkmcnt(2)
    v_mfma_f32_32x32x16_bf16 v[16:31], v[128:131], a[144:147], v[16:31]
    ds_read_b64_tr_b16 v[136:137], v174 offset:24672
    s_waitcnt vmcnt(15)
    v_mfma_f32_32x32x16_bf16 v[32:47], v[128:131], a[148:151], v[32:47]
    ds_read_b64_tr_b16 v[138:139], v174 offset:25696
    s_add_u32 s84, s63, 32768
    buffer_load_dwordx4 a[184:187], v186, s[28:31], s84 offen sc1
L_padA1_12:
    s_cbranch_execz L_retA1
    buffer_load_dwordx4 a[188:191], v186, s[28:31], s84 offen offset:1024 sc1
    s_waitcnt lgkmcnt(2)
    v_mfma_f32_32x32x16_bf16 v[208:223], v[132:135], a[144:147], v[208:223]
    ds_read_b64_tr_b16 v[140:141], v175 offset:24672
    s_add_u32 m0, s81, 8224
    s_lshl3_add_u32 s83, s57, s95
    buffer_load_dwordx4 v198, s[24:27], s83 offen lds
    buffer_load_dwordx4 v199, s[24:27], s83 offen offset:1024 lds
    v_mfma_f32_32x32x16_bf16 v[224:239], v[132:135], a[148:151], v[224:239]
    ds_read_b64_tr_b16 v[142:143], v175 offset:25696
    s_waitcnt vmcnt(16) lgkmcnt(2)
    v_mfma_f32_32x32x16_bf16 v[16:31], v[136:139], a[152:155], v[16:31]
    ds_read_b64_tr_b16 v[128:129], v174 offset:41120
    s_waitcnt vmcnt(15)
    v_mfma_f32_32x32x16_bf16 v[32:47], v[136:139], a[156:159], v[32:47]
    ds_read_b64_tr_b16 v[130:131], v174 offset:42144
    v_cndmask_b32 v189, 2, 2, s[92:93]
    s_waitcnt vmcnt(12)
    v_cmp_gt_u32 vcc, v189, v182
    s_nop 4
    s_cbranch_vccz L_ok5
    s_mov_b32 s85, 200000
L_re5:
    s_sleep 1
    buffer_load_dword v182, v187, s[28:31], 0 offen sc1
    s_waitcnt vmcnt(0)
    v_cmp_gt_u32 vcc, v189, v182
    s_sub_u32 s85, s85, 1
    s_cbranch_scc1 L_ok5
    s_nop 2
    s_cbranch_vccnz L_re5
L_ok5:
    s_and_b32 s84, s56, 0x1800
    s_add_u32 s84, s84, 49152
    buffer_load_dwordx4 a[192:195], v186, s[28:31], s84 offen sc1
    buffer_load_dwordx4 a[196:199], v186, s[28:31], s84 offen offset:1024 sc1
    s_waitcnt lgkmcnt(2)
    v_mfma_f32_32x32x16_bf16 v[208:223], v[140:143], a[152:155], v[208:223]
    ds_read_b64_tr_b16 v[132:133], v175 offset:41120
    v_mfma_f32_32x32x16_bf16 v[224:239], v[140:143], a[156:159], v[224:239]
    ds_read_b64_tr_b16 v[134:135], v175 offset:42144
    buffer_load_dword v188, v187, s[28:31], 0 offen sc1
    s_waitcnt lgkmcnt(2)
    v_mfma_f32_32x32x16_bf16 v[16:31], v[128:131], a[160:163], v[16:31]
    ds_read_b64_tr_b16 v[136:137], v174 offset:57568
    v_mfma_f32_32x32x16_bf16 v[32:47], v[128:131], a[164:167], v[32:47]
    ds_read_b64_tr_b16 v[138:139], v174 offset:58592
    s_and_b32 s84, s57, 0x1800
    s_add_u32 s84, s84, 49152
    buffer_load_dwordx4 a[200:203], v186, s[28:31], s84 offen sc1
    buffer_load_dwordx4 a[204:207], v186, s[28:31], s84 offen offset:1024 sc1
    s_waitcnt lgkmcnt(2)
    v_mfma_f32_32x32x16_bf16 v[208:223], v[132:135], a[160:163], v[208:223]
    ds_read_b64_tr_b16 v[140:141], v175 offset:57568
    s_add_u32 m0, s81, 24672
    s_lshl3_add_u32 s83, s58, s95
    buffer_load_dwordx4 v198, s[24:27], s83 offen lds
    buffer_load_dwordx4 v199, s[24:27], s83 offen offset:1024 lds
    v_mfma_f32_32x32x16_bf16 v[224:239], v[132:135], a[164:167], v[224:239]
    ds_read_b64_tr_b16 v[142:143], v175 offset:58592
    s_waitcnt vmcnt(16) lgkmcnt(2)
    v_mfma_f32_32x32x16_bf16 v[16:31], v[136:139], a[168:171], v[16:31]
    ds_read_b64_tr_b16 v[128:129], v176 offset:8224
    s_waitcnt vmcnt(15)
    v_mfma_f32_32x32x16_bf16 v[32:47], v[136:139], a[172:175], v[32:47]
    ds_read_b64_tr_b16 v[130:131], v176 offset:9248
    s_and_b32 s84, s58, 0x1800
    s_add_u32 s84, s84, 49152
    buffer_load_dwordx4 a[208:211], v186, s[28:31], s84 offen sc1
    buffer_load_dwordx4 a[212:215], v186, s[28:31], s84 offen offset:1024 sc1
    s_waitcnt lgkmcnt(2)
    v_mfma_f32_32x32x16_bf16 v[208:223], v[140:143], a[168:171], v[208:223]
    ds_read_b64_tr_b16 v[132:133], v177 offset:8224
    v_mfma_f32_32x32x16_bf16 v[224:239], v[140:143], a[172:175], v[224:239]
    ds_read_b64_tr_b16 v[134:135], v177 offset:9248
    s_waitcnt vmcnt(14) lgkmcnt(2)
    v_mfma_f32_32x32x16_bf16 v[16:31], v[128:131], a[176:179], v[16:31]
    ds_read_b64_tr_b16 v[136:137], v176 offset:24672
    s_waitcnt vmcnt(13)
    v_mfma_f32_32x32x16_bf16 v[32:47], v[128:131], a[180:183], v[32:47]
    ds_read_b64_tr_b16 v[138:139], v176 offset:25696
    s_and_b32 s84, s59, 0x1800
    s_add_u32 s84, s84, 49152
    buffer_load_dwordx4 a[216:219], v186, s[28:31], s84 offen sc1
    buffer_load_dwordx4 a[220:223], v186, s[28:31], s84 offen offset:1024 sc1
    s_waitcnt lgkmcnt(2)
    v_mfma_f32_32x32x16_bf16 v[208:223], v[132:135], a[176:179], v[208:223]
    ds_read_b64_tr_b16 v[140:141], v177 offset:24672
    s_add_u32 m0, s81, 41120
    s_lshl3_add_u32 s83, s59, s95
    buffer_load_dwordx4 v198, s[24:27], s83 offen lds
    buffer_load_dwordx4 v199, s[24:27], s83 offen offset:1024 lds
    v_mfma_f32_32x32x16_bf16 v[224:239], v[132:135], a[180:183], v[224:239]
    ds_read_b64_tr_b16 v[142:143], v177 offset:25696
    s_waitcnt vmcnt(16) lgkmcnt(2)
    v_mfma_f32_32x32x16_bf16 v[16:31], v[136:139], a[184:187], v[16:31]
    ds_read_b64_tr_b16 v[128:129], v176 offset:41120
    s_waitcnt vmcnt(15)
    v_mfma_f32_32x32x16_bf16 v[32:47], v[136:139], a[188:191], v[32:47]
    ds_read_b64_tr_b16 v[130:131], v176 offset:42144
    v_cndmask_b32 v189, 2, 3, s[92:93]
    s_waitcnt vmcnt(10)
    v_cmp_gt_u32 vcc, v189, v188
    s_nop 4
    s_cbranch_vccz L_ok6
    s_mov_b32 s85, 200000
L_re6:
    s_sleep 1
    buffer_load_dword v188, v187, s[28:31], 0 offen sc1
    s_waitcnt vmcnt(0)
    v_cmp_gt_u32 vcc, v189, v188
    s_sub_u32 s85, s85, 1
    s_cbranch_scc1 L_ok6
    s_nop 2
    s_cbranch_vccnz L_re6
L_ok6:
    s_add_u32 s84, s56, 57344
    buffer_load_dwordx4 a[224:227], v186, s[28:31], s84 offen sc1
    buffer_load_dwordx4 a[228:231], v186, s[28:31], s84 offen offset:1024 sc1
    s_waitcnt lgkmcnt(2)
    v_mfma_f32_32x32x16_bf16 v[208:223], v[140:143], a[184:187], v[208:223]
    ds_read_b64_tr_b16 v[132:133], v177 offset:41120
    v_mfma_f32_32x32x16_bf16 v[224:239], v[140:143], a[188:191], v[224:239]
    ds_read_b64_tr_b16 v[134:135], v177 offset:42144
    s_waitcnt lgkmcnt(2)
    v_mfma_f32_32x32x16_bf16 v[16:31], v[128:131], a[192:195], v[16:31]
    ds_read_b64_tr_b16 v[136:137], v174 offset:16448
    s_lshl_b32 s83, s52, 2
    s_add_u32 s83, s83, s44
    s_lshl_b32 s83, s83, 14
    s_lshl_b32 s84, s53, 7
    s_add_u32 s83, s83, s84
    v_lshrrev_b32 v248, 3, v197
    v_lshlrev_b32 v248, 10, v248
    v_and_b32 v249, 7, v197
    v_lshl_add_u32 v248, v249, 4, v248
    v_add_u32 v185, s83, v248
    v_mfma_f32_32x32x16_bf16 v[32:47], v[128:131], a[196:199], v[32:47]
    ds_read_b64_tr_b16 v[138:139], v174 offset:17472
    s_add_u32 s84, s57, 57344
    buffer_load_dwordx4 a[232:235], v186, s[28:31], s84 offen sc1
    buffer_load_dwordx4 a[236:239], v186, s[28:31], s84 offen offset:1024 sc1
    s_mov_b32 s84, 8192
    buffer_load_dwordx4 v[240:243], v185, s[4:7], 0 offen
    buffer_load_dwordx4 v[244:247], v185, s[4:7], s84 offen
    s_waitcnt lgkmcnt(2)
    v_mfma_f32_32x32x16_bf16 v[208:223], v[132:135], a[192:195], v[208:223]
    ds_read_b64_tr_b16 v[140:141], v175 offset:16448
    s_add_u32 m0, s81, 57568
    s_lshl3_add_u32 s83, s60, s95
    buffer_load_dwordx4 v198, s[24:27], s83 offen lds
    buffer_load_dwordx4 v199, s[24:27], s83 offen offset:1024 lds
    v_mfma_f32_32x32x16_bf16 v[224:239], v[132:135], a[196:199], v[224:239]
    ds_read_b64_tr_b16 v[142:143], v175 offset:17472
    v_bfe_u32 v8, v197, 3, 2
    v_mul_u32_u24 v8, 8224, v8
    v_and_b32 v9, 7, v197
    v_lshl_add_u32 v8, v9, 8, v8
L_padA1_13:
    s_cbranch_execz L_retA1
    s_waitcnt vmcnt(17) lgkmcnt(2)
    v_mfma_f32_32x32x16_bf16 v[16:31], v[136:139], a[200:203], v[16:31]
    ds_read_b64_tr_b16 v[128:129], v174 offset:32896
    v_add_u32 v8, s81, v8
    v_lshrrev_b32 v10, 5, v197
    v_xor_b32 v10, v10, v9
    s_waitcnt vmcnt(16)
    v_mfma_f32_32x32x16_bf16 v[32:47], v[136:139], a[204:207], v[32:47]
    ds_read_b64_tr_b16 v[130:131], v174 offset:33920
    s_add_u32 s84, s58, 57344
    buffer_load_dwordx4 a[240:243], v186, s[28:31], s84 offen sc1
    buffer_load_dwordx4 a[244:247], v186, s[28:31], s84 offen offset:1024 sc1
    v_lshl_add_u32 v0, v10, 4, v8
    s_waitcnt lgkmcnt(2)
    v_mfma_f32_32x32x16_bf16 v[208:223], v[140:143], a[200:203], v[208:223]
    ds_read_b64_tr_b16 v[132:133], v175 offset:32896
    v_xor_b32 v11, 2, v10
    v_lshl_add_u32 v1, v11, 4, v8
    v_xor_b32 v11, 4, v10
    v_lshl_add_u32 v2, v11, 4, v8
    v_mfma_f32_32x32x16_bf16 v[224:239], v[140:143], a[204:207], v[224:239]
    ds_read_b64_tr_b16 v[134:135], v175 offset:33920
    v_xor_b32 v11, 6, v10
    v_lshl_add_u32 v3, v11, 4, v8
    v_lshrrev_b32 v8, 3, v197
    s_waitcnt vmcnt(15) lgkmcnt(2)
    v_mfma_f32_32x32x16_bf16 v[16:31], v[128:131], a[208:211], v[16:31]
    ds_read_b64_tr_b16 v[136:137], v174 offset:49344
    v_and_b32 v10, 3, v197
    v_lshlrev_b32 v10, 1, v10
    v_xor_b32 v10, v10, v8
    s_waitcnt vmcnt(14)
    v_mfma_f32_32x32x16_bf16 v[32:47], v[128:131], a[212:215], v[32:47]
    ds_read_b64_tr_b16 v[138:139], v174 offset:50368
    s_add_u32 s84, s59, 57344
    buffer_load_dwordx4 a[248:251], v186, s[28:31], s84 offen sc1
    buffer_load_dwordx4 a[252:255], v186, s[28:31], s84 offen offset:1024 sc1
    v_bfe_u32 v11, v197, 2, 1
    s_waitcnt lgkmcnt(2)
    v_mfma_f32_32x32x16_bf16 v[208:223], v[132:135], a[208:211], v[208:223]
    ds_read_b64_tr_b16 v[140:141], v175 offset:49344
    s_add_u32 m0, s81, 16448
    s_lshl3_add_u32 s83, s61, s95
    buffer_load_dwordx4 v198, s[24:27], s83 offen lds
    buffer_load_dwordx4 v199, s[24:27], s83 offen offset:1024 lds
    v_mfma_f32_32x32x16_bf16 v[224:239], v[132:135], a[212:215], v[224:239]
    ds_read_b64_tr_b16 v[142:143], v175 offset:50368
    v_lshlrev_b32 v11, 7, v11
    v_lshl_add_u32 v11, v8, 8, v11
    v_mov_b32 v9, s44
    v_mul_u32_u24 v9, 16448, v9
    s_waitcnt vmcnt(17) lgkmcnt(2)
    v_mfma_f32_32x32x16_bf16 v[16:31], v[136:139], a[216:219], v[16:31]
    ds_read_b64_tr_b16 v[128:129], v174 offset:0
    v_add_u32 v11, v11, v9
    v_lshl_add_u32 v4, v10, 4, v11
    v_xor_b32 v10, 1, v10
    s_waitcnt vmcnt(16)
    v_mfma_f32_32x32x16_bf16 v[32:47], v[136:139], a[220:223], v[32:47]
    ds_read_b64_tr_b16 v[130:131], v174 offset:1024
    s_add_u32 s84, s60, 57344
    buffer_load_dwordx4 a[0:3], v186, s[28:31], s84 offen sc1
    buffer_load_dwordx4 a[4:7], v186, s[28:31], s84 offen offset:1024 sc1
    v_lshl_add_u32 v5, v10, 4, v11
    s_waitcnt lgkmcnt(2)
    v_mfma_f32_32x32x16_bf16 v[208:223], v[140:143], a[216:219], v[208:223]
    ds_read_b64_tr_b16 v[132:133], v175 offset:0
    v_mfma_f32_32x32x16_bf16 v[224:239], v[140:143], a[220:223], v[224:239]
    ds_read_b64_tr_b16 v[134:135], v175 offset:1024
    v_mov_b32 v6, v185
    s_waitcnt vmcnt(15) lgkmcnt(2)
    v_mfma_f32_32x32x16_bf16 v[16:31], v[128:131], a[224:227], v[16:31]
    ds_read_b64_tr_b16 v[136:137], v174 offset:8224
    s_waitcnt vmcnt(14)
    v_mfma_f32_32x32x16_bf16 v[32:47], v[128:131], a[228:231], v[32:47]
    ds_read_b64_tr_b16 v[138:139], v174 offset:9248
    s_add_u32 s84, s61, 57344
    buffer_load_dwordx4 a[8:11], v186, s[28:31], s84 offen sc1
    buffer_load_dwordx4 a[12:15], v186, s[28:31], s84 offen offset:1024 sc1
    s_waitcnt lgkmcnt(2)
    v_mfma_f32_32x32x16_bf16 v[208:223], v[132:135], a[224:227], v[208:223]
    ds_read_b64_tr_b16 v[140:141], v175 offset:8224
    s_add_u32 m0, s81, 0
    s_lshl3_add_u32 s83, s62, s95
    buffer_load_dwordx4 v198, s[24:27], s83 offen lds
    buffer_load_dwordx4 v199, s[24:27], s83 offen offset:1024 lds
    v_mfma_f32_32x32x16_bf16 v[224:239], v[132:135], a[228:231], v[224:239]
    ds_read_b64_tr_b16 v[142:143], v175 offset:9248
    s_waitcnt vmcnt(17) lgkmcnt(2)
    v_mfma_f32_32x32x16_bf16 v[16:31], v[136:139], a[232:235], v[16:31]
    ds_read_b64_tr_b16 v[128:129], v174 offset:24672
    s_waitcnt vmcnt(16)
    v_mfma_f32_32x32x16_bf16 v[32:47], v[136:139], a[236:239], v[32:47]
    ds_read_b64_tr_b16 v[130:131], v174 offset:25696
    s_add_u32 s84, s62, 57344
    buffer_load_dwordx4 a[16:19], v186, s[28:31], s84 offen sc1
    buffer_load_dwordx4 a[20:23], v186, s[28:31], s84 offen offset:1024 sc1
    s_waitcnt lgkmcnt(2)
    v_mfma_f32_32x32x16_bf16 v[208:223], v[140:143], a[232:235], v[208:223]
    ds_read_b64_tr_b16 v[132:133], v175 offset:24672
    v_mfma_f32_32x32x16_bf16 v[224:239], v[140:143], a[236:239], v[224:239]
    ds_read_b64_tr_b16 v[134:135], v175 offset:25696
    s_waitcnt vmcnt(13) lgkmcnt(2)
    v_mfma_f32_32x32x16_bf16 v[16:31], v[128:131], a[240:243], v[16:31]
    ds_read_b64_tr_b16 v[136:137], v174 offset:41120
    s_waitcnt vmcnt(12)
    v_mfma_f32_32x32x16_bf16 v[32:47], v[128:131], a[244:247], v[32:47]
    ds_read_b64_tr_b16 v[138:139], v174 offset:42144
    s_add_u32 s84, s63, 57344
    buffer_load_dwordx4 a[24:27], v186, s[28:31], s84 offen sc1
    buffer_load_dwordx4 a[28:31], v186, s[28:31], s84 offen offset:1024 sc1
    s_waitcnt lgkmcnt(2)
    v_mfma_f32_32x32x16_bf16 v[208:223], v[132:135], a[240:243], v[208:223]
    ds_read_b64_tr_b16 v[140:141], v175 offset:41120
    s_add_u32 m0, s81, 8224
    s_lshl3_add_u32 s83, s63, s95
    buffer_load_dwordx4 v198, s[24:27], s83 offen lds
    buffer_load_dwordx4 v199, s[24:27], s83 offen offset:1024 lds
    v_mfma_f32_32x32x16_bf16 v[224:239], v[132:135], a[244:247], v[224:239]
    ds_read_b64_tr_b16 v[142:143], v175 offset:42144
    s_waitcnt vmcnt(15) lgkmcnt(2)
    v_mfma_f32_32x32x16_bf16 v[16:31], v[136:139], a[248:251], v[16:31]
    ds_read_b64_tr_b16 v[128:129], v174 offset:57568
    v_lshlrev_b32 v96, 16, v240
    s_waitcnt vmcnt(14)
    v_mfma_f32_32x32x16_bf16 v[32:47], v[136:139], a[252:255], v[32:47]
    ds_read_b64_tr_b16 v[130:131], v174 offset:58592
    v_and_b32 v97, 0xffff0000, v240
    v_lshlrev_b32 v98, 16, v241
    s_waitcnt lgkmcnt(2)
    v_mfma_f32_32x32x16_bf16 v[208:223], v[140:143], a[248:251], v[208:223]
    ds_read_b64_tr_b16 v[132:133], v175 offset:57568
    v_and_b32 v99, 0xffff0000, v241
    v_mfma_f32_32x32x16_bf16 v[224:239], v[140:143], a[252:255], v[224:239]
    ds_read_b64_tr_b16 v[134:135], v175 offset:58592
    v_lshlrev_b32 v100, 16, v242
    v_and_b32 v101, 0xffff0000, v242
    s_waitcnt vmcnt(11) lgkmcnt(2)
    v_mfma_f32_32x32x16_bf16 v[16:31], v[128:131], a[0:3], v[16:31]
    ds_read_b64_tr_b16 v[136:137], v174 offset:16448
    v_lshlrev_b32 v102, 16, v243
    s_waitcnt vmcnt(10)
    v_mfma_f32_32x32x16_bf16 v[32:47], v[128:131], a[4:7], v[32:47]
    ds_read_b64_tr_b16 v[138:139], v174 offset:17472
    v_and_b32 v103, 0xffff0000, v243
    s_waitcnt lgkmcnt(2)
    v_mfma_f32_32x32x16_bf16 v[208:223], v[132:135], a[0:3], v[208:223]
    ds_read_b64_tr_b16 v[140:141], v175 offset:16448
    v_lshlrev_b32 v104, 16, v244
    v_and_b32 v105, 0xffff0000, v244
    v_mfma_f32_32x32x16_bf16 v[224:239], v[132:135], a[4:7], v[224:239]
    ds_read_b64_tr_b16 v[142:143], v175 offset:17472
L_padA0_4:
    s_cbranch_execz L_retA0
    v_lshlrev_b32 v106, 16, v245
    s_waitcnt vmcnt(9) lgkmcnt(2)
    v_mfma_f32_32x32x16_bf16 v[16:31], v[136:139], a[8:11], v[16:31]
    s_waitcnt vmcnt(6)
    ds_read_b64_tr_b16 v[128:129], v174 offset:0
    v_and_b32 v107, 0xffff0000, v245
    v_mfma_f32_32x32x16_bf16 v[32:47], v[136:139], a[12:15], v[32:47]
    ds_read_b64_tr_b16 v[130:131], v174 offset:1024
    v_lshlrev_b32 v108, 16, v246
    v_and_b32 v109, 0xffff0000, v246
    s_waitcnt lgkmcnt(2)
    v_mfma_f32_32x32x16_bf16 v[208:223], v[140:143], a[8:11], v[208:223]
    ds_read_b64_tr_b16 v[132:133], v175 offset:0
    v_lshlrev_b32 v110, 16, v247
    v_mfma_f32_32x32x16_bf16 v[224:239], v[140:143], a[12:15], v[224:239]
    ds_read_b64_tr_b16 v[134:135], v175 offset:1024
    v_and_b32 v111, 0xffff0000, v247
    s_waitcnt vmcnt(0)
    ds_read_b64_tr_b16 v[136:137], v174 offset:8224
    ds_read_b64_tr_b16 v[138:139], v174 offset:9248
    ds_read_b64_tr_b16 v[140:141], v175 offset:8224
    ds_read_b64_tr_b16 v[142:143], v175 offset:9248
    s_waitcnt lgkmcnt(6)
    v_mfma_f32_32x32x16_bf16 v[16:31], v[128:131], a[16:19], v[16:31]
    s_waitcnt lgkmcnt(2)
    v_mfma_f32_32x32x16_bf16 v[16:31], v[136:139], a[24:27], v[16:31]
    v_mfma_f32_32x32x16_bf16 v[208:223], v[132:135], a[16:19], v[208:223]
    s_waitcnt lgkmcnt(0)
    v_mfma_f32_32x32x16_bf16 v[208:223], v[140:143], a[24:27], v[208:223]
    v_mfma_f32_32x32x16_bf16 v[32:47], v[128:131], a[20:23], v[32:47]
    s_nop 7
    ds_write_b128 v0, v[16:19] offset:0
    ds_write_b128 v1, v[20:23] offset:0
    v_mfma_f32_32x32x16_bf16 v[32:47], v[136:139], a[28:31], v[32:47]
    ds_write_b128 v2, v[24:27] offset:0
    ds_write_b128 v3, v[28:31] offset:0
    ds_write_b128 v0, v[208:211] offset:128
    v_mfma_f32_32x32x16_bf16 v[224:239], v[132:135], a[20:23], v[224:239]
    ds_write_b128 v1, v[212:215] offset:128
    ds_write_b128 v2, v[216:219] offset:128
    v_mfma_f32_32x32x16_bf16 v[224:239], v[140:143], a[28:31], v[224:239]
    ds_write_b128 v3, v[220:223] offset:128
    s_nop 3
    ds_write_b128 v0, v[32:35] offset:32896
    ds_write_b128 v1, v[36:39] offset:32896
    ds_write_b128 v2, v[40:43] offset:32896
    ds_write_b128 v3, v[44:47] offset:32896
    s_nop 2
    ds_write_b128 v0, v[224:227] offset:33024
    ds_write_b128 v1, v[228:231] offset:33024
    ds_write_b128 v2, v[232:235] offset:33024
    ds_write_b128 v3, v[236:239] offset:33024
    s_waitcnt lgkmcnt(0)
    s_barrier
    ds_read_b128 v[128:131], v4 offset:0
    ds_read_b128 v[132:135], v4 offset:2048
    ds_read_b128 v[136:139], v4 offset:4096
    ds_read_b128 v[140:143], v4 offset:6144
    ds_read_b128 v[144:147], v5 offset:0
    ds_read_b128 v[148:151], v5 offset:2048
    ds_read_b128 v[152:155], v5 offset:4096
    ds_read_b128 v[156:159], v5 offset:6144
    ds_read_b128 v[160:163], v4 offset:8224
    ds_read_b128 v[164:167], v4 offset:10272
    ds_read_b128 v[168:171], v4 offset:12320
    ds_read_b128 v[172:175], v4 offset:14368
    ds_read_b128 v[176:179], v5 offset:8224
    ds_read_b128 v[180:183], v5 offset:10272
    ds_read_b128 v[184:187], v5 offset:12320
    ds_read_b128 v[188:191], v5 offset:14368
    s_waitcnt lgkmcnt(15)
    v_pk_add_f32 v[96:97], v[96:97], v[128:129]
    v_pk_add_f32 v[98:99], v[98:99], v[130:131]
    s_waitcnt lgkmcnt(13)
    v_pk_add_f32 v[132:133], v[132:133], v[136:137]
    v_pk_add_f32 v[134:135], v[134:135], v[138:139]
    s_waitcnt lgkmcnt(12)
    v_pk_add_f32 v[96:97], v[96:97], v[140:141]
    v_pk_add_f32 v[98:99], v[98:99], v[142:143]
    v_pk_add_f32 v[96:97], v[96:97], v[132:133]
    v_pk_add_f32 v[98:99], v[98:99], v[134:135]
    v_cvt_pk_bf16_f32 v8, v96, v97
    v_cvt_pk_bf16_f32 v9, v98, v99
    s_waitcnt lgkmcnt(11)
    v_pk_add_f32 v[100:101], v[100:101], v[144:145]
    v_pk_add_f32 v[102:103], v[102:103], v[146:147]
    s_waitcnt lgkmcnt(9)
    v_pk_add_f32 v[148:149], v[148:149], v[152:153]
    v_pk_add_f32 v[150:151], v[150:151], v[154:155]
    s_waitcnt lgkmcnt(8)
    v_pk_add_f32 v[100:101], v[100:101], v[156:157]
    v_pk_add_f32 v[102:103], v[102:103], v[158:159]
    v_pk_add_f32 v[100:101], v[100:101], v[148:149]
    v_pk_add_f32 v[102:103], v[102:103], v[150:151]
    v_cvt_pk_bf16_f32 v10, v100, v101
    v_cvt_pk_bf16_f32 v11, v102, v103
    s_mov_b32 s84, 0
    buffer_store_dwordx4 v[8:11], v6, s[32:35], s84 offen sc1
    s_waitcnt lgkmcnt(7)
    v_pk_add_f32 v[104:105], v[104:105], v[160:161]
    v_pk_add_f32 v[106:107], v[106:107], v[162:163]
    s_waitcnt lgkmcnt(5)
    v_pk_add_f32 v[164:165], v[164:165], v[168:169]
    v_pk_add_f32 v[166:167], v[166:167], v[170:171]
    s_waitcnt lgkmcnt(4)
    v_pk_add_f32 v[104:105], v[104:105], v[172:173]
    v_pk_add_f32 v[106:107], v[106:107], v[174:175]
    v_pk_add_f32 v[104:105], v[104:105], v[164:165]
    v_pk_add_f32 v[106:107], v[106:107], v[166:167]
    v_cvt_pk_bf16_f32 v12, v104, v105
    v_cvt_pk_bf16_f32 v13, v106, v107
    s_waitcnt lgkmcnt(3)
    v_pk_add_f32 v[108:109], v[108:109], v[176:177]
    v_pk_add_f32 v[110:111], v[110:111], v[178:179]
    s_waitcnt lgkmcnt(1)
    v_pk_add_f32 v[180:181], v[180:181], v[184:185]
    v_pk_add_f32 v[182:183], v[182:183], v[186:187]
    s_waitcnt lgkmcnt(0)
    v_pk_add_f32 v[108:109], v[108:109], v[188:189]
    v_pk_add_f32 v[110:111], v[110:111], v[190:191]
    v_pk_add_f32 v[108:109], v[108:109], v[180:181]
    v_pk_add_f32 v[110:111], v[110:111], v[182:183]
    v_cvt_pk_bf16_f32 v14, v108, v109
    v_cvt_pk_bf16_f32 v15, v110, v111
    s_mov_b32 s84, 8192
    buffer_store_dwordx4 v[12:15], v6, s[32:35], s84 offen sc1
    s_endpgm
L_endA:
.p2align 12
L_mainB:
    s_add_u32 s84, s85, 2
    s_sub_u32 s83, s84, 7
    s_cmp_gt_u32 s84, 7
    s_cselect_b32 s84, s83, s84
    s_lshl_b32 s58, s84, 7
    s_mul_i32 s66, s84, 196608
    s_mul_i32 s74, s84, 229376
    s_add_u32 s84, s85, 3
    s_sub_u32 s83, s84, 7
    s_cmp_gt_u32 s84, 7
    s_cselect_b32 s84, s83, s84
    s_lshl_b32 s59, s84, 7
    s_mul_i32 s67, s84, 196608
    s_mul_i32 s75, s84, 229376
    s_add_u32 s84, s85, 4
    s_sub_u32 s83, s84, 7
    s_cmp_gt_u32 s84, 7
    s_cselect_b32 s84, s83, s84
    s_lshl_b32 s60, s84, 7
    s_mul_i32 s68, s84, 196608
    s_mul_i32 s76, s84, 229376
    s_add_u32 s84, s85, 5
    s_sub_u32 s83, s84, 7
    s_cmp_gt_u32 s84, 7
    s_cselect_b32 s84, s83, s84
    s_lshl_b32 s61, s84, 7
    s_mul_i32 s69, s84, 196608
    s_mul_i32 s77, s84, 229376
    s_add_u32 s84, s85, 6
    s_sub_u32 s83, s84, 7
    s_cmp_gt_u32 s84, 7
    s_cselect_b32 s84, s83, s84
    s_lshl_b32 s62, s84, 7
    s_mul_i32 s70, s84, 196608
    s_mul_i32 s78, s84, 229376
    s_add_u32 s84, s85, 7
    s_sub_u32 s83, s84, 7
    s_cmp_gt_u32 s84, 7
    s_cselect_b32 s84, s83, s84
    s_lshl_b32 s63, s84, 7
    s_mul_i32 s71, s84, 196608
    s_mul_i32 s79, s84, 229376
    v_lshrrev_b32 v240, 5, v197
    v_bfe_u32 v241, v197, 1, 3
    v_xor_b32 v240, v240, v241
    v_lshlrev_b32 v240, 4, v240
    v_and_b32 v241, 31, v197
    v_lshl_add_u32 v240, v241, 7, v240
    s_lshl_b32 s83, s3, 6
    v_xor_b32 v240, s83, v240
    s_mul_i32 s84, s45, 8224
    v_add_u32 v174, s84, v240
    v_xor_b32 v241, 32, v240
    v_add_u32 v175, s84, v241
    v_xor_b32 v241, 64, v240
    v_add_u32 v176, s84, v241
    v_xor_b32 v241, 0x60, v240
    v_add_u32 v177, s84, v241
    v_and_b32 v240, 31, v197
    v_mov_b32 v241, 0x3f803f80
    v_cmp_eq_u32 vcc, 0, v240
    s_nop 1
    v_cndmask_b32 v144, 0, v241, vcc
    v_cmp_eq_u32 vcc, 20, v240
    s_nop 1
    v_cndmask_b32 v144, v144, v241, vcc
    v_cmp_eq_u32 vcc, 8, v240
    s_nop 1
    v_cndmask_b32 v148, 0, v241, vcc
    v_cmp_eq_u32 vcc, 28, v240
    s_nop 1
    v_cndmask_b32 v148, v148, v241, vcc
    v_mov_b32 v145, v144
    v_mov_b32 v149, v148
    v_mov_b32 v146, v144
    v_mov_b32 v150, v148
    v_mov_b32 v147, v144
    v_mov_b32 v151, v148
    v_lshrrev_b32 v240, 5, v197
    v_lshlrev_b32 v240, 10, v240
    v_bfe_u32 v241, v197, 2, 2
    v_lshl_add_u32 v240, v241, 7, v240
    v_and_b32 v241, 3, v197
    v_lshl_add_u32 v240, v241, 3, v240
    v_bfe_u32 v241, v197, 3, 1
    v_xor_b32 v241, s46, v241
    v_lshl_add_u32 v240, v241, 6, v240
    v_bfe_u32 v241, v197, 4, 1
    v_mul_u32_u24 v241, 8224, v241
    v_add_u32 v240, v240, v241
    s_lshl_b32 s83, s3, 12
    s_xor_b32 s84, s83, 4096
    v_add_u32 v240, 65792, v240
    v_add_u32 v178, s83, v240
    v_add_u32 v179, s84, v240
    s_lshl_b32 s83, s47, 1
    s_add_u32 s83, s83, s45
    s_lshl_b32 s84, s83, 2
    s_add_u32 s84, s84, s48
    s_lshl_b32 s84, s84, 5
    s_add_u32 s84, s84, s49
    s_lshl_b32 s84, s84, 1
    s_add_u32 s84, s84, s46
    s_lshl_b32 s84, s84, 2
    s_add_u32 s84, s84, 10747904
    v_mov_b32 v252, 1073741824
    v_writelane_b32 v252, s84, 0
    v_mov_b32 v96, 0
    s_lshl_b32 s83, s51, 2
    s_lshl_b32 s84, s46, 1
    s_add_u32 s83, s83, s84
    s_add_u32 s83, s83, s45
    s_mul_i32 s84, s83, 34816
    s_mul_i32 s83, s83, 2176
    s_add_u32 s83, s83, 10485760
    s_add_u32 s84, s84, 12582912
    v_and_b32 v240, 15, v197
    v_lshl_add_u32 v240, s47, 4, v240
    v_cmp_gt_u32 vcc, 0x88, v240
    v_lshlrev_b32 v240, 4, v240
    v_mov_b32 v241, 1073741824
    v_cndmask_b32 v240, v241, v240, vcc
    v_lshrrev_b32 v241, 4, v197
    v_lshl_add_u32 v154, v241, 2, v240
    v_add_u32 v154, s83, v154
    v_mul_u32_u24 v241, 2176, v241
    v_add3_u32 v153, v241, v240, s84
    v_mov_b32 v97, -1
    s_mov_b32 s54, 0
    s_mov_b32 s55, -1
    v_mov_b32 v170, 0
    v_mov_b32 v171, 0
    v_and_b32 v240, 3, v197
    v_cmp_eq_u32 s[86:87], 1, v240
    v_cmp_eq_u32 s[88:89], 2, v240
    v_cmp_eq_u32 s[90:91], 3, v240
    v_and_b32 v240, 4, v197
    v_cmp_eq_u32 s[92:93], 4, v240
    s_mul_i32 s94, s44, 458752
    s_lshl_b32 s95, s44, 17
    s_mov_b32 s96, 0x3b000000
    s_lshl_b32 s83, s47, 1
    s_add_u32 s83, s83, s45
    s_mul_i32 s83, s83, 144
    s_mul_i32 s84, s48, 36
    s_add_u32 s83, s83, s84
    s_lshl_b32 s84, s50, 2
    s_add_u32 s83, s83, s84
    s_lshl_b32 s84, s46, 1
    s_add_u32 s83, s83, s84
    s_lshl_b32 s83, s83, 11
    v_lshl_add_u32 v196, v197, 4, s83
    v_lshrrev_b32 v240, 3, v197
    v_lshlrev_b32 v240, 10, v240
    v_bfe_u32 v241, v197, 4, 1
    v_lshlrev_b32 v241, 2, v241
    v_xor_b32 v241, v241, v197
    v_and_b32 v241, 7, v241
    v_lshl_add_u32 v240, v241, 4, v240
    s_lshl_b32 s83, s53, 7
    v_add_u32 v198, s83, v240
    v_add_u32 v199, 7168, v198
    s_and_b32 s83, s2, 63
    s_lshl_b32 s83, s83, 2
    s_add_u32 s83, s83, 0
    s_cmp_eq_u32 s44, 0
    s_cselect_b32 s83, s83, 1073741824
    v_mov_b32 v208, 1073741824
    v_writelane_b32 v208, s83, 0
    s_lshl_b32 s83, s46, 8
    s_lshl_b32 s84, s45, 7
    s_add_u32 s83, s83, s84
    s_add_u32 s83, s83, 156416
    v_and_b32 v240, 31, v197
    v_lshl_add_u32 v191, v240, 2, s83
    v_lshrrev_b32 v240, 5, v197
    v_lshl_add_u32 v191, v240, 9, v191
    s_lshl_b32 s83, s51, 7
    s_mul_i32 s84, s44, 49152
    s_add_u32 s84, s84, s83
    v_lshrrev_b32 v240, 3, v197
    v_mul_u32_u24 v240, 3072, v240
    v_bfe_u32 v241, v197, 4, 1
    v_lshlrev_b32 v241, 2, v241
    v_xor_b32 v241, v241, v197
    v_and_b32 v241, 7, v241
    v_lshl_add_u32 v240, v241, 4, v240
    v_add_u32 v186, s84, v240
    v_add_u32 v187, 23552, v186
    s_lshl_b32 s83, s51, 1
    s_add_u32 s83, s83, s46
    s_mul_i32 s83, s83, 4352
    s_add_u32 s83, s83, 10485760
    v_and_b32 v240, 31, v197
    v_lshrrev_b32 v241, 5, v197
    v_lshl_add_u32 v242, v241, 4, v240
    v_add_u32 v241, 32, v241
    v_cmp_gt_u32 vcc, 16, v240
    s_nop 1
    v_cndmask_b32 v242, v241, v242, vcc
    v_lshl_add_u32 v152, v242, 4, s83
    s_waitcnt vmcnt(17)
    s_barrier
    ds_read_b128 a[0:3], v174 offset:0
    ds_read_b128 a[4:7], v174 offset:4096
    ds_read_b64_tr_b16 v[128:129], v178 offset:0
    ds_read_b64_tr_b16 v[130:131], v178 offset:512
    ds_read_b64_tr_b16 v[132:133], v178 offset:32
    ds_read_b64_tr_b16 v[134:135], v178 offset:544
    s_waitcnt lgkmcnt(2)
    v_mfma_f32_32x32x16_bf16 v[0:15], v[128:131], a[0:3], 0
    ds_read_b64_tr_b16 v[136:137], v178 offset:2048
    ds_read_b64_tr_b16 v[138:139], v178 offset:2560
    ds_read_b128 a[8:11], v175 offset:0
    v_mfma_f32_32x32x16_bf16 v[16:31], v[128:131], a[4:7], 0
    ds_read_b128 a[12:15], v175 offset:4096
    ds_read_b64_tr_b16 v[140:141], v178 offset:2080
    ds_read_b64_tr_b16 v[142:143], v178 offset:2592
    s_waitcnt lgkmcnt(6)
    v_mfma_f32_32x32x16_bf16 v[32:47], v[132:135], a[0:3], 0
    s_add_u32 m0, s80, 32896
    ds_read_b128 a[16:19], v176 offset:0
    buffer_load_dwordx4 v182, s[4:7], s58 offen lds
    v_mfma_f32_32x32x16_bf16 v[48:63], v[132:135], a[4:7], 0
    ds_read_b128 a[20:23], v176 offset:4096
    buffer_load_dwordx4 v183, s[4:7], s58 offen offset:1024 lds
    v_mfma_f32_4x4x4_16b_bf16 v[68:71], a[0:1], a[0:1], 0
    v_mfma_f32_4x4x4_16b_bf16 v[72:75], a[4:5], a[4:5], 0
    v_mfma_f32_4x4x4_16b_bf16 v[88:91], a[2:3], a[2:3], 0
    v_mfma_f32_4x4x4_16b_bf16 v[92:95], a[6:7], a[6:7], 0
    v_mfma_f32_16x16x32_bf16 v[64:67], v[144:147], a[0:3], 0
    v_mfma_f32_16x16x32_bf16 v[64:67], v[148:151], a[4:7], v[64:67]
    v_mfma_f32_16x16x32_bf16 v[156:159], v[144:147], v[128:131], 0
    v_mfma_f32_16x16x32_bf16 v[156:159], v[148:151], v[132:135], v[156:159]
    s_waitcnt lgkmcnt(2)
    v_mfma_f32_32x32x16_bf16 v[0:15], v[136:139], a[8:11], v[0:15]
    ds_read_b64_tr_b16 v[128:129], v179 offset:0
    ds_read_b64_tr_b16 v[130:131], v179 offset:512
    v_mfma_f32_32x32x16_bf16 v[16:31], v[136:139], a[12:15], v[16:31]
    ds_read_b64_tr_b16 v[132:133], v179 offset:32
    ds_read_b64_tr_b16 v[134:135], v179 offset:544
    v_mfma_f32_32x32x16_bf16 v[32:47], v[140:143], a[8:11], v[32:47]
    ds_read_b128 a[24:27], v177 offset:0
    buffer_load_dwordx4 v184, s[4:7], s58 offen offset:2048 lds
    v_mfma_f32_32x32x16_bf16 v[48:63], v[140:143], a[12:15], v[48:63]
    ds_read_b128 a[28:31], v177 offset:4096
    buffer_load_dwordx4 v185, s[4:7], s58 offen offset:3072 lds
    v_mfma_f32_4x4x4_16b_bf16 v[68:71], a[8:9], a[8:9], v[68:71]
    v_mfma_f32_4x4x4_16b_bf16 v[72:75], a[12:13], a[12:13], v[72:75]
    v_mfma_f32_4x4x4_16b_bf16 v[88:91], a[10:11], a[10:11], v[88:91]
    v_mfma_f32_4x4x4_16b_bf16 v[92:95], a[14:15], a[14:15], v[92:95]
    v_mfma_f32_16x16x32_bf16 v[64:67], v[144:147], a[8:11], v[64:67]
    v_mfma_f32_16x16x32_bf16 v[64:67], v[148:151], a[12:15], v[64:67]
    v_mfma_f32_16x16x32_bf16 v[156:159], v[144:147], v[136:139], v[156:159]
    v_mfma_f32_16x16x32_bf16 v[156:159], v[148:151], v[140:143], v[156:159]
    s_waitcnt lgkmcnt(2)
    v_mfma_f32_32x32x16_bf16 v[0:15], v[128:131], a[16:19], v[0:15]
    ds_read_b64_tr_b16 v[136:137], v179 offset:2048
    ds_read_b64_tr_b16 v[138:139], v179 offset:2560
    v_mfma_f32_32x32x16_bf16 v[16:31], v[128:131], a[20:23], v[16:31]
    ds_read_b64_tr_b16 v[140:141], v179 offset:2080
    ds_read_b64_tr_b16 v[142:143], v179 offset:2592
    s_add_u32 m0, s81, 98688
    v_mfma_f32_32x32x16_bf16 v[32:47], v[132:135], a[16:19], v[32:47]
    buffer_load_dwordx4 v188, s[12:15], s74 offen lds
    buffer_load_dwordx4 v189, s[12:15], s74 offen offset:1024 lds
    s_add_u32 m0, s81, 106912
    v_mfma_f32_32x32x16_bf16 v[48:63], v[132:135], a[20:23], v[48:63]
    buffer_load_dwordx4 v188, s[16:19], s74 offen lds
    buffer_load_dwordx4 v189, s[16:19], s74 offen offset:1024 lds
    s_mov_b64 exec, 0
    s_cmp_eq_u32 s44, 0
    s_cbranch_scc1 L_padB1_0
    s_cmp_eq_u32 s44, 1
    s_cbranch_scc1 L_padB1_1
    s_cmp_eq_u32 s44, 2
    s_cbranch_scc1 L_padB1_2
    s_branch L_padB1_3
L_retB1:
    s_mov_b64 exec, -1
    s_waitcnt vmcnt(8) lgkmcnt(0)
    s_barrier
    v_mfma_f32_32x32x16_bf16 v[0:15], v[136:139], a[24:27], v[0:15]
    ds_read_b64_tr_b16 v[128:129], v178 offset:16448
    ds_read_b64_tr_b16 v[130:131], v178 offset:16960
    ds_read_b128 a[32:35], v174 offset:16448
    v_mfma_f32_32x32x16_bf16 v[16:31], v[136:139], a[28:31], v[16:31]
    ds_read_b128 a[36:39], v174 offset:20544
    ds_read_b64_tr_b16 v[132:133], v178 offset:16480
    ds_read_b64_tr_b16 v[134:135], v178 offset:16992
    s_add_u32 m0, s80, 49344
    v_mfma_f32_32x32x16_bf16 v[32:47], v[140:143], a[24:27], v[32:47]
    buffer_load_dwordx4 v182, s[4:7], s59 offen lds
    v_mfma_f32_32x32x16_bf16 v[48:63], v[140:143], a[28:31], v[48:63]
    buffer_load_dwordx4 v183, s[4:7], s59 offen offset:1024 lds
    buffer_load_dwordx4 v184, s[4:7], s59 offen offset:2048 lds
    s_waitcnt lgkmcnt(0)
    v_mfma_f32_32x32x16_bf16 v[0:15], v[128:131], a[32:35], v[0:15]
    ds_read_b64_tr_b16 v[136:137], v178 offset:18496
    ds_read_b64_tr_b16 v[138:139], v178 offset:19008
    ds_read_b128 a[40:43], v175 offset:16448
    v_mfma_f32_32x32x16_bf16 v[16:31], v[128:131], a[36:39], v[16:31]
    ds_read_b128 a[44:47], v175 offset:20544
    ds_read_b64_tr_b16 v[140:141], v178 offset:18528
    ds_read_b64_tr_b16 v[142:143], v178 offset:19040
    v_mfma_f32_32x32x16_bf16 v[32:47], v[132:135], a[32:35], v[32:47]
    ds_read_b128 a[48:51], v176 offset:16448
    buffer_load_dwordx4 v185, s[4:7], s59 offen offset:3072 lds
    v_mfma_f32_32x32x16_bf16 v[48:63], v[132:135], a[36:39], v[48:63]
    s_add_u32 m0, s81, 115136
    ds_read_b128 a[52:55], v176 offset:20544
    buffer_load_dwordx4 v188, s[12:15], s75 offen lds
    buffer_load_dwordx4 v189, s[12:15], s75 offen offset:1024 lds
    v_mfma_f32_4x4x4_16b_bf16 v[68:71], a[32:33], a[32:33], v[68:71]
    v_mfma_f32_4x4x4_16b_bf16 v[72:75], a[36:37], a[36:37], v[72:75]
    v_mfma_f32_4x4x4_16b_bf16 v[88:91], a[34:35], a[34:35], v[88:91]
    v_mfma_f32_4x4x4_16b_bf16 v[92:95], a[38:39], a[38:39], v[92:95]
    v_mfma_f32_16x16x32_bf16 v[64:67], v[144:147], a[32:35], v[64:67]
    v_mfma_f32_16x16x32_bf16 v[64:67], v[148:151], a[36:39], v[64:67]
    v_mfma_f32_16x16x32_bf16 v[156:159], v[144:147], v[128:131], v[156:159]
    v_mfma_f32_16x16x32_bf16 v[156:159], v[148:151], v[132:135], v[156:159]
    s_waitcnt lgkmcnt(2)
    v_mfma_f32_32x32x16_bf16 v[0:15], v[136:139], a[40:43], v[0:15]
    ds_read_b64_tr_b16 v[128:129], v179 offset:16448
    ds_read_b64_tr_b16 v[130:131], v179 offset:16960
    v_mfma_f32_32x32x16_bf16 v[16:31], v[136:139], a[44:47], v[16:31]
    ds_read_b64_tr_b16 v[132:133], v179 offset:16480
    ds_read_b64_tr_b16 v[134:135], v179 offset:16992
    v_mfma_f32_32x32x16_bf16 v[32:47], v[140:143], a[40:43], v[32:47]
    ds_read_b128 a[56:59], v177 offset:16448
    buffer_store_dword v96, v252, s[28:31], 0 offen sc1
    v_mfma_f32_32x32x16_bf16 v[48:63], v[140:143], a[44:47], v[48:63]
    ds_read_b128 a[60:63], v177 offset:20544
    v_mfma_f32_4x4x4_16b_bf16 v[68:71], a[40:41], a[40:41], v[68:71]
    v_mfma_f32_4x4x4_16b_bf16 v[72:75], a[44:45], a[44:45], v[72:75]
    v_mfma_f32_4x4x4_16b_bf16 v[88:91], a[42:43], a[42:43], v[88:91]
    v_mfma_f32_4x4x4_16b_bf16 v[92:95], a[46:47], a[46:47], v[92:95]
L_padB1_0:
    s_cbranch_execz L_padB1_4
    v_mfma_f32_16x16x32_bf16 v[64:67], v[144:147], a[40:43], v[64:67]
    v_mfma_f32_16x16x32_bf16 v[64:67], v[148:151], a[44:47], v[64:67]
    v_mfma_f32_16x16x32_bf16 v[156:159], v[144:147], v[136:139], v[156:159]
    v_mfma_f32_16x16x32_bf16 v[156:159], v[148:151], v[140:143], v[156:159]
    s_waitcnt lgkmcnt(2)
    v_mfma_f32_32x32x16_bf16 v[0:15], v[128:131], a[48:51], v[0:15]
    ds_read_b64_tr_b16 v[136:137], v179 offset:18496
    ds_read_b64_tr_b16 v[138:139], v179 offset:19008
    v_mfma_f32_32x32x16_bf16 v[16:31], v[128:131], a[52:55], v[16:31]
    ds_read_b64_tr_b16 v[140:141], v179 offset:18528
    ds_read_b64_tr_b16 v[142:143], v179 offset:19040
    s_add_u32 m0, s81, 123360
    v_mfma_f32_32x32x16_bf16 v[32:47], v[132:135], a[48:51], v[32:47]
    buffer_load_dwordx4 v188, s[16:19], s75 offen lds
    buffer_load_dwordx4 v189, s[16:19], s75 offen offset:1024 lds
    v_mfma_f32_32x32x16_bf16 v[48:63], v[132:135], a[52:55], v[48:63]
    buffer_store_dword v97, v154, s[28:31], 0 offen sc1
    s_waitcnt vmcnt(10) lgkmcnt(0)
    s_barrier
    v_mfma_f32_32x32x16_bf16 v[0:15], v[136:139], a[56:59], v[0:15]
    ds_read_b64_tr_b16 v[128:129], v178 offset:32896
    ds_read_b64_tr_b16 v[130:131], v178 offset:33408
    ds_read_b128 a[64:67], v174 offset:32896
    v_mfma_f32_32x32x16_bf16 v[16:31], v[136:139], a[60:63], v[16:31]
    ds_read_b128 a[68:71], v174 offset:36992
    ds_read_b64_tr_b16 v[132:133], v178 offset:32928
    ds_read_b64_tr_b16 v[134:135], v178 offset:33440
    s_add_u32 m0, s80, 0
    v_mfma_f32_32x32x16_bf16 v[32:47], v[140:143], a[56:59], v[32:47]
    buffer_load_dwordx4 v182, s[4:7], s60 offen lds
    v_mfma_f32_32x32x16_bf16 v[48:63], v[140:143], a[60:63], v[48:63]
    buffer_load_dwordx4 v183, s[4:7], s60 offen offset:1024 lds
    buffer_load_dwordx4 v184, s[4:7], s60 offen offset:2048 lds
    s_waitcnt lgkmcnt(0)
    v_mfma_f32_32x32x16_bf16 v[0:15], v[128:131], a[64:67], v[0:15]
    ds_read_b64_tr_b16 v[136:137], v178 offset:34944
    ds_read_b64_tr_b16 v[138:139], v178 offset:35456
    ds_read_b128 a[72:75], v175 offset:32896
    v_mfma_f32_32x32x16_bf16 v[16:31], v[128:131], a[68:71], v[16:31]
    ds_read_b128 a[76:79], v175 offset:36992
    ds_read_b64_tr_b16 v[140:141], v178 offset:34976
    ds_read_b64_tr_b16 v[142:143], v178 offset:35488
    v_mfma_f32_32x32x16_bf16 v[32:47], v[132:135], a[64:67], v[32:47]
    ds_read_b128 a[80:83], v176 offset:32896
    buffer_load_dwordx4 v185, s[4:7], s60 offen offset:3072 lds
    v_mfma_f32_32x32x16_bf16 v[48:63], v[132:135], a[68:71], v[48:63]
    s_add_u32 m0, s81, 65792
    ds_read_b128 a[84:87], v176 offset:36992
    buffer_load_dwordx4 v188, s[12:15], s76 offen lds
    buffer_load_dwordx4 v189, s[12:15], s76 offen offset:1024 lds
    v_mfma_f32_4x4x4_16b_bf16 v[68:71], a[64:65], a[64:65], v[68:71]
    v_mfma_f32_4x4x4_16b_bf16 v[72:75], a[68:69], a[68:69], v[72:75]
    v_mfma_f32_4x4x4_16b_bf16 v[88:91], a[66:67], a[66:67], v[88:91]
    v_mfma_f32_4x4x4_16b_bf16 v[92:95], a[70:71], a[70:71], v[92:95]
    v_mfma_f32_16x16x32_bf16 v[64:67], v[144:147], a[64:67], v[64:67]
    v_mfma_f32_16x16x32_bf16 v[64:67], v[148:151], a[68:71], v[64:67]
    v_mfma_f32_16x16x32_bf16 v[156:159], v[144:147], v[128:131], v[156:159]
    v_mfma_f32_16x16x32_bf16 v[156:159], v[148:151], v[132:135], v[156:159]
    s_waitcnt lgkmcnt(2)
    v_mfma_f32_32x32x16_bf16 v[0:15], v[136:139], a[72:75], v[0:15]
    ds_read_b64_tr_b16 v[128:129], v179 offset:32896
    ds_read_b64_tr_b16 v[130:131], v179 offset:33408
    s_lshl_b32 s83, s52, 2
    s_add_u32 s83, s83, s44
    s_lshl_b32 s83, s83, 14
    s_lshl_b32 s84, s53, 7
    s_add_u32 s83, s83, s84
    v_and_b32 v103, 3, v197
    v_lshlrev_b32 v103, 12, v103
    v_add_u32 v103, s83, v103
    buffer_store_dword v197, v103, s[32:35], 0 offen sc1
    v_mfma_f32_32x32x16_bf16 v[16:31], v[136:139], a[76:79], v[16:31]
    ds_read_b64_tr_b16 v[132:133], v179 offset:32928
    ds_read_b64_tr_b16 v[134:135], v179 offset:33440
    v_mfma_f32_32x32x16_bf16 v[32:47], v[140:143], a[72:75], v[32:47]
    ds_read_b128 a[88:91], v177 offset:32896
    v_mfma_f32_32x32x16_bf16 v[48:63], v[140:143], a[76:79], v[48:63]
    ds_read_b128 a[92:95], v177 offset:36992
    v_mfma_f32_4x4x4_16b_bf16 v[68:71], a[72:73], a[72:73], v[68:71]
    v_mfma_f32_4x4x4_16b_bf16 v[72:75], a[76:77], a[76:77], v[72:75]
    v_mfma_f32_4x4x4_16b_bf16 v[88:91], a[74:75], a[74:75], v[88:91]
    v_mfma_f32_4x4x4_16b_bf16 v[92:95], a[78:79], a[78:79], v[92:95]
    v_mfma_f32_16x16x32_bf16 v[64:67], v[144:147], a[72:75], v[64:67]
    v_mfma_f32_16x16x32_bf16 v[64:67], v[148:151], a[76:79], v[64:67]
    v_mfma_f32_16x16x32_bf16 v[156:159], v[144:147], v[136:139], v[156:159]
    v_mfma_f32_16x16x32_bf16 v[156:159], v[148:151], v[140:143], v[156:159]
    s_waitcnt lgkmcnt(2)
    v_mfma_f32_32x32x16_bf16 v[0:15], v[128:131], a[80:83], v[0:15]
    ds_read_b64_tr_b16 v[136:137], v179 offset:34944
    ds_read_b64_tr_b16 v[138:139], v179 offset:35456
    v_mfma_f32_32x32x16_bf16 v[16:31], v[128:131], a[84:87], v[16:31]
    ds_read_b64_tr_b16 v[140:141], v179 offset:34976
    ds_read_b64_tr_b16 v[142:143], v179 offset:35488
    s_add_u32 m0, s81, 74016
    v_mfma_f32_32x32x16_bf16 v[32:47], v[132:135], a[80:83], v[32:47]
    buffer_load_dwordx4 v188, s[16:19], s76 offen lds
    buffer_load_dwordx4 v189, s[16:19], s76 offen offset:1024 lds
    v_mfma_f32_32x32x16_bf16 v[48:63], v[132:135], a[84:87], v[48:63]
    s_waitcnt vmcnt(10) lgkmcnt(0)
    s_barrier
    v_mfma_f32_32x32x16_bf16 v[0:15], v[136:139], a[88:91], v[0:15]
    ds_read_b64_tr_b16 v[128:129], v178 offset:49344
    ds_read_b64_tr_b16 v[130:131], v178 offset:49856
    ds_read_b128 a[96:99], v174 offset:49344
    s_lshl_b32 s83, s2, 2
    s_add_u32 s83, s83, s44
    s_mul_i32 s84, s83, 1792
    v_min_u32 v120, 13, v197
    v_lshl_add_u32 v120, v120, 7, s84
    buffer_load_dword v121, v120, s[20:23], 0 offen
    s_mul_i32 s84, s83, 512
    v_min_u32 v120, 3, v197
    v_lshl_add_u32 v120, v120, 7, s84
    buffer_load_dword v122, v120, s[24:27], 0 offen
    v_mfma_f32_32x32x16_bf16 v[16:31], v[136:139], a[92:95], v[16:31]
    ds_read_b128 a[100:103], v174 offset:53440
    ds_read_b64_tr_b16 v[132:133], v178 offset:49376
    ds_read_b64_tr_b16 v[134:135], v178 offset:49888
    s_add_u32 m0, s80, 16448
    v_mfma_f32_32x32x16_bf16 v[32:47], v[140:143], a[88:91], v[32:47]
    buffer_load_dwordx4 v182, s[4:7], s61 offen lds
    v_mfma_f32_32x32x16_bf16 v[48:63], v[140:143], a[92:95], v[48:63]
    buffer_load_dwordx4 v183, s[4:7], s61 offen offset:1024 lds
    buffer_load_dwordx4 v184, s[4:7], s61 offen offset:2048 lds
    s_waitcnt lgkmcnt(0)
    v_mfma_f32_32x32x16_bf16 v[0:15], v[128:131], a[96:99], v[0:15]
    ds_read_b64_tr_b16 v[136:137], v178 offset:51392
    ds_read_b64_tr_b16 v[138:139], v178 offset:51904
    ds_read_b128 a[104:107], v175 offset:49344
    v_mfma_f32_32x32x16_bf16 v[16:31], v[128:131], a[100:103], v[16:31]
    ds_read_b128 a[108:111], v175 offset:53440
    ds_read_b64_tr_b16 v[140:141], v178 offset:51424
    ds_read_b64_tr_b16 v[142:143], v178 offset:51936
    v_mfma_f32_32x32x16_bf16 v[32:47], v[132:135], a[96:99], v[32:47]
    ds_read_b128 a[112:115], v176 offset:49344
    buffer_load_dwordx4 v185, s[4:7], s61 offen offset:3072 lds
    v_mfma_f32_32x32x16_bf16 v[48:63], v[132:135], a[100:103], v[48:63]
    s_add_u32 m0, s81, 82240
L_padB1_1:
    s_cbranch_execz L_padB1_5
    ds_read_b128 a[116:119], v176 offset:53440
    buffer_load_dwordx4 v188, s[12:15], s77 offen lds
    buffer_load_dwordx4 v189, s[12:15], s77 offen offset:1024 lds
    v_mfma_f32_4x4x4_16b_bf16 v[68:71], a[96:97], a[96:97], v[68:71]
    v_mfma_f32_4x4x4_16b_bf16 v[72:75], a[100:101], a[100:101], v[72:75]
    v_mfma_f32_4x4x4_16b_bf16 v[88:91], a[98:99], a[98:99], v[88:91]
    v_mfma_f32_4x4x4_16b_bf16 v[92:95], a[102:103], a[102:103], v[92:95]
    v_mfma_f32_16x16x32_bf16 v[64:67], v[144:147], a[96:99], v[64:67]
    v_mfma_f32_16x16x32_bf16 v[64:67], v[148:151], a[100:103], v[64:67]
    v_mfma_f32_16x16x32_bf16 v[156:159], v[144:147], v[128:131], v[156:159]
    v_mfma_f32_16x16x32_bf16 v[156:159], v[148:151], v[132:135], v[156:159]
    s_waitcnt lgkmcnt(2)
    v_mfma_f32_32x32x16_bf16 v[0:15], v[136:139], a[104:107], v[0:15]
    ds_read_b64_tr_b16 v[128:129], v179 offset:49344
    ds_read_b64_tr_b16 v[130:131], v179 offset:49856
    v_mfma_f32_32x32x16_bf16 v[16:31], v[136:139], a[108:111], v[16:31]
    ds_read_b64_tr_b16 v[132:133], v179 offset:49376
    ds_read_b64_tr_b16 v[134:135], v179 offset:49888
    v_mfma_f32_32x32x16_bf16 v[32:47], v[140:143], a[104:107], v[32:47]
    ds_read_b128 a[120:123], v177 offset:49344
    v_mfma_f32_32x32x16_bf16 v[48:63], v[140:143], a[108:111], v[48:63]
    ds_read_b128 a[124:127], v177 offset:53440
    v_mfma_f32_4x4x4_16b_bf16 v[68:71], a[104:105], a[104:105], v[68:71]
    v_mfma_f32_4x4x4_16b_bf16 v[72:75], a[108:109], a[108:109], v[72:75]
    v_mfma_f32_4x4x4_16b_bf16 v[88:91], a[106:107], a[106:107], v[88:91]
    v_mfma_f32_4x4x4_16b_bf16 v[92:95], a[110:111], a[110:111], v[92:95]
    v_mfma_f32_16x16x32_bf16 v[64:67], v[144:147], a[104:107], v[64:67]
    v_mfma_f32_16x16x32_bf16 v[64:67], v[148:151], a[108:111], v[64:67]
    v_mfma_f32_16x16x32_bf16 v[156:159], v[144:147], v[136:139], v[156:159]
    v_mfma_f32_16x16x32_bf16 v[156:159], v[148:151], v[140:143], v[156:159]
    s_waitcnt lgkmcnt(2)
    v_mfma_f32_32x32x16_bf16 v[0:15], v[128:131], a[112:115], v[0:15]
    ds_read_b64_tr_b16 v[136:137], v179 offset:51392
    ds_read_b64_tr_b16 v[138:139], v179 offset:51904
    v_mfma_f32_32x32x16_bf16 v[16:31], v[128:131], a[116:119], v[16:31]
    ds_read_b64_tr_b16 v[140:141], v179 offset:51424
    ds_read_b64_tr_b16 v[142:143], v179 offset:51936
    s_add_u32 m0, s81, 90464
    v_mfma_f32_32x32x16_bf16 v[32:47], v[132:135], a[112:115], v[32:47]
    buffer_load_dwordx4 v188, s[16:19], s77 offen lds
    buffer_load_dwordx4 v189, s[16:19], s77 offen offset:1024 lds
    v_mfma_f32_32x32x16_bf16 v[48:63], v[132:135], a[116:119], v[48:63]
    s_waitcnt vmcnt(10) lgkmcnt(0)
    s_barrier
    v_mfma_f32_32x32x16_bf16 v[0:15], v[136:139], a[120:123], v[0:15]
    ds_read_b64_tr_b16 v[128:129], v178 offset:0
    ds_read_b64_tr_b16 v[130:131], v178 offset:512
    ds_read_b128 a[128:131], v174 offset:0
    v_mfma_f32_32x32x16_bf16 v[16:31], v[136:139], a[124:127], v[16:31]
    ds_read_b128 a[132:135], v174 offset:4096
    ds_read_b64_tr_b16 v[132:133], v178 offset:32
    ds_read_b64_tr_b16 v[134:135], v178 offset:544
    s_add_u32 m0, s80, 32896
    v_mfma_f32_32x32x16_bf16 v[32:47], v[140:143], a[120:123], v[32:47]
    buffer_load_dwordx4 v182, s[4:7], s62 offen lds
    v_mfma_f32_32x32x16_bf16 v[48:63], v[140:143], a[124:127], v[48:63]
    buffer_load_dwordx4 v183, s[4:7], s62 offen offset:1024 lds
    buffer_load_dwordx4 v184, s[4:7], s62 offen offset:2048 lds
    s_waitcnt lgkmcnt(0)
    v_mfma_f32_32x32x16_bf16 v[0:15], v[128:131], a[128:131], v[0:15]
    ds_read_b64_tr_b16 v[136:137], v178 offset:2048
    ds_read_b64_tr_b16 v[138:139], v178 offset:2560
    ds_read_b128 a[136:139], v175 offset:0
    v_mfma_f32_32x32x16_bf16 v[16:31], v[128:131], a[132:135], v[16:31]
    ds_read_b128 a[140:143], v175 offset:4096
    ds_read_b64_tr_b16 v[140:141], v178 offset:2080
    ds_read_b64_tr_b16 v[142:143], v178 offset:2592
    v_mfma_f32_32x32x16_bf16 v[32:47], v[132:135], a[128:131], v[32:47]
    ds_read_b128 a[144:147], v176 offset:0
    buffer_load_dwordx4 v185, s[4:7], s62 offen offset:3072 lds
    v_mfma_f32_32x32x16_bf16 v[48:63], v[132:135], a[132:135], v[48:63]
    s_add_u32 m0, s81, 98688
    ds_read_b128 a[148:151], v176 offset:4096
    buffer_load_dwordx4 v188, s[12:15], s78 offen lds
    buffer_load_dwordx4 v189, s[12:15], s78 offen offset:1024 lds
    v_mfma_f32_4x4x4_16b_bf16 v[68:71], a[128:129], a[128:129], v[68:71]
    v_mfma_f32_4x4x4_16b_bf16 v[72:75], a[132:133], a[132:133], v[72:75]
    v_mfma_f32_4x4x4_16b_bf16 v[88:91], a[130:131], a[130:131], v[88:91]
    v_mfma_f32_4x4x4_16b_bf16 v[92:95], a[134:135], a[134:135], v[92:95]
    v_mfma_f32_16x16x32_bf16 v[64:67], v[144:147], a[128:131], v[64:67]
    v_mfma_f32_16x16x32_bf16 v[64:67], v[148:151], a[132:135], v[64:67]
    v_mfma_f32_16x16x32_bf16 v[156:159], v[144:147], v[128:131], v[156:159]
    v_mfma_f32_16x16x32_bf16 v[156:159], v[148:151], v[132:135], v[156:159]
    s_waitcnt lgkmcnt(2)
    v_mfma_f32_32x32x16_bf16 v[0:15], v[136:139], a[136:139], v[0:15]
    ds_read_b64_tr_b16 v[128:129], v179 offset:0
    ds_read_b64_tr_b16 v[130:131], v179 offset:512
    v_mfma_f32_32x32x16_bf16 v[16:31], v[136:139], a[140:143], v[16:31]
    ds_read_b64_tr_b16 v[132:133], v179 offset:32
    ds_read_b64_tr_b16 v[134:135], v179 offset:544
    v_mfma_f32_32x32x16_bf16 v[32:47], v[140:143], a[136:139], v[32:47]
    ds_read_b128 a[152:155], v177 offset:0
    v_mfma_f32_32x32x16_bf16 v[48:63], v[140:143], a[140:143], v[48:63]
    ds_read_b128 a[156:159], v177 offset:4096
    v_mfma_f32_4x4x4_16b_bf16 v[68:71], a[136:137], a[136:137], v[68:71]
    v_mfma_f32_4x4x4_16b_bf16 v[72:75], a[140:141], a[140:141], v[72:75]
    v_mfma_f32_4x4x4_16b_bf16 v[88:91], a[138:139], a[138:139], v[88:91]
    v_mfma_f32_4x4x4_16b_bf16 v[92:95], a[142:143], a[142:143], v[92:95]
    v_mfma_f32_16x16x32_bf16 v[64:67], v[144:147], a[136:139], v[64:67]
    v_mfma_f32_16x16x32_bf16 v[64:67], v[148:151], a[140:143], v[64:67]
    v_mfma_f32_16x16x32_bf16 v[156:159], v[144:147], v[136:139], v[156:159]
    v_mfma_f32_16x16x32_bf16 v[156:159], v[148:151], v[140:143], v[156:159]
    s_waitcnt lgkmcnt(2)
    v_mfma_f32_32x32x16_bf16 v[0:15], v[128:131], a[144:147], v[0:15]
    ds_read_b64_tr_b16 v[136:137], v179 offset:2048
    ds_read_b64_tr_b16 v[138:139], v179 offset:2560
    v_mfma_f32_32x32x16_bf16 v[16:31], v[128:131], a[148:151], v[16:31]
    ds_read_b64_tr_b16 v[140:141], v179 offset:2080
    ds_read_b64_tr_b16 v[142:143], v179 offset:2592
    s_add_u32 m0, s81, 106912
    v_mfma_f32_32x32x16_bf16 v[32:47], v[132:135], a[144:147], v[32:47]
    buffer_load_dwordx4 v188, s[16:19], s78 offen lds
    buffer_load_dwordx4 v189, s[16:19], s78 offen offset:1024 lds
    v_mfma_f32_32x32x16_bf16 v[48:63], v[132:135], a[148:151], v[48:63]
    s_waitcnt vmcnt(8) lgkmcnt(0)
    s_barrier
    v_mfma_f32_32x32x16_bf16 v[0:15], v[136:139], a[152:155], v[0:15]
    ds_read_b64_tr_b16 v[128:129], v178 offset:16448
    ds_read_b64_tr_b16 v[130:131], v178 offset:16960
    ds_read_b128 a[160:163], v174 offset:16448
    v_mov_b32 v209, 1
    buffer_atomic_add v209, v208, s[36:39], 0 offen
    v_mfma_f32_32x32x16_bf16 v[16:31], v[136:139], a[156:159], v[16:31]
    ds_read_b128 a[164:167], v174 offset:20544
    ds_read_b64_tr_b16 v[132:133], v178 offset:16480
    ds_read_b64_tr_b16 v[134:135], v178 offset:16992
    s_add_u32 m0, s80, 49344
    v_mfma_f32_32x32x16_bf16 v[32:47], v[140:143], a[152:155], v[32:47]
    buffer_load_dwordx4 v182, s[4:7], s63 offen lds
    v_mfma_f32_32x32x16_bf16 v[48:63], v[140:143], a[156:159], v[48:63]
    buffer_load_dwordx4 v183, s[4:7], s63 offen offset:1024 lds
    buffer_load_dwordx4 v184, s[4:7], s63 offen offset:2048 lds
    s_waitcnt lgkmcnt(0)
L_padB0_0:
    s_cbranch_execz L_padB0_4
    v_mfma_f32_32x32x16_bf16 v[0:15], v[128:131], a[160:163], v[0:15]
    ds_read_b64_tr_b16 v[136:137], v178 offset:18496
    ds_read_b64_tr_b16 v[138:139], v178 offset:19008
    ds_read_b128 a[168:171], v175 offset:16448
    v_mfma_f32_32x32x16_bf16 v[16:31], v[128:131], a[164:167], v[16:31]
    ds_read_b128 a[172:175], v175 offset:20544
    ds_read_b64_tr_b16 v[140:141], v178 offset:18528
    ds_read_b64_tr_b16 v[142:143], v178 offset:19040
    v_mfma_f32_32x32x16_bf16 v[32:47], v[132:135], a[160:163], v[32:47]
    ds_read_b128 a[176:179], v176 offset:16448
    buffer_load_dwordx4 v185, s[4:7], s63 offen offset:3072 lds
    v_mfma_f32_32x32x16_bf16 v[48:63], v[132:135], a[164:167], v[48:63]
    s_add_u32 m0, s81, 115136
    ds_read_b128 a[180:183], v176 offset:20544
    buffer_load_dwordx4 v188, s[12:15], s79 offen lds
    buffer_load_dwordx4 v189, s[12:15], s79 offen offset:1024 lds
    v_mfma_f32_4x4x4_16b_bf16 v[68:71], a[160:161], a[160:161], v[68:71]
    v_mfma_f32_4x4x4_16b_bf16 v[72:75], a[164:165], a[164:165], v[72:75]
    v_mfma_f32_4x4x4_16b_bf16 v[88:91], a[162:163], a[162:163], v[88:91]
    v_mfma_f32_4x4x4_16b_bf16 v[92:95], a[166:167], a[166:167], v[92:95]
    v_mfma_f32_16x16x32_bf16 v[64:67], v[144:147], a[160:163], v[64:67]
    v_mfma_f32_16x16x32_bf16 v[64:67], v[148:151], a[164:167], v[64:67]
    v_mfma_f32_16x16x32_bf16 v[156:159], v[144:147], v[128:131], v[156:159]
    v_mfma_f32_16x16x32_bf16 v[156:159], v[148:151], v[132:135], v[156:159]
    s_waitcnt lgkmcnt(2)
    v_mfma_f32_32x32x16_bf16 v[0:15], v[136:139], a[168:171], v[0:15]
    ds_read_b64_tr_b16 v[128:129], v179 offset:16448
    ds_read_b64_tr_b16 v[130:131], v179 offset:16960
    v_and_b32 v248, 16, v197
    v_cmp_eq_u32 vcc, 0, v248
    v_lshl_or_b32 v80, v81, 16, v80
    s_nop 0
    v_cndmask_b32 v200, 0, v80, vcc
    v_cndmask_b32 v204, v80, 0, vcc
    v_lshl_or_b32 v82, v83, 16, v82
    v_cndmask_b32 v201, 0, v82, vcc
    v_cndmask_b32 v205, v82, 0, vcc
    v_lshl_or_b32 v84, v85, 16, v84
    v_cndmask_b32 v202, 0, v84, vcc
    v_cndmask_b32 v206, v84, 0, vcc
    v_lshl_or_b32 v86, v87, 16, v86
    v_cndmask_b32 v203, 0, v86, vcc
    v_cndmask_b32 v207, v86, 0, vcc
    v_mfma_f32_32x32x16_bf16 v[16:31], v[136:139], a[172:175], v[16:31]
    ds_read_b64_tr_b16 v[132:133], v179 offset:16480
    ds_read_b64_tr_b16 v[134:135], v179 offset:16992
    v_mfma_f32_32x32x16_bf16 v[32:47], v[140:143], a[168:171], v[32:47]
    ds_read_b128 a[184:187], v177 offset:16448
    v_mfma_f32_32x32x16_bf16 v[48:63], v[140:143], a[172:175], v[48:63]
    ds_read_b128 a[188:191], v177 offset:20544
    v_mfma_f32_4x4x4_16b_bf16 v[68:71], a[168:169], a[168:169], v[68:71]
    v_mfma_f32_4x4x4_16b_bf16 v[72:75], a[172:173], a[172:173], v[72:75]
    v_mfma_f32_4x4x4_16b_bf16 v[88:91], a[170:171], a[170:171], v[88:91]
    v_mfma_f32_4x4x4_16b_bf16 v[92:95], a[174:175], a[174:175], v[92:95]
    v_mfma_f32_16x16x32_bf16 v[64:67], v[144:147], a[168:171], v[64:67]
    v_mfma_f32_16x16x32_bf16 v[64:67], v[148:151], a[172:175], v[64:67]
    v_mfma_f32_16x16x32_bf16 v[156:159], v[144:147], v[136:139], v[156:159]
    v_mfma_f32_16x16x32_bf16 v[156:159], v[148:151], v[140:143], v[156:159]
    s_waitcnt lgkmcnt(2)
    v_mfma_f32_32x32x16_bf16 v[0:15], v[128:131], a[176:179], v[0:15]
    ds_read_b64_tr_b16 v[136:137], v179 offset:18496
    ds_read_b64_tr_b16 v[138:139], v179 offset:19008
    v_mfma_f32_32x32x16_bf16 v[16:31], v[128:131], a[180:183], v[16:31]
    ds_read_b64_tr_b16 v[140:141], v179 offset:18528
    ds_read_b64_tr_b16 v[142:143], v179 offset:19040
    s_add_u32 m0, s81, 123360
    v_mfma_f32_32x32x16_bf16 v[32:47], v[132:135], a[176:179], v[32:47]
    buffer_load_dwordx4 v188, s[16:19], s79 offen lds
    buffer_load_dwordx4 v189, s[16:19], s79 offen offset:1024 lds
    v_mfma_f32_32x32x16_bf16 v[48:63], v[132:135], a[180:183], v[48:63]
    s_waitcnt vmcnt(9) lgkmcnt(0)
    s_barrier
    v_mfma_f32_32x32x16_bf16 v[0:15], v[136:139], a[184:187], v[0:15]
    ds_read_b64_tr_b16 v[128:129], v178 offset:32896
    ds_read_b64_tr_b16 v[130:131], v178 offset:33408
    ds_read_b128 a[192:195], v174 offset:32896
    v_mfma_f32_32x32x16_bf16 v[16:31], v[136:139], a[188:191], v[16:31]
    ds_read_b128 a[196:199], v174 offset:36992
    ds_read_b64_tr_b16 v[132:133], v178 offset:32928
    ds_read_b64_tr_b16 v[134:135], v178 offset:33440
    v_mfma_f32_32x32x16_bf16 v[32:47], v[140:143], a[184:187], v[32:47]
    s_add_u32 m0, s81, 0
    s_add_u32 s83, s72, 256
    buffer_load_dwordx4 v188, s[12:15], s83 offen lds
    buffer_load_dwordx4 v189, s[12:15], s83 offen offset:1024 lds
    v_mfma_f32_32x32x16_bf16 v[48:63], v[140:143], a[188:191], v[48:63]
    v_lshrrev_b32 v248, 5, v197
    v_lshlrev_b32 v248, 10, v248
    s_and_b32 s56, s53, 3
    s_lshl_b32 s56, s56, 1
    s_add_u32 s56, s56, s52
    s_and_b32 s56, s56, 7
    s_lshl_b32 s56, s56, 11
    s_waitcnt lgkmcnt(0)
    v_mfma_f32_32x32x16_bf16 v[0:15], v[128:131], a[192:195], v[0:15]
    ds_read_b64_tr_b16 v[136:137], v178 offset:34944
    ds_read_b64_tr_b16 v[138:139], v178 offset:35456
    ds_read_b128 a[200:203], v175 offset:32896
    v_mfma_f32_32x32x16_bf16 v[16:31], v[128:131], a[196:199], v[16:31]
    ds_read_b128 a[204:207], v175 offset:36992
    ds_read_b64_tr_b16 v[140:141], v178 offset:34976
    ds_read_b64_tr_b16 v[142:143], v178 offset:35488
    v_mfma_f32_32x32x16_bf16 v[32:47], v[132:135], a[192:195], v[32:47]
    ds_read_b128 a[208:211], v176 offset:32896
    s_add_u32 m0, s81, 8224
    s_add_u32 s83, s72, 256
    buffer_load_dwordx4 v188, s[16:19], s83 offen lds
    buffer_load_dwordx4 v189, s[16:19], s83 offen offset:1024 lds
    v_mfma_f32_32x32x16_bf16 v[48:63], v[132:135], a[196:199], v[48:63]
    ds_read_b128 a[212:215], v176 offset:36992
    v_bfe_u32 v249, v197, 2, 2
    v_mfma_f32_4x4x4_16b_bf16 v[68:71], a[192:193], a[192:193], v[68:71]
    v_mfma_f32_4x4x4_16b_bf16 v[72:75], a[196:197], a[196:197], v[72:75]
    v_mfma_f32_4x4x4_16b_bf16 v[88:91], a[194:195], a[194:195], v[88:91]
    v_mfma_f32_4x4x4_16b_bf16 v[92:95], a[198:199], a[198:199], v[92:95]
    v_mfma_f32_16x16x32_bf16 v[64:67], v[144:147], a[192:195], v[64:67]
    v_mfma_f32_16x16x32_bf16 v[64:67], v[148:151], a[196:199], v[64:67]
    v_mfma_f32_16x16x32_bf16 v[156:159], v[144:147], v[128:131], v[156:159]
    v_mfma_f32_16x16x32_bf16 v[156:159], v[148:151], v[132:135], v[156:159]
    s_waitcnt lgkmcnt(2)
    v_mfma_f32_32x32x16_bf16 v[0:15], v[136:139], a[200:203], v[0:15]
    ds_read_b64_tr_b16 v[128:129], v179 offset:32896
    ds_read_b64_tr_b16 v[130:131], v179 offset:33408
    v_mfma_f32_32x32x16_bf16 v[16:31], v[136:139], a[204:207], v[16:31]
    ds_read_b64_tr_b16 v[132:133], v179 offset:32928
    ds_read_b64_tr_b16 v[134:135], v179 offset:33440
    s_add_u32 s57, s56, 2048
    s_and_b32 s57, s57, 0x3800
    v_mfma_f32_32x32x16_bf16 v[32:47], v[140:143], a[200:203], v[32:47]
    ds_read_b128 a[216:219], v177 offset:32896
    v_lshl_add_u32 v248, v249, 7, v248
    s_add_u32 s58, s57, 2048
    s_and_b32 s58, s58, 0x3800
    v_mfma_f32_32x32x16_bf16 v[48:63], v[140:143], a[204:207], v[48:63]
    ds_read_b128 a[220:223], v177 offset:36992
    s_add_u32 m0, s81, 16448
    s_add_u32 s83, s73, 256
    buffer_load_dwordx4 v188, s[12:15], s83 offen lds
L_padB1_2:
    s_cbranch_execz L_padB1_6
    buffer_load_dwordx4 v189, s[12:15], s83 offen offset:1024 lds
    v_mfma_f32_4x4x4_16b_bf16 v[68:71], a[200:201], a[200:201], v[68:71]
    v_mfma_f32_4x4x4_16b_bf16 v[72:75], a[204:205], a[204:205], v[72:75]
    v_mfma_f32_4x4x4_16b_bf16 v[88:91], a[202:203], a[202:203], v[88:91]
    v_mfma_f32_4x4x4_16b_bf16 v[92:95], a[206:207], a[206:207], v[92:95]
    v_mfma_f32_16x16x32_bf16 v[64:67], v[144:147], a[200:203], v[64:67]
    v_mfma_f32_16x16x32_bf16 v[64:67], v[148:151], a[204:207], v[64:67]
    v_mfma_f32_16x16x32_bf16 v[156:159], v[144:147], v[136:139], v[156:159]
    v_mfma_f32_16x16x32_bf16 v[156:159], v[148:151], v[140:143], v[156:159]
    s_waitcnt lgkmcnt(2)
    v_mfma_f32_32x32x16_bf16 v[0:15], v[128:131], a[208:211], v[0:15]
    ds_read_b64_tr_b16 v[136:137], v179 offset:34944
    ds_read_b64_tr_b16 v[138:139], v179 offset:35456
    s_lshl_b32 s83, s45, 10
    s_add_u32 s83, s83, 154112
    v_and_b32 v241, 31, v197
    v_lshl_add_u32 v241, v241, 4, s83
    s_lshl_b32 s84, s46, 3
    s_add_u32 s83, s83, s84
    v_lshl_add_u32 v240, v197, 4, s83
    v_mfma_f32_32x32x16_bf16 v[16:31], v[128:131], a[212:215], v[16:31]
    ds_read_b64_tr_b16 v[140:141], v179 offset:34976
    ds_read_b64_tr_b16 v[142:143], v179 offset:35488
    s_add_u32 s59, s58, 2048
    s_and_b32 s59, s59, 0x3800
    v_mfma_f32_32x32x16_bf16 v[32:47], v[132:135], a[208:211], v[32:47]
    v_and_b32 v249, 3, v197
    v_lshl_add_u32 v248, v249, 3, v248
    s_add_u32 s60, s59, 2048
    s_and_b32 s60, s60, 0x3800
    v_mfma_f32_32x32x16_bf16 v[48:63], v[132:135], a[212:215], v[48:63]
    s_add_u32 m0, s81, 24672
    s_add_u32 s83, s73, 256
    buffer_load_dwordx4 v188, s[16:19], s83 offen lds
    buffer_load_dwordx4 v189, s[16:19], s83 offen offset:1024 lds
    s_waitcnt vmcnt(8) lgkmcnt(0)
    s_barrier
    v_mfma_f32_32x32x16_bf16 v[0:15], v[136:139], a[216:219], v[0:15]
    ds_read_b64_tr_b16 v[128:129], v178 offset:49344
    ds_read_b64_tr_b16 v[130:131], v178 offset:49856
    ds_read_b128 a[224:227], v174 offset:49344
    v_mfma_f32_32x32x16_bf16 v[16:31], v[136:139], a[220:223], v[16:31]
    ds_read_b128 a[228:231], v174 offset:53440
    ds_read_b64_tr_b16 v[132:133], v178 offset:49376
    ds_read_b64_tr_b16 v[134:135], v178 offset:49888
    v_mfma_f32_32x32x16_bf16 v[32:47], v[140:143], a[216:219], v[32:47]
    s_add_u32 m0, s81, 32896
    s_add_u32 s83, s74, 256
    buffer_load_dwordx4 v188, s[12:15], s83 offen lds
    buffer_load_dwordx4 v189, s[12:15], s83 offen offset:1024 lds
    v_mfma_f32_32x32x16_bf16 v[48:63], v[140:143], a[220:223], v[48:63]
    v_bfe_u32 v249, v197, 3, 1
    v_xor_b32 v249, s46, v249
    s_add_u32 s61, s60, 2048
    s_and_b32 s61, s61, 0x3800
    s_waitcnt lgkmcnt(0)
    v_mfma_f32_32x32x16_bf16 v[0:15], v[128:131], a[224:227], v[0:15]
    ds_read_b64_tr_b16 v[136:137], v178 offset:51392
    ds_read_b64_tr_b16 v[138:139], v178 offset:51904
    ds_read_b128 a[232:235], v175 offset:49344
    v_mfma_f32_32x32x16_bf16 v[16:31], v[128:131], a[228:231], v[16:31]
    ds_read_b128 a[236:239], v175 offset:53440
    ds_read_b64_tr_b16 v[140:141], v178 offset:51424
    ds_read_b64_tr_b16 v[142:143], v178 offset:51936
    v_mfma_f32_32x32x16_bf16 v[32:47], v[132:135], a[224:227], v[32:47]
    ds_read_b128 a[240:243], v176 offset:49344
    s_add_u32 m0, s81, 41120
    s_add_u32 s83, s74, 256
    buffer_load_dwordx4 v188, s[16:19], s83 offen lds
    buffer_load_dwordx4 v189, s[16:19], s83 offen offset:1024 lds
    v_mfma_f32_32x32x16_bf16 v[48:63], v[132:135], a[228:231], v[48:63]
    ds_read_b128 a[244:247], v176 offset:53440
    v_lshl_add_u32 v248, v249, 6, v248
    s_add_u32 s62, s61, 2048
    s_and_b32 s62, s62, 0x3800
    v_mfma_f32_4x4x4_16b_bf16 v[68:71], a[224:225], a[224:225], v[68:71]
    v_mfma_f32_4x4x4_16b_bf16 v[72:75], a[228:229], a[228:229], v[72:75]
    v_mfma_f32_4x4x4_16b_bf16 v[88:91], a[226:227], a[226:227], v[88:91]
    v_mfma_f32_4x4x4_16b_bf16 v[92:95], a[230:231], a[230:231], v[92:95]
    v_mfma_f32_16x16x32_bf16 v[64:67], v[144:147], a[224:227], v[64:67]
    v_mfma_f32_16x16x32_bf16 v[64:67], v[148:151], a[228:231], v[64:67]
    s_waitcnt lgkmcnt(5)
    v_mfma_f32_4x4x4_16b_bf16 v[68:71], a[232:233], a[232:233], v[68:71]
    s_waitcnt lgkmcnt(4)
    v_mfma_f32_4x4x4_16b_bf16 v[72:75], a[236:237], a[236:237], v[72:75]
    v_mfma_f32_4x4x4_16b_bf16 v[88:91], a[234:235], a[234:235], v[88:91]
    v_mfma_f32_4x4x4_16b_bf16 v[92:95], a[238:239], a[238:239], v[92:95]
    v_mfma_f32_16x16x32_bf16 v[64:67], v[144:147], a[232:235], v[64:67]
    v_mfma_f32_16x16x32_bf16 v[64:67], v[148:151], a[236:239], v[64:67]
    v_mfma_f32_16x16x32_bf16 v[156:159], v[144:147], v[128:131], v[156:159]
    v_mfma_f32_16x16x32_bf16 v[156:159], v[148:151], v[132:135], v[156:159]
    s_waitcnt lgkmcnt(2)
    v_mfma_f32_16x16x32_bf16 v[156:159], v[144:147], v[136:139], v[156:159]
    ds_read_b64_tr_b16 v[128:129], v179 offset:49344
    ds_read_b64_tr_b16 v[130:131], v179 offset:49856
    v_mfma_f32_16x16x32_bf16 v[156:159], v[148:151], v[140:143], v[156:159]
    ds_read_b64_tr_b16 v[132:133], v179 offset:49376
    ds_read_b64_tr_b16 v[134:135], v179 offset:49888
    v_mfma_f32_32x32x16_bf16 v[0:15], v[136:139], a[232:235], v[0:15]
    ds_read_b128 a[248:251], v177 offset:49344
    v_bfe_u32 v249, v197, 4, 1
    s_add_u32 s63, s62, 2048
    s_and_b32 s63, s63, 0x3800
    v_add_f32 v68, v68, v88
    v_add_f32 v69, v69, v89
    v_add_f32 v70, v70, v90
    v_add_f32 v71, v71, v91
    v_mfma_f32_32x32x16_bf16 v[16:31], v[136:139], a[236:239], v[16:31]
    ds_read_b128 a[252:255], v177 offset:53440
    v_mul_u32_u24 v249, 8224, v249
    v_add_f32 v72, v72, v92
    v_add_f32 v73, v73, v93
    v_add_f32 v74, v74, v94
    v_add_f32 v75, v75, v95
    v_cndmask_b32 v68, v68, v69, s[86:87]
    v_mfma_f32_32x32x16_bf16 v[32:47], v[140:143], a[232:235], v[32:47]
    s_add_u32 m0, s81, 65792
    s_add_u32 s83, s75, 256
    buffer_load_dwordx4 v188, s[12:15], s83 offen lds
    buffer_load_dwordx4 v189, s[12:15], s83 offen offset:1024 lds
    v_cndmask_b32 v72, v72, v73, s[86:87]
    v_cndmask_b32 v68, v68, v70, s[88:89]
    v_cndmask_b32 v72, v72, v74, s[88:89]
    v_cndmask_b32 v68, v68, v71, s[90:91]
    v_mfma_f32_32x32x16_bf16 v[48:63], v[140:143], a[236:239], v[48:63]
    v_add_u32 v248, v248, v249
    s_lshl_b32 s83, s3, 12
    s_xor_b32 s84, s83, 4096
    v_add_u32 v182, s83, v248
    v_add_u32 v183, s84, v248
    v_add_u32 v184, 65792, v182
    v_add_u32 v185, 65792, v183
    s_waitcnt lgkmcnt(2)
    v_mfma_f32_32x32x16_bf16 v[0:15], v[128:131], a[240:243], v[0:15]
    ds_read_b64_tr_b16 v[136:137], v179 offset:51392
    ds_read_b64_tr_b16 v[138:139], v179 offset:51904
    v_cndmask_b32 v72, v72, v75, s[90:91]
    s_nop 1
    v_permlane32_swap_b32 v68, v72
    v_add_f32 v65, v68, v72
    ds_write_b64 v240, v[64:65]
    ds_write_b32 v191, v156 offset:0
L_padB1_3:
    s_cbranch_execz L_padB1_7
    v_mfma_f32_32x32x16_bf16 v[16:31], v[128:131], a[244:247], v[16:31]
    ds_read_b64_tr_b16 v[140:141], v179 offset:51424
    ds_read_b64_tr_b16 v[142:143], v179 offset:51936
    v_mfma_f32_32x32x16_bf16 v[32:47], v[132:135], a[240:243], v[32:47]
    s_add_u32 m0, s81, 74016
    s_add_u32 s83, s75, 256
    buffer_load_dwordx4 v188, s[16:19], s83 offen lds
    buffer_load_dwordx4 v189, s[16:19], s83 offen offset:1024 lds
    v_mfma_f32_32x32x16_bf16 v[48:63], v[132:135], a[244:247], v[48:63]
    s_waitcnt vmcnt(12) lgkmcnt(0)
    s_barrier
    v_mfma_f32_32x32x16_bf16 v[0:15], v[136:139], a[248:251], v[0:15]
    ds_read_b64_tr_b16 v[128:129], v182 offset:0
    ds_read_b64_tr_b16 v[130:131], v182 offset:512
    v_xor_b32 v242, 0x80, v191
    ds_read_b32 v242, v242 offset:0
    ds_read_b128 v[244:247], v241
    ds_read_b128 v[248:251], v241 offset:512
    v_mfma_f32_32x32x16_bf16 v[16:31], v[136:139], a[252:255], v[16:31]
    ds_read_b64_tr_b16 v[132:133], v182 offset:32
    ds_read_b64_tr_b16 v[134:135], v182 offset:544
    v_mfma_f32_32x32x16_bf16 v[32:47], v[140:143], a[248:251], v[32:47]
    s_add_u32 m0, s81, 49344
    s_add_u32 s83, s76, 256
    buffer_load_dwordx4 v188, s[12:15], s83 offen lds
    buffer_load_dwordx4 v189, s[12:15], s83 offen offset:1024 lds
    s_waitcnt lgkmcnt(4)
    v_add_f32 v242, v242, v156
    s_waitcnt lgkmcnt(3)
    v_add_f32 v244, v244, v246
    v_mul_f32 v244, 0xbb000000, v244
    v_cvt_pk_bf16_f32 v161, v244, 0
    v_lshlrev_b32 v246, 16, v161
    v_sub_f32 v246, v244, v246
    v_cvt_pk_bf16_f32 v160, v244, v246
    v_cndmask_b32 v162, 0, v160, s[54:55]
    v_cndmask_b32 v163, 0, v161, s[54:55]
    v_cndmask_b32 v160, v160, 0, s[54:55]
    v_cndmask_b32 v161, v161, 0, s[54:55]
    v_mfma_f32_32x32x16_bf16 v[48:63], v[140:143], a[252:255], v[48:63]
    v_cvt_pk_bf16_f32 v168, v242, v242
    v_lshlrev_b32 v169, 16, v168
    v_sub_f32 v242, v242, v169
    v_cvt_pk_bf16_f32 v169, v242, 0
    s_waitcnt lgkmcnt(2)
    v_add_f32 v248, v248, v250
    v_mul_f32 v248, 0xbb000000, v248
    v_cvt_pk_bf16_f32 v165, v248, 0
    v_lshlrev_b32 v250, 16, v165
    v_sub_f32 v250, v248, v250
    v_cvt_pk_bf16_f32 v164, v248, v250
    v_cndmask_b32 v166, 0, v164, s[54:55]
    v_cndmask_b32 v167, 0, v165, s[54:55]
    v_cndmask_b32 v164, v164, 0, s[54:55]
    v_cndmask_b32 v165, v165, 0, s[54:55]
    s_waitcnt lgkmcnt(0)
    v_mfma_f32_32x32x16_bf16 v[64:79], v[128:131], a[0:3], 0
    ds_read_b64_tr_b16 v[136:137], v182 offset:2048
    ds_read_b64_tr_b16 v[138:139], v182 offset:2560
    v_mfma_f32_32x32x16_bf16 v[0:15], v[168:171], v[160:163], v[0:15]
    v_mfma_f32_32x32x16_bf16 v[80:95], v[128:131], a[4:7], 0
    ds_read_b64_tr_b16 v[140:141], v182 offset:2080
    ds_read_b64_tr_b16 v[142:143], v182 offset:2592
    v_mfma_f32_32x32x16_bf16 v[96:111], v[132:135], a[0:3], 0
    s_add_u32 m0, s81, 57568
    s_add_u32 s83, s76, 256
    buffer_load_dwordx4 v188, s[16:19], s83 offen lds
    buffer_load_dwordx4 v189, s[16:19], s83 offen offset:1024 lds
    v_mfma_f32_32x32x16_bf16 v[112:127], v[132:135], a[4:7], 0
    v_mfma_f32_32x32x16_bf16 v[16:31], v[168:171], v[164:167], v[16:31]
    v_mfma_f32_16x16x32_bf16 v[156:159], v[144:147], v[128:131], 0
    v_mfma_f32_16x16x32_bf16 v[156:159], v[148:151], v[132:135], v[156:159]
    s_waitcnt lgkmcnt(0)
    v_mfma_f32_32x32x16_bf16 v[64:79], v[136:139], a[8:11], v[64:79]
    ds_read_b64_tr_b16 v[128:129], v183 offset:0
    ds_read_b64_tr_b16 v[130:131], v183 offset:512
    v_mfma_f32_32x32x16_bf16 v[32:47], v[168:171], v[162:165], v[32:47]
    v_mfma_f32_32x32x16_bf16 v[80:95], v[136:139], a[12:15], v[80:95]
    ds_read_b64_tr_b16 v[132:133], v183 offset:32
    ds_read_b64_tr_b16 v[134:135], v183 offset:544
    v_mfma_f32_32x32x16_bf16 v[96:111], v[140:143], a[8:11], v[96:111]
    v_mfma_f32_32x32x16_bf16 v[48:63], v[168:171], v[166:169], v[48:63]
    v_mfma_f32_32x32x16_bf16 v[112:127], v[140:143], a[12:15], v[112:127]
    s_add_u32 m0, s81, 82240
    s_add_u32 s83, s77, 256
    buffer_load_dwordx4 v188, s[12:15], s83 offen lds
    buffer_load_dwordx4 v189, s[12:15], s83 offen offset:1024 lds
    v_mfma_f32_16x16x32_bf16 v[156:159], v[144:147], v[136:139], v[156:159]
    v_mfma_f32_16x16x32_bf16 v[156:159], v[148:151], v[140:143], v[156:159]
    s_waitcnt lgkmcnt(0)
    v_mfma_f32_32x32x16_bf16 v[64:79], v[128:131], a[16:19], v[64:79]
    ds_read_b64_tr_b16 v[136:137], v183 offset:2048
    ds_read_b64_tr_b16 v[138:139], v183 offset:2560
    v_add_f32 v245, v245, v247
    v_mul_f32 v246, v244, v244
    v_mfma_f32_32x32x16_bf16 v[80:95], v[128:131], a[20:23], v[80:95]
    ds_read_b64_tr_b16 v[140:141], v183 offset:2080
    ds_read_b64_tr_b16 v[142:143], v183 offset:2592
    v_fma_f32 v245, v245, s96, -v246
    v_max_f32 v245, 0, v245
    v_add_f32 v245, 0x3727c5ac, v245
    v_mfma_f32_32x32x16_bf16 v[96:111], v[132:135], a[16:19], v[96:111]
    v_rsq_f32 v192, v245
    v_rcp_f32 v194, v245
    v_mul_f32 v172, 0x3fb8aa3b, v192
    v_mfma_f32_32x32x16_bf16 v[112:127], v[132:135], a[20:23], v[112:127]
    s_add_u32 m0, s81, 90464
    s_add_u32 s83, s77, 256
    buffer_load_dwordx4 v188, s[16:19], s83 offen lds
    buffer_load_dwordx4 v189, s[16:19], s83 offen offset:1024 lds
    s_waitcnt vmcnt(16) lgkmcnt(0)
    s_barrier
    v_mfma_f32_32x32x16_bf16 v[64:79], v[136:139], a[24:27], v[64:79]
    ds_read_b64_tr_b16 v[128:129], v182 offset:16448
    ds_read_b64_tr_b16 v[130:131], v182 offset:16960
    v_add_f32 v249, v249, v251
    v_mul_f32 v250, v248, v248
    v_mfma_f32_32x32x16_bf16 v[80:95], v[136:139], a[28:31], v[80:95]
    ds_read_b64_tr_b16 v[132:133], v182 offset:16480
    ds_read_b64_tr_b16 v[134:135], v182 offset:16992
    v_fma_f32 v249, v249, s96, -v250
    v_max_f32 v249, 0, v249
    v_add_f32 v249, 0x3727c5ac, v249
    v_mfma_f32_32x32x16_bf16 v[96:111], v[140:143], a[24:27], v[96:111]
    s_add_u32 m0, s81, 0
    s_add_u32 s83, s78, 256
    buffer_load_dwordx4 v188, s[12:15], s83 offen lds
    buffer_load_dwordx4 v189, s[12:15], s83 offen offset:1024 lds
    v_mfma_f32_32x32x16_bf16 v[112:127], v[140:143], a[28:31], v[112:127]
    v_rsq_f32 v193, v249
    v_rcp_f32 v195, v249
    v_mul_f32 v173, 0x3fb8aa3b, v193
    s_waitcnt lgkmcnt(0)
    v_mfma_f32_32x32x16_bf16 v[64:79], v[128:131], a[32:35], v[64:79]
    ds_read_b64_tr_b16 v[136:137], v182 offset:18496
    ds_read_b64_tr_b16 v[138:139], v182 offset:19008
    v_mul_f32 v0, v194, v0
    v_mul_f32 v1, v194, v1
    v_mfma_f32_32x32x16_bf16 v[80:95], v[128:131], a[36:39], v[80:95]
    ds_read_b64_tr_b16 v[140:141], v182 offset:18528
    ds_read_b64_tr_b16 v[142:143], v182 offset:19040
    v_mul_f32 v0, v0, v8
    v_mul_f32 v1, v1, v9
    v_cvt_pk_bf16_f32 v0, v0, v1
    v_mfma_f32_32x32x16_bf16 v[96:111], v[132:135], a[32:35], v[96:111]
L_padB1_4:
    s_cbranch_execz L_padB1_8
    s_add_u32 m0, s81, 8224
    s_add_u32 s83, s78, 256
    buffer_load_dwordx4 v188, s[16:19], s83 offen lds
    buffer_load_dwordx4 v189, s[16:19], s83 offen offset:1024 lds
    v_mul_f32 v2, v194, v2
    v_mfma_f32_32x32x16_bf16 v[112:127], v[132:135], a[36:39], v[112:127]
    v_mul_f32 v3, v194, v3
    v_mul_f32 v2, v2, v10
    v_mul_f32 v3, v3, v11
    v_cvt_pk_bf16_f32 v1, v2, v3
    v_mfma_f32_16x16x32_bf16 v[156:159], v[144:147], v[128:131], v[156:159]
    v_mul_f32 v4, v194, v4
    v_mfma_f32_16x16x32_bf16 v[156:159], v[148:151], v[132:135], v[156:159]
    v_mul_f32 v5, v194, v5
    s_waitcnt lgkmcnt(0)
    v_mfma_f32_32x32x16_bf16 v[64:79], v[136:139], a[40:43], v[64:79]
    ds_read_b64_tr_b16 v[128:129], v183 offset:16448
    ds_read_b64_tr_b16 v[130:131], v183 offset:16960
    v_mul_f32 v4, v4, v12
    v_mul_f32 v5, v5, v13
    v_mfma_f32_32x32x16_bf16 v[80:95], v[136:139], a[44:47], v[80:95]
    ds_read_b64_tr_b16 v[132:133], v183 offset:16480
    ds_read_b64_tr_b16 v[134:135], v183 offset:16992
    v_cvt_pk_bf16_f32 v2, v4, v5
    v_mul_f32 v6, v194, v6
    v_mul_f32 v7, v194, v7
    v_mfma_f32_32x32x16_bf16 v[96:111], v[140:143], a[40:43], v[96:111]
    v_mul_f32 v6, v6, v14
    v_mul_f32 v7, v7, v15
    v_cvt_pk_bf16_f32 v3, v6, v7
    s_mov_b32 s84, 0
    buffer_store_dwordx4 v[0:3], v196, s[28:31], s84 offen offset:0 sc1
    v_mfma_f32_32x32x16_bf16 v[112:127], v[140:143], a[44:47], v[112:127]
    s_add_u32 m0, s81, 98688
    s_add_u32 s83, s79, 256
    buffer_load_dwordx4 v188, s[12:15], s83 offen lds
    buffer_load_dwordx4 v189, s[12:15], s83 offen offset:1024 lds
    v_mfma_f32_16x16x32_bf16 v[156:159], v[144:147], v[136:139], v[156:159]
    v_mul_f32 v16, v195, v16
    v_mfma_f32_16x16x32_bf16 v[156:159], v[148:151], v[140:143], v[156:159]
    v_mul_f32 v17, v195, v17
    s_waitcnt lgkmcnt(0)
    v_mfma_f32_32x32x16_bf16 v[64:79], v[128:131], a[48:51], v[64:79]
    ds_read_b64_tr_b16 v[136:137], v183 offset:18496
    ds_read_b64_tr_b16 v[138:139], v183 offset:19008
    v_mul_f32 v16, v16, v24
    v_mul_f32 v17, v17, v25
    v_mfma_f32_32x32x16_bf16 v[80:95], v[128:131], a[52:55], v[80:95]
    ds_read_b64_tr_b16 v[140:141], v183 offset:18528
    ds_read_b64_tr_b16 v[142:143], v183 offset:19040
    v_cvt_pk_bf16_f32 v16, v16, v17
    v_mul_f32 v18, v195, v18
    v_mul_f32 v19, v195, v19
    v_mfma_f32_32x32x16_bf16 v[96:111], v[132:135], a[48:51], v[96:111]
    v_mul_f32 v18, v18, v26
    v_mul_f32 v19, v19, v27
    v_cvt_pk_bf16_f32 v17, v18, v19
    v_mul_f32 v20, v195, v20
    v_mfma_f32_32x32x16_bf16 v[112:127], v[132:135], a[52:55], v[112:127]
    s_add_u32 m0, s81, 106912
    s_add_u32 s83, s79, 256
    buffer_load_dwordx4 v188, s[16:19], s83 offen lds
    buffer_load_dwordx4 v189, s[16:19], s83 offen offset:1024 lds
    v_mul_f32 v21, v195, v21
    s_waitcnt vmcnt(21) lgkmcnt(0)
    s_barrier
    v_mfma_f32_32x32x16_bf16 v[64:79], v[136:139], a[56:59], v[64:79]
    ds_read_b64_tr_b16 v[128:129], v182 offset:32896
    ds_read_b64_tr_b16 v[130:131], v182 offset:33408
    v_mul_f32 v20, v20, v28
    v_mul_f32 v21, v21, v29
    v_mfma_f32_32x32x16_bf16 v[80:95], v[136:139], a[60:63], v[80:95]
    ds_read_b64_tr_b16 v[132:133], v182 offset:32928
    ds_read_b64_tr_b16 v[134:135], v182 offset:33440
    v_cvt_pk_bf16_f32 v18, v20, v21
    v_mul_f32 v22, v195, v22
    v_mul_f32 v23, v195, v23
    v_mfma_f32_32x32x16_bf16 v[96:111], v[140:143], a[56:59], v[96:111]
    s_add_u32 m0, s81, 131584
    s_lshl3_add_u32 s83, s56, s94
    buffer_load_dwordx4 v198, s[20:23], s83 offen lds
    buffer_load_dwordx4 v199, s[20:23], s83 offen offset:1024 lds
    v_mul_f32 v22, v22, v30
    v_mfma_f32_32x32x16_bf16 v[112:127], v[140:143], a[60:63], v[112:127]
    v_mul_f32 v23, v23, v31
    v_cvt_pk_bf16_f32 v19, v22, v23
    s_mov_b32 s84, 0
    buffer_store_dwordx4 v[16:19], v196, s[28:31], s84 offen offset:1024 sc1
    s_waitcnt lgkmcnt(0)
    v_mfma_f32_32x32x16_bf16 v[64:79], v[128:131], a[64:67], v[64:79]
    ds_read_b64_tr_b16 v[136:137], v182 offset:34944
    ds_read_b64_tr_b16 v[138:139], v182 offset:35456
    v_lshlrev_b32 v174, 2, v197
    buffer_load_dword v175, v174, s[36:39], 0 offen sc1
    v_mfma_f32_32x32x16_bf16 v[80:95], v[128:131], a[68:71], v[80:95]
    ds_read_b64_tr_b16 v[140:141], v182 offset:34976
    ds_read_b64_tr_b16 v[142:143], v182 offset:35488
    v_mul_f32 v32, v194, v32
    v_mul_f32 v33, v194, v33
    v_mul_f32 v32, v32, v40
    v_mfma_f32_32x32x16_bf16 v[96:111], v[132:135], a[64:67], v[96:111]
    v_mul_f32 v33, v33, v41
    v_cvt_pk_bf16_f32 v32, v32, v33
    v_mul_f32 v34, v194, v34
    v_mul_f32 v35, v194, v35
    v_mul_f32 v34, v34, v42
    v_mfma_f32_32x32x16_bf16 v[112:127], v[132:135], a[68:71], v[112:127]
    v_mul_f32 v35, v35, v43
    v_cvt_pk_bf16_f32 v33, v34, v35
    v_mul_f32 v36, v194, v36
    v_mul_f32 v37, v194, v37
    v_mfma_f32_16x16x32_bf16 v[156:159], v[144:147], v[128:131], v[156:159]
    v_mul_f32 v36, v36, v44
    v_mfma_f32_16x16x32_bf16 v[156:159], v[148:151], v[132:135], v[156:159]
    v_mul_f32 v37, v37, v45
    s_waitcnt lgkmcnt(0)
    v_mfma_f32_32x32x16_bf16 v[64:79], v[136:139], a[72:75], v[64:79]
    ds_read_b64_tr_b16 v[128:129], v183 offset:32896
    ds_read_b64_tr_b16 v[130:131], v183 offset:33408
    v_cvt_pk_bf16_f32 v34, v36, v37
    v_mul_f32 v38, v194, v38
    v_mfma_f32_32x32x16_bf16 v[80:95], v[136:139], a[76:79], v[80:95]
    ds_read_b64_tr_b16 v[132:133], v183 offset:32928
    ds_read_b64_tr_b16 v[134:135], v183 offset:33440
    v_mul_f32 v39, v194, v39
    v_mul_f32 v38, v38, v46
    v_mul_f32 v39, v39, v47
    s_add_u32 m0, s81, 16448
    v_mfma_f32_32x32x16_bf16 v[96:111], v[140:143], a[72:75], v[96:111]
    buffer_load_dwordx4 v186, s[8:11], s64 offen lds
    buffer_load_dwordx4 v187, s[8:11], s64 offen offset:1024 lds
    v_cvt_pk_bf16_f32 v35, v38, v39
    v_mfma_f32_32x32x16_bf16 v[112:127], v[140:143], a[76:79], v[112:127]
    s_mov_b32 s84, 0
    buffer_store_dwordx4 v[32:35], v196, s[28:31], s84 offen offset:2048 sc1
    v_mul_f32 v48, v195, v48
    v_mul_f32 v49, v195, v49
    v_mul_f32 v48, v48, v56
    v_mfma_f32_16x16x32_bf16 v[156:159], v[144:147], v[136:139], v[156:159]
    v_mul_f32 v49, v49, v57
    v_mfma_f32_16x16x32_bf16 v[156:159], v[148:151], v[140:143], v[156:159]
    s_waitcnt lgkmcnt(0)
    v_mfma_f32_32x32x16_bf16 v[64:79], v[128:131], a[80:83], v[64:79]
    ds_read_b64_tr_b16 v[136:137], v183 offset:34944
    ds_read_b64_tr_b16 v[138:139], v183 offset:35456
    v_cvt_pk_bf16_f32 v48, v48, v49
    v_mul_f32 v50, v195, v50
    v_mfma_f32_32x32x16_bf16 v[80:95], v[128:131], a[84:87], v[80:95]
    ds_read_b64_tr_b16 v[140:141], v183 offset:34976
    ds_read_b64_tr_b16 v[142:143], v183 offset:35488
    v_mul_f32 v51, v195, v51
    v_mul_f32 v50, v50, v58
    v_mul_f32 v51, v51, v59
    v_mfma_f32_32x32x16_bf16 v[96:111], v[132:135], a[80:83], v[96:111]
    v_cvt_pk_bf16_f32 v49, v50, v51
    v_mul_f32 v52, v195, v52
    v_mul_f32 v53, v195, v53
    v_mul_f32 v52, v52, v60
    v_mul_f32 v53, v53, v61
    s_add_u32 m0, s81, 24672
    v_mfma_f32_32x32x16_bf16 v[112:127], v[132:135], a[84:87], v[112:127]
    buffer_load_dwordx4 v186, s[8:11], s65 offen lds
L_padB0_1:
    s_cbranch_execz L_retB0
    buffer_load_dwordx4 v187, s[8:11], s65 offen offset:1024 lds
    v_cvt_pk_bf16_f32 v50, v52, v53
    s_waitcnt vmcnt(26) lgkmcnt(0)
    s_barrier
    v_mfma_f32_32x32x16_bf16 v[64:79], v[136:139], a[88:91], v[64:79]
    ds_read_b64_tr_b16 v[128:129], v184 offset:0
    ds_read_b64_tr_b16 v[130:131], v184 offset:512
    v_mul_f32 v54, v195, v54
    v_mul_f32 v55, v195, v55
    v_mfma_f32_32x32x16_bf16 v[80:95], v[136:139], a[92:95], v[80:95]
    ds_read_b64_tr_b16 v[132:133], v184 offset:32
    ds_read_b64_tr_b16 v[134:135], v184 offset:544
    v_mul_f32 v54, v54, v62
    v_mul_f32 v55, v55, v63
    v_cvt_pk_bf16_f32 v51, v54, v55
    v_mfma_f32_32x32x16_bf16 v[96:111], v[140:143], a[88:91], v[96:111]
    s_add_u32 m0, s81, 139808
    s_lshl3_add_u32 s83, s57, s94
    buffer_load_dwordx4 v198, s[20:23], s83 offen lds
    buffer_load_dwordx4 v199, s[20:23], s83 offen offset:1024 lds
    v_mfma_f32_32x32x16_bf16 v[112:127], v[140:143], a[92:95], v[112:127]
    s_mov_b32 s84, 0
    buffer_store_dwordx4 v[48:51], v196, s[28:31], s84 offen offset:3072 sc1
    s_waitcnt lgkmcnt(0)
    v_mfma_f32_32x32x16_bf16 v[64:79], v[128:131], a[96:99], v[64:79]
    ds_read_b64_tr_b16 v[136:137], v184 offset:2048
    ds_read_b64_tr_b16 v[138:139], v184 offset:2560
    v_mfma_f32_32x32x16_bf16 v[80:95], v[128:131], a[100:103], v[80:95]
    ds_read_b64_tr_b16 v[140:141], v184 offset:2080
    ds_read_b64_tr_b16 v[142:143], v184 offset:2592
    v_mfma_f32_32x32x16_bf16 v[96:111], v[132:135], a[96:99], v[96:111]
    v_mfma_f32_32x32x16_bf16 v[112:127], v[132:135], a[100:103], v[112:127]
    v_mfma_f32_16x16x32_bf16 v[156:159], v[144:147], v[128:131], v[156:159]
    v_mfma_f32_16x16x32_bf16 v[156:159], v[148:151], v[132:135], v[156:159]
    s_waitcnt lgkmcnt(0)
    v_mfma_f32_32x32x16_bf16 v[64:79], v[136:139], a[104:107], v[64:79]
    ds_read_b64_tr_b16 v[128:129], v185 offset:0
    ds_read_b64_tr_b16 v[130:131], v185 offset:512
    v_mfma_f32_32x32x16_bf16 v[80:95], v[136:139], a[108:111], v[80:95]
    ds_read_b64_tr_b16 v[132:133], v185 offset:32
    ds_read_b64_tr_b16 v[134:135], v185 offset:544
    s_add_u32 m0, s81, 32896
    v_mfma_f32_32x32x16_bf16 v[96:111], v[140:143], a[104:107], v[96:111]
    buffer_load_dwordx4 v186, s[8:11], s66 offen lds
    buffer_load_dwordx4 v187, s[8:11], s66 offen offset:1024 lds
    v_mfma_f32_32x32x16_bf16 v[112:127], v[140:143], a[108:111], v[112:127]
    v_mfma_f32_16x16x32_bf16 v[156:159], v[144:147], v[136:139], v[156:159]
    v_mfma_f32_16x16x32_bf16 v[156:159], v[148:151], v[140:143], v[156:159]
    s_waitcnt lgkmcnt(0)
    v_mfma_f32_32x32x16_bf16 v[64:79], v[128:131], a[112:115], v[64:79]
    ds_read_b64_tr_b16 v[136:137], v185 offset:2048
    ds_read_b64_tr_b16 v[138:139], v185 offset:2560
    v_mfma_f32_32x32x16_bf16 v[80:95], v[128:131], a[116:119], v[80:95]
    ds_read_b64_tr_b16 v[140:141], v185 offset:2080
    ds_read_b64_tr_b16 v[142:143], v185 offset:2592
    v_mfma_f32_32x32x16_bf16 v[96:111], v[132:135], a[112:115], v[96:111]
    v_mfma_f32_32x32x16_bf16 v[112:127], v[132:135], a[116:119], v[112:127]
    s_add_u32 m0, s81, 41120
    s_lshl3_add_u32 s83, s58, s94
    buffer_load_dwordx4 v198, s[20:23], s83 offen lds
    buffer_load_dwordx4 v199, s[20:23], s83 offen offset:1024 lds
    s_waitcnt vmcnt(29) lgkmcnt(0)
    s_barrier
    v_mfma_f32_32x32x16_bf16 v[64:79], v[136:139], a[120:123], v[64:79]
    ds_read_b64_tr_b16 v[128:129], v182 offset:49344
    ds_read_b64_tr_b16 v[130:131], v182 offset:49856
    v_mfma_f32_32x32x16_bf16 v[80:95], v[136:139], a[124:127], v[80:95]
    ds_read_b64_tr_b16 v[132:133], v182 offset:49376
    ds_read_b64_tr_b16 v[134:135], v182 offset:49888
    v_mfma_f32_32x32x16_bf16 v[96:111], v[140:143], a[120:123], v[96:111]
    s_add_u32 m0, s81, 148032
    s_lshl3_add_u32 s83, s59, s94
    buffer_load_dwordx4 v198, s[20:23], s83 offen lds
    buffer_load_dwordx4 v199, s[20:23], s83 offen offset:1024 lds
    v_mfma_f32_32x32x16_bf16 v[112:127], v[140:143], a[124:127], v[112:127]
    s_waitcnt lgkmcnt(0)
    v_mfma_f32_32x32x16_bf16 v[64:79], v[128:131], a[128:131], v[64:79]
    ds_read_b64_tr_b16 v[136:137], v182 offset:51392
    ds_read_b64_tr_b16 v[138:139], v182 offset:51904
    v_mfma_f32_32x32x16_bf16 v[80:95], v[128:131], a[132:135], v[80:95]
    ds_read_b64_tr_b16 v[140:141], v182 offset:51424
    ds_read_b64_tr_b16 v[142:143], v182 offset:51936
    v_mfma_f32_32x32x16_bf16 v[96:111], v[132:135], a[128:131], v[96:111]
    v_mfma_f32_32x32x16_bf16 v[112:127], v[132:135], a[132:135], v[112:127]
    v_mfma_f32_16x16x32_bf16 v[156:159], v[144:147], v[128:131], v[156:159]
    v_mfma_f32_16x16x32_bf16 v[156:159], v[148:151], v[132:135], v[156:159]
    s_waitcnt lgkmcnt(0)
    v_mfma_f32_32x32x16_bf16 v[64:79], v[136:139], a[136:139], v[64:79]
    ds_read_b64_tr_b16 v[128:129], v183 offset:49344
    ds_read_b64_tr_b16 v[130:131], v183 offset:49856
    v_mfma_f32_32x32x16_bf16 v[80:95], v[136:139], a[140:143], v[80:95]
    ds_read_b64_tr_b16 v[132:133], v183 offset:49376
    ds_read_b64_tr_b16 v[134:135], v183 offset:49888
    s_add_u32 m0, s81, 65792
    v_mfma_f32_32x32x16_bf16 v[96:111], v[140:143], a[136:139], v[96:111]
    buffer_load_dwordx4 v186, s[8:11], s67 offen lds
    buffer_load_dwordx4 v187, s[8:11], s67 offen offset:1024 lds
    v_mfma_f32_32x32x16_bf16 v[112:127], v[140:143], a[140:143], v[112:127]
    v_mfma_f32_16x16x32_bf16 v[156:159], v[144:147], v[136:139], v[156:159]
    v_mfma_f32_16x16x32_bf16 v[156:159], v[148:151], v[140:143], v[156:159]
    s_waitcnt lgkmcnt(0)
    v_mfma_f32_32x32x16_bf16 v[64:79], v[128:131], a[144:147], v[64:79]
    ds_read_b64_tr_b16 v[136:137], v183 offset:51392
    ds_read_b64_tr_b16 v[138:139], v183 offset:51904
    v_mfma_f32_32x32x16_bf16 v[80:95], v[128:131], a[148:151], v[80:95]
    ds_read_b64_tr_b16 v[140:141], v183 offset:51424
    ds_read_b64_tr_b16 v[142:143], v183 offset:51936
    v_mfma_f32_32x32x16_bf16 v[96:111], v[132:135], a[144:147], v[96:111]
    s_add_u32 m0, s81, 74016
    v_mfma_f32_32x32x16_bf16 v[112:127], v[132:135], a[148:151], v[112:127]
    buffer_load_dwordx4 v186, s[8:11], s68 offen lds
    buffer_load_dwordx4 v187, s[8:11], s68 offen offset:1024 lds
    s_waitcnt vmcnt(31) lgkmcnt(0)
    s_barrier
    v_mfma_f32_32x32x16_bf16 v[64:79], v[136:139], a[152:155], v[64:79]
    ds_read_b64_tr_b16 v[128:129], v184 offset:16448
    ds_read_b64_tr_b16 v[130:131], v184 offset:16960
    v_mfma_f32_32x32x16_bf16 v[80:95], v[136:139], a[156:159], v[80:95]
    ds_read_b64_tr_b16 v[132:133], v184 offset:16480
    ds_read_b64_tr_b16 v[134:135], v184 offset:16992
    v_mfma_f32_32x32x16_bf16 v[96:111], v[140:143], a[152:155], v[96:111]
    s_add_u32 m0, s81, 49344
    s_lshl3_add_u32 s83, s60, s94
    buffer_load_dwordx4 v198, s[20:23], s83 offen lds
    buffer_load_dwordx4 v199, s[20:23], s83 offen offset:1024 lds
    s_waitcnt vmcnt(12)
    v_mov_b32 v190, 1
    buffer_store_dword v190, v252, s[28:31], 0 offen sc1
    v_mfma_f32_32x32x16_bf16 v[112:127], v[140:143], a[156:159], v[112:127]
    s_waitcnt lgkmcnt(0)
    v_mfma_f32_32x32x16_bf16 v[64:79], v[128:131], a[160:163], v[64:79]
    ds_read_b64_tr_b16 v[136:137], v184 offset:18496
    ds_read_b64_tr_b16 v[138:139], v184 offset:19008
    v_mfma_f32_32x32x16_bf16 v[80:95], v[128:131], a[164:167], v[80:95]
    ds_read_b64_tr_b16 v[140:141], v184 offset:18528
    ds_read_b64_tr_b16 v[142:143], v184 offset:19040
    v_mfma_f32_32x32x16_bf16 v[96:111], v[132:135], a[160:163], v[96:111]
    v_lshrrev_b32 v176, 5, v197
    v_mfma_f32_32x32x16_bf16 v[112:127], v[132:135], a[164:167], v[112:127]
    v_lshlrev_b32 v176, 10, v176
L_padB1_5:
    s_cbranch_execz L_padB1_9
    v_mfma_f32_16x16x32_bf16 v[156:159], v[144:147], v[128:131], v[156:159]
    v_mfma_f32_16x16x32_bf16 v[156:159], v[148:151], v[132:135], v[156:159]
    s_waitcnt lgkmcnt(0)
    v_mfma_f32_32x32x16_bf16 v[64:79], v[136:139], a[168:171], v[64:79]
    ds_read_b64_tr_b16 v[128:129], v185 offset:16448
    ds_read_b64_tr_b16 v[130:131], v185 offset:16960
    v_mfma_f32_32x32x16_bf16 v[80:95], v[136:139], a[172:175], v[80:95]
    ds_read_b64_tr_b16 v[132:133], v185 offset:16480
    ds_read_b64_tr_b16 v[134:135], v185 offset:16992
    s_add_u32 m0, s81, 57568
    v_mfma_f32_32x32x16_bf16 v[96:111], v[140:143], a[168:171], v[96:111]
    buffer_load_dwordx4 v186, s[8:11], s69 offen lds
    buffer_load_dwordx4 v187, s[8:11], s69 offen offset:1024 lds
    v_mfma_f32_32x32x16_bf16 v[112:127], v[140:143], a[172:175], v[112:127]
    v_bfe_u32 v177, v197, 2, 2
    v_mfma_f32_16x16x32_bf16 v[156:159], v[144:147], v[136:139], v[156:159]
    v_mfma_f32_16x16x32_bf16 v[156:159], v[148:151], v[140:143], v[156:159]
    s_waitcnt lgkmcnt(0)
    v_mfma_f32_32x32x16_bf16 v[64:79], v[128:131], a[176:179], v[64:79]
    ds_read_b64_tr_b16 v[136:137], v185 offset:18496
    ds_read_b64_tr_b16 v[138:139], v185 offset:19008
    v_mfma_f32_32x32x16_bf16 v[80:95], v[128:131], a[180:183], v[80:95]
    ds_read_b64_tr_b16 v[140:141], v185 offset:18528
    ds_read_b64_tr_b16 v[142:143], v185 offset:19040
    v_mfma_f32_32x32x16_bf16 v[96:111], v[132:135], a[176:179], v[96:111]
    v_lshl_add_u32 v176, v177, 7, v176
    v_mfma_f32_32x32x16_bf16 v[112:127], v[132:135], a[180:183], v[112:127]
    v_and_b32 v177, 3, v197
    s_waitcnt lgkmcnt(0)
    s_barrier
    v_mfma_f32_32x32x16_bf16 v[64:79], v[136:139], a[184:187], v[64:79]
    ds_read_b64_tr_b16 v[128:129], v182 offset:0
    ds_read_b64_tr_b16 v[130:131], v182 offset:512
    v_mfma_f32_32x32x16_bf16 v[80:95], v[136:139], a[188:191], v[80:95]
    ds_read_b64_tr_b16 v[132:133], v182 offset:32
    ds_read_b64_tr_b16 v[134:135], v182 offset:544
    v_mfma_f32_32x32x16_bf16 v[96:111], v[140:143], a[184:187], v[96:111]
    s_add_u32 m0, s81, 82240
    s_lshl3_add_u32 s83, s61, s94
    buffer_load_dwordx4 v198, s[20:23], s83 offen lds
    buffer_load_dwordx4 v199, s[20:23], s83 offen offset:1024 lds
    v_mfma_f32_32x32x16_bf16 v[112:127], v[140:143], a[188:191], v[112:127]
    v_lshl_add_u32 v176, v177, 3, v176
    s_waitcnt lgkmcnt(0)
    v_mfma_f32_32x32x16_bf16 v[64:79], v[128:131], a[192:195], v[64:79]
    ds_read_b64_tr_b16 v[136:137], v182 offset:2048
    ds_read_b64_tr_b16 v[138:139], v182 offset:2560
    v_mfma_f32_32x32x16_bf16 v[80:95], v[128:131], a[196:199], v[80:95]
    ds_read_b64_tr_b16 v[140:141], v182 offset:2080
    ds_read_b64_tr_b16 v[142:143], v182 offset:2592
    v_mfma_f32_32x32x16_bf16 v[96:111], v[132:135], a[192:195], v[96:111]
    v_bfe_u32 v177, v197, 3, 1
    v_mfma_f32_32x32x16_bf16 v[112:127], v[132:135], a[196:199], v[112:127]
    v_xor_b32 v177, s46, v177
    v_mfma_f32_16x16x32_bf16 v[156:159], v[144:147], v[128:131], v[156:159]
    v_mfma_f32_16x16x32_bf16 v[156:159], v[148:151], v[132:135], v[156:159]
    s_waitcnt lgkmcnt(0)
    v_mfma_f32_32x32x16_bf16 v[64:79], v[136:139], a[200:203], v[64:79]
    ds_read_b64_tr_b16 v[128:129], v183 offset:0
    ds_read_b64_tr_b16 v[130:131], v183 offset:512
    v_mfma_f32_32x32x16_bf16 v[80:95], v[136:139], a[204:207], v[80:95]
    ds_read_b64_tr_b16 v[132:133], v183 offset:32
    ds_read_b64_tr_b16 v[134:135], v183 offset:544
    s_add_u32 m0, s81, 90464
    v_mfma_f32_32x32x16_bf16 v[96:111], v[140:143], a[200:203], v[96:111]
    buffer_load_dwordx4 v186, s[8:11], s70 offen lds
    buffer_load_dwordx4 v187, s[8:11], s70 offen offset:1024 lds
    v_mfma_f32_32x32x16_bf16 v[112:127], v[140:143], a[204:207], v[112:127]
    v_lshl_add_u32 v176, v177, 6, v176
    v_mfma_f32_16x16x32_bf16 v[156:159], v[144:147], v[136:139], v[156:159]
    v_mfma_f32_16x16x32_bf16 v[156:159], v[148:151], v[140:143], v[156:159]
    s_waitcnt lgkmcnt(0)
    v_mfma_f32_32x32x16_bf16 v[64:79], v[128:131], a[208:211], v[64:79]
    ds_read_b64_tr_b16 v[136:137], v183 offset:2048
    ds_read_b64_tr_b16 v[138:139], v183 offset:2560
    v_mfma_f32_32x32x16_bf16 v[80:95], v[128:131], a[212:215], v[80:95]
    ds_read_b64_tr_b16 v[140:141], v183 offset:2080
    ds_read_b64_tr_b16 v[142:143], v183 offset:2592
    v_mfma_f32_32x32x16_bf16 v[96:111], v[132:135], a[208:211], v[96:111]
    v_bfe_u32 v177, v197, 4, 1
    v_mfma_f32_32x32x16_bf16 v[112:127], v[132:135], a[212:215], v[112:127]
    v_lshl_add_u32 v176, v177, 5, v176
    s_waitcnt lgkmcnt(0)
    s_barrier
    v_mfma_f32_32x32x16_bf16 v[64:79], v[136:139], a[216:219], v[64:79]
    ds_read_b64_tr_b16 v[128:129], v184 offset:32896
    ds_read_b64_tr_b16 v[130:131], v184 offset:33408
    v_mfma_f32_32x32x16_bf16 v[80:95], v[136:139], a[220:223], v[80:95]
    ds_read_b64_tr_b16 v[132:133], v184 offset:32928
    ds_read_b64_tr_b16 v[134:135], v184 offset:33440
    v_mfma_f32_32x32x16_bf16 v[96:111], v[140:143], a[216:219], v[96:111]
    s_add_u32 m0, s81, 0
    s_lshl3_add_u32 s83, s62, s94
    buffer_load_dwordx4 v198, s[20:23], s83 offen lds
    buffer_load_dwordx4 v199, s[20:23], s83 offen offset:1024 lds
    v_mfma_f32_32x32x16_bf16 v[112:127], v[140:143], a[220:223], v[112:127]
    s_lshl_b32 s83, s3, 12
    s_xor_b32 s84, s83, 4096
    v_add_u32 v178, s83, v176
    v_add_u32 v179, s84, v176
    v_add_u32 v180, 65792, v178
    v_add_u32 v181, 65792, v179
    s_waitcnt lgkmcnt(0)
    v_mfma_f32_32x32x16_bf16 v[64:79], v[128:131], a[224:227], v[64:79]
    ds_read_b64_tr_b16 v[136:137], v184 offset:34944
    ds_read_b64_tr_b16 v[138:139], v184 offset:35456
    v_mfma_f32_32x32x16_bf16 v[80:95], v[128:131], a[228:231], v[80:95]
    ds_read_b64_tr_b16 v[140:141], v184 offset:34976
    ds_read_b64_tr_b16 v[142:143], v184 offset:35488
    v_mfma_f32_32x32x16_bf16 v[96:111], v[132:135], a[224:227], v[96:111]
    v_mfma_f32_32x32x16_bf16 v[112:127], v[132:135], a[228:231], v[112:127]
    v_mfma_f32_16x16x32_bf16 v[156:159], v[144:147], v[128:131], v[156:159]
    v_mfma_f32_16x16x32_bf16 v[156:159], v[148:151], v[132:135], v[156:159]
    s_waitcnt lgkmcnt(0)
    v_mfma_f32_16x16x32_bf16 v[156:159], v[144:147], v[136:139], v[156:159]
    ds_read_b64_tr_b16 v[128:129], v185 offset:32896
    ds_read_b64_tr_b16 v[130:131], v185 offset:33408
    v_mfma_f32_16x16x32_bf16 v[156:159], v[148:151], v[140:143], v[156:159]
    ds_read_b64_tr_b16 v[132:133], v185 offset:32928
    ds_read_b64_tr_b16 v[134:135], v185 offset:33440
    s_add_u32 m0, s81, 8224
    v_mfma_f32_32x32x16_bf16 v[64:79], v[136:139], a[232:235], v[64:79]
    buffer_load_dwordx4 v186, s[8:11], s71 offen lds
    buffer_load_dwordx4 v187, s[8:11], s71 offen offset:1024 lds
    v_mfma_f32_32x32x16_bf16 v[80:95], v[136:139], a[236:239], v[80:95]
    v_mfma_f32_32x32x16_bf16 v[96:111], v[140:143], a[232:235], v[96:111]
    ds_write_b32 v191, v156 offset:1024
    v_mfma_f32_32x32x16_bf16 v[112:127], v[140:143], a[236:239], v[112:127]
    s_waitcnt lgkmcnt(1)
    v_mfma_f32_32x32x16_bf16 v[64:79], v[128:131], a[240:243], v[64:79]
    ds_read_b64_tr_b16 v[136:137], v185 offset:34944
    ds_read_b64_tr_b16 v[138:139], v185 offset:35456
    v_mfma_f32_32x32x16_bf16 v[80:95], v[128:131], a[244:247], v[80:95]
    ds_read_b64_tr_b16 v[140:141], v185 offset:34976
    ds_read_b64_tr_b16 v[142:143], v185 offset:35488
    v_mfma_f32_32x32x16_bf16 v[96:111], v[132:135], a[240:243], v[96:111]
    s_mul_i32 s83, s52, 294912
    s_mul_i32 s84, s44, 73728
L_padB1_6:
    s_cbranch_execz L_padB1_10
    s_add_u32 s83, s83, s84
    v_lshl_add_u32 v155, v197, 4, s83
    v_mfma_f32_32x32x16_bf16 v[112:127], v[132:135], a[244:247], v[112:127]
    s_lshl_b32 s83, s52, 2
    s_add_u32 s83, s83, s44
    s_lshl_b32 s83, s83, 8
    s_add_u32 s83, s83, 10747904
    v_and_b32 v176, 7, v197
    v_lshl_add_u32 v253, v176, 2, s83
    s_waitcnt lgkmcnt(0)
    s_barrier
    v_mfma_f32_32x32x16_bf16 v[64:79], v[136:139], a[248:251], v[64:79]
    ds_read_b64_tr_b16 v[128:129], v178 offset:16448
    ds_read_b64_tr_b16 v[130:131], v178 offset:16960
    v_cmp_gt_u32 vcc, 4, v175
    s_nop 4
    s_cbranch_vccz L_ok7
    s_mov_b32 s85, 200000
L_re7:
    s_sleep 1
    buffer_load_dword v175, v174, s[36:39], 0 offen sc1
    s_waitcnt vmcnt(0)
    v_cmp_gt_u32 vcc, 4, v175
    s_sub_u32 s85, s85, 1
    s_cbranch_scc1 L_ok7
    s_nop 2
    s_cbranch_vccnz L_re7
L_ok7:
    v_mfma_f32_32x32x16_bf16 v[80:95], v[136:139], a[252:255], v[80:95]
    ds_read_b64_tr_b16 v[132:133], v178 offset:18496
    ds_read_b64_tr_b16 v[134:135], v178 offset:19008
    v_xor_b32 v176, 0x80, v191
    ds_read_b32 v176, v176 offset:1024
    v_mfma_f32_32x32x16_bf16 v[96:111], v[140:143], a[248:251], v[96:111]
    s_add_u32 m0, s81, 98688
    s_lshl3_add_u32 s83, s63, s94
    buffer_load_dwordx4 v198, s[20:23], s83 offen lds
    buffer_load_dwordx4 v199, s[20:23], s83 offen offset:1024 lds
    s_add_u32 s94, s94, 131072
    v_mfma_f32_32x32x16_bf16 v[112:127], v[140:143], a[252:255], v[112:127]
    s_waitcnt lgkmcnt(0)
    v_add_f32 v176, v176, v156
    v_cvt_pk_bf16_f32 v168, v176, v176
    v_lshlrev_b32 v169, 16, v168
    v_sub_f32 v176, v176, v169
    v_cvt_pk_bf16_f32 v169, v176, 0
    v_mfma_f32_32x32x16_bf16 v[0:15], v[128:131], a[0:3], 0
    ds_read_b64_tr_b16 v[136:137], v179 offset:16448
    v_mfma_f32_32x32x16_bf16 v[64:79], v[168:171], v[160:163], v[64:79]
    buffer_load_dword v188, v253, s[28:31], 0 offen sc1
    v_mfma_f32_32x32x16_bf16 v[16:31], v[128:131], a[4:7], 0
    ds_read_b64_tr_b16 v[138:139], v179 offset:16960
    v_mfma_f32_32x32x16_bf16 v[80:95], v[168:171], v[164:167], v[80:95]
    v_mfma_f32_16x16x32_bf16 v[156:159], v[144:147], v[128:131], 0
    v_mfma_f32_32x32x16_bf16 v[0:15], v[132:135], a[8:11], v[0:15]
    ds_read_b64_tr_b16 v[140:141], v179 offset:18496
    s_add_u32 m0, s81, 106912
    s_lshl3_add_u32 s83, s56, s94
    buffer_load_dwordx4 v198, s[20:23], s83 offen lds
    buffer_load_dwordx4 v199, s[20:23], s83 offen offset:1024 lds
    v_mfma_f32_32x32x16_bf16 v[16:31], v[132:135], a[12:15], v[16:31]
    ds_read_b64_tr_b16 v[142:143], v179 offset:19008
    v_mfma_f32_32x32x16_bf16 v[96:111], v[168:171], v[162:165], v[96:111]
    v_mfma_f32_16x16x32_bf16 v[156:159], v[144:147], v[132:135], v[156:159]
    v_mfma_f32_32x32x16_bf16 v[112:127], v[168:171], v[166:169], v[112:127]
    s_barrier
    s_waitcnt lgkmcnt(2)
    v_mfma_f32_32x32x16_bf16 v[0:15], v[136:139], a[16:19], v[0:15]
    ds_read_b64_tr_b16 v[128:129], v178 offset:24672
    s_add_u32 m0, s81, 115136
    s_lshl3_add_u32 s83, s57, s94
    buffer_load_dwordx4 v198, s[20:23], s83 offen lds
    buffer_load_dwordx4 v199, s[20:23], s83 offen offset:1024 lds
    v_mfma_f32_32x32x16_bf16 v[16:31], v[136:139], a[20:23], v[16:31]
    ds_read_b64_tr_b16 v[130:131], v178 offset:25184
    v_mul_f32 v64, v194, v64
    s_waitcnt lgkmcnt(2)
    v_mfma_f32_32x32x16_bf16 v[0:15], v[140:143], a[24:27], v[0:15]
    ds_read_b64_tr_b16 v[132:133], v178 offset:26720
    v_mul_f32 v65, v194, v65
    v_mul_f32 v64, v64, v72
    v_mul_f32 v65, v65, v73
    v_cvt_pk_bf16_f32 v64, v64, v65
    v_mul_f32 v66, v194, v66
    v_mfma_f32_32x32x16_bf16 v[16:31], v[140:143], a[28:31], v[16:31]
    ds_read_b64_tr_b16 v[134:135], v178 offset:27232
    v_mul_f32 v67, v194, v67
    v_mul_f32 v66, v66, v74
    v_mul_f32 v67, v67, v75
    v_cvt_pk_bf16_f32 v65, v66, v67
    v_mul_f32 v68, v194, v68
    s_waitcnt lgkmcnt(2)
    v_mfma_f32_32x32x16_bf16 v[0:15], v[128:131], a[32:35], v[0:15]
    ds_read_b64_tr_b16 v[136:137], v179 offset:24672
    s_add_u32 m0, s81, 123360
    s_lshl3_add_u32 s83, s58, s94
    buffer_load_dwordx4 v198, s[20:23], s83 offen lds
    buffer_load_dwordx4 v199, s[20:23], s83 offen offset:1024 lds
    v_mul_f32 v69, v194, v69
    v_mfma_f32_32x32x16_bf16 v[16:31], v[128:131], a[36:39], v[16:31]
    ds_read_b64_tr_b16 v[138:139], v179 offset:25184
    v_mul_f32 v68, v68, v76
    v_mul_f32 v69, v69, v77
    v_cvt_pk_bf16_f32 v66, v68, v69
    v_mul_f32 v70, v194, v70
    v_mul_f32 v71, v194, v71
    v_mfma_f32_16x16x32_bf16 v[156:159], v[144:147], v[128:131], v[156:159]
    v_mul_f32 v70, v70, v78
    v_mul_f32 v71, v71, v79
    s_waitcnt lgkmcnt(2)
    v_mfma_f32_32x32x16_bf16 v[0:15], v[132:135], a[40:43], v[0:15]
    ds_read_b64_tr_b16 v[140:141], v179 offset:26720
    v_cvt_pk_bf16_f32 v67, v70, v71
    s_mov_b32 s84, 16384
    buffer_store_dwordx4 v[64:67], v196, s[28:31], s84 offen offset:0 sc1
    v_mul_f32 v80, v195, v80
    v_mul_f32 v81, v195, v81
    v_mfma_f32_32x32x16_bf16 v[16:31], v[132:135], a[44:47], v[16:31]
    ds_read_b64_tr_b16 v[142:143], v179 offset:27232
    v_mul_f32 v80, v80, v88
    v_mul_f32 v81, v81, v89
    v_cvt_pk_bf16_f32 v80, v80, v81
    v_mul_f32 v82, v195, v82
    v_mul_f32 v83, v195, v83
    v_mfma_f32_16x16x32_bf16 v[156:159], v[144:147], v[132:135], v[156:159]
    v_mul_f32 v82, v82, v90
    v_mul_f32 v83, v83, v91
    s_waitcnt vmcnt(29)
    s_barrier
    s_waitcnt lgkmcnt(2)
    v_mfma_f32_32x32x16_bf16 v[0:15], v[136:139], a[48:51], v[0:15]
    ds_read_b64_tr_b16 v[128:129], v178 offset:32896
    s_add_u32 m0, s81, 16448
    s_lshl3_add_u32 s83, s59, s94
    buffer_load_dwordx4 v198, s[20:23], s83 offen lds
    buffer_load_dwordx4 v199, s[20:23], s83 offen offset:1024 lds
    v_cvt_pk_bf16_f32 v81, v82, v83
    v_cndmask_b32 v189, 0, 1, s[92:93]
    s_waitcnt vmcnt(9)
    v_cmp_gt_u32 vcc, v189, v188
    s_nop 4
    s_cbranch_vccz L_ok10
    s_mov_b32 s85, 200000
L_re10:
    s_sleep 1
    buffer_load_dword v188, v253, s[28:31], 0 offen sc1
    s_waitcnt vmcnt(0)
    v_cmp_gt_u32 vcc, v189, v188
    s_sub_u32 s85, s85, 1
    s_cbranch_scc1 L_ok10
    s_nop 2
    s_cbranch_vccnz L_re10
L_ok10:
    s_add_u32 s84, s56, 0
    buffer_load_dwordx4 a[0:3], v155, s[28:31], s84 offen sc1
    buffer_load_dwordx4 a[4:7], v155, s[28:31], s84 offen offset:1024 sc1
    v_mfma_f32_32x32x16_bf16 v[16:31], v[136:139], a[52:55], v[16:31]
    ds_read_b64_tr_b16 v[130:131], v178 offset:33408
    v_mul_f32 v84, v195, v84
    v_mul_f32 v85, v195, v85
    v_mul_f32 v84, v84, v92
    v_mul_f32 v85, v85, v93
    v_cvt_pk_bf16_f32 v82, v84, v85
    s_waitcnt lgkmcnt(2)
    v_mfma_f32_32x32x16_bf16 v[0:15], v[140:143], a[56:59], v[0:15]
    ds_read_b64_tr_b16 v[132:133], v178 offset:34944
    v_mul_f32 v86, v195, v86
    v_mul_f32 v87, v195, v87
    v_mul_f32 v86, v86, v94
    v_mul_f32 v87, v87, v95
    v_cvt_pk_bf16_f32 v83, v86, v87
L_padB1_7:
    s_cbranch_execz L_padB1_11
    v_mfma_f32_32x32x16_bf16 v[16:31], v[140:143], a[60:63], v[16:31]
    ds_read_b64_tr_b16 v[134:135], v178 offset:35456
    s_mov_b32 s84, 16384
    buffer_store_dwordx4 v[80:83], v196, s[28:31], s84 offen offset:1024 sc1
    v_mul_f32 v96, v194, v96
    v_mul_f32 v97, v194, v97
    v_mul_f32 v96, v96, v104
    s_waitcnt lgkmcnt(2)
    v_mfma_f32_32x32x16_bf16 v[0:15], v[128:131], a[64:67], v[0:15]
    ds_read_b64_tr_b16 v[136:137], v179 offset:32896
    v_mul_f32 v97, v97, v105
    v_cvt_pk_bf16_f32 v96, v96, v97
    v_mul_f32 v98, v194, v98
    v_mul_f32 v99, v194, v99
    v_mul_f32 v98, v98, v106
    v_mfma_f32_32x32x16_bf16 v[16:31], v[128:131], a[68:71], v[16:31]
    ds_read_b64_tr_b16 v[138:139], v179 offset:33408
    v_mul_f32 v99, v99, v107
    v_cvt_pk_bf16_f32 v97, v98, v99
    v_mul_f32 v100, v194, v100
    v_mul_f32 v101, v194, v101
    v_mul_f32 v100, v100, v108
    s_add_u32 s84, s57, 0
    buffer_load_dwordx4 a[8:11], v155, s[28:31], s84 offen sc1
    buffer_load_dwordx4 a[12:15], v155, s[28:31], s84 offen offset:1024 sc1
    v_mfma_f32_16x16x32_bf16 v[156:159], v[144:147], v[128:131], v[156:159]
    v_mul_f32 v101, v101, v109
    v_cvt_pk_bf16_f32 v98, v100, v101
    s_waitcnt lgkmcnt(2)
    v_mfma_f32_32x32x16_bf16 v[0:15], v[132:135], a[72:75], v[0:15]
    ds_read_b64_tr_b16 v[140:141], v179 offset:34944
    v_mul_f32 v102, v194, v102
    v_mul_f32 v103, v194, v103
    v_mul_f32 v102, v102, v110
    v_mul_f32 v103, v103, v111
    v_cvt_pk_bf16_f32 v99, v102, v103
    v_mfma_f32_32x32x16_bf16 v[16:31], v[132:135], a[76:79], v[16:31]
    ds_read_b64_tr_b16 v[142:143], v179 offset:35456
    s_mov_b32 s84, 16384
    buffer_store_dwordx4 v[96:99], v196, s[28:31], s84 offen offset:2048 sc1
    v_mul_f32 v112, v195, v112
    v_mul_f32 v113, v195, v113
    v_mul_f32 v112, v112, v120
    v_mfma_f32_16x16x32_bf16 v[156:159], v[144:147], v[132:135], v[156:159]
    v_mul_f32 v113, v113, v121
    v_cvt_pk_bf16_f32 v112, v112, v113
    s_barrier
    s_waitcnt lgkmcnt(2)
    v_mfma_f32_32x32x16_bf16 v[0:15], v[136:139], a[80:83], v[0:15]
    ds_read_b64_tr_b16 v[128:129], v180 offset:0
    s_add_u32 m0, s81, 24672
    s_lshl3_add_u32 s83, s60, s94
    buffer_load_dwordx4 v198, s[20:23], s83 offen lds
    buffer_load_dwordx4 v199, s[20:23], s83 offen offset:1024 lds
    v_mul_f32 v114, v195, v114
    s_add_u32 s84, s58, 0
    buffer_load_dwordx4 a[16:19], v155, s[28:31], s84 offen sc1
    buffer_load_dwordx4 a[20:23], v155, s[28:31], s84 offen offset:1024 sc1
    v_mfma_f32_32x32x16_bf16 v[16:31], v[136:139], a[84:87], v[16:31]
    ds_read_b64_tr_b16 v[130:131], v180 offset:512
    v_mul_f32 v115, v195, v115
    v_mul_f32 v114, v114, v122
    v_mul_f32 v115, v115, v123
    v_cvt_pk_bf16_f32 v113, v114, v115
    v_mul_f32 v116, v195, v116
    s_waitcnt lgkmcnt(2)
    v_mfma_f32_32x32x16_bf16 v[0:15], v[140:143], a[88:91], v[0:15]
    ds_read_b64_tr_b16 v[132:133], v180 offset:2048
    v_mul_f32 v117, v195, v117
    v_mul_f32 v116, v116, v124
    v_mul_f32 v117, v117, v125
    v_cvt_pk_bf16_f32 v114, v116, v117
    v_mul_f32 v118, v195, v118
    v_mfma_f32_32x32x16_bf16 v[16:31], v[140:143], a[92:95], v[16:31]
    ds_read_b64_tr_b16 v[134:135], v180 offset:2560
    v_mul_f32 v119, v195, v119
    v_mul_f32 v118, v118, v126
    v_mul_f32 v119, v119, v127
    v_cvt_pk_bf16_f32 v115, v118, v119
    s_mov_b32 s84, 16384
    buffer_store_dwordx4 v[112:115], v196, s[28:31], s84 offen offset:3072 sc1
    s_waitcnt lgkmcnt(2)
    v_mfma_f32_32x32x16_bf16 v[0:15], v[128:131], a[96:99], v[0:15]
    ds_read_b64_tr_b16 v[136:137], v181 offset:0
    v_lshrrev_b32 v183, 5, v197
    v_mfma_f32_32x32x16_bf16 v[16:31], v[128:131], a[100:103], v[16:31]
    ds_read_b64_tr_b16 v[138:139], v181 offset:512
    v_lshlrev_b32 v183, 9, v183
    s_add_u32 s84, s59, 0
    buffer_load_dwordx4 a[24:27], v155, s[28:31], s84 offen sc1
    buffer_load_dwordx4 a[28:31], v155, s[28:31], s84 offen offset:1024 sc1
    v_mfma_f32_16x16x32_bf16 v[156:159], v[144:147], v[128:131], v[156:159]
    s_waitcnt lgkmcnt(2)
    v_mfma_f32_32x32x16_bf16 v[0:15], v[132:135], a[104:107], v[0:15]
    ds_read_b64_tr_b16 v[140:141], v181 offset:2048
    v_mfma_f32_32x32x16_bf16 v[16:31], v[132:135], a[108:111], v[16:31]
    ds_read_b64_tr_b16 v[142:143], v181 offset:2560
    v_bfe_u32 v184, v197, 2, 2
    v_mfma_f32_16x16x32_bf16 v[156:159], v[144:147], v[132:135], v[156:159]
    s_barrier
    s_waitcnt lgkmcnt(2)
    v_mfma_f32_32x32x16_bf16 v[0:15], v[136:139], a[112:115], v[0:15]
    ds_read_b64_tr_b16 v[128:129], v180 offset:8224
    s_add_u32 m0, s81, 32896
    s_lshl3_add_u32 s83, s61, s94
    buffer_load_dwordx4 v198, s[20:23], s83 offen lds
    buffer_load_dwordx4 v199, s[20:23], s83 offen offset:1024 lds
    s_add_u32 s84, s60, 0
    buffer_load_dwordx4 a[32:35], v155, s[28:31], s84 offen sc1
    buffer_load_dwordx4 a[36:39], v155, s[28:31], s84 offen offset:1024 sc1
    v_mfma_f32_32x32x16_bf16 v[16:31], v[136:139], a[116:119], v[16:31]
    ds_read_b64_tr_b16 v[130:131], v180 offset:8736
    v_lshl_add_u32 v183, v184, 7, v183
    s_waitcnt lgkmcnt(2)
    v_mfma_f32_32x32x16_bf16 v[0:15], v[140:143], a[120:123], v[0:15]
    ds_read_b64_tr_b16 v[132:133], v180 offset:10272
    v_mfma_f32_32x32x16_bf16 v[16:31], v[140:143], a[124:127], v[16:31]
    ds_read_b64_tr_b16 v[134:135], v180 offset:10784
    v_and_b32 v184, 3, v197
    s_waitcnt lgkmcnt(2)
    v_mfma_f32_32x32x16_bf16 v[0:15], v[128:131], a[128:131], v[0:15]
    ds_read_b64_tr_b16 v[136:137], v181 offset:8224
    v_lshl_add_u32 v183, v184, 3, v183
    v_mfma_f32_32x32x16_bf16 v[16:31], v[128:131], a[132:135], v[16:31]
    ds_read_b64_tr_b16 v[138:139], v181 offset:8736
    s_add_u32 s84, s61, 0
    buffer_load_dwordx4 a[40:43], v155, s[28:31], s84 offen sc1
    buffer_load_dwordx4 a[44:47], v155, s[28:31], s84 offen offset:1024 sc1
    v_mfma_f32_16x16x32_bf16 v[156:159], v[144:147], v[128:131], v[156:159]
    s_waitcnt lgkmcnt(2)
    v_mfma_f32_32x32x16_bf16 v[0:15], v[132:135], a[136:139], v[0:15]
    ds_read_b64_tr_b16 v[140:141], v181 offset:10272
    v_bfe_u32 v184, v197, 3, 1
    v_mfma_f32_32x32x16_bf16 v[16:31], v[132:135], a[140:143], v[16:31]
    ds_read_b64_tr_b16 v[142:143], v181 offset:10784
    v_lshl_add_u32 v183, v184, 6, v183
    v_mfma_f32_16x16x32_bf16 v[156:159], v[144:147], v[132:135], v[156:159]
    s_barrier
    s_waitcnt lgkmcnt(2)
    v_mfma_f32_32x32x16_bf16 v[0:15], v[136:139], a[144:147], v[0:15]
    ds_read_b64_tr_b16 v[128:129], v178 offset:57568
    s_add_u32 m0, s81, 65792
    s_lshl3_add_u32 s83, s62, s94
    buffer_load_dwordx4 v198, s[20:23], s83 offen lds
    buffer_load_dwordx4 v199, s[20:23], s83 offen offset:1024 lds
    s_add_u32 s84, s62, 0
    buffer_load_dwordx4 a[48:51], v155, s[28:31], s84 offen sc1
    buffer_load_dwordx4 a[52:55], v155, s[28:31], s84 offen offset:1024 sc1
    v_mfma_f32_32x32x16_bf16 v[16:31], v[136:139], a[148:151], v[16:31]
    ds_read_b64_tr_b16 v[130:131], v178 offset:58080
    s_waitcnt lgkmcnt(2)
    v_mfma_f32_32x32x16_bf16 v[0:15], v[140:143], a[152:155], v[0:15]
    ds_read_b64_tr_b16 v[132:133], v178 offset:59616
    v_bfe_u32 v184, v197, 4, 1
    v_mfma_f32_32x32x16_bf16 v[16:31], v[140:143], a[156:159], v[16:31]
    ds_read_b64_tr_b16 v[134:135], v178 offset:60128
    v_lshl_add_u32 v183, v184, 5, v183
L_padB0_2:
    s_cbranch_execz L_retB0
    s_waitcnt lgkmcnt(2)
    v_mfma_f32_32x32x16_bf16 v[0:15], v[128:131], a[160:163], v[0:15]
    ds_read_b64_tr_b16 v[136:137], v179 offset:57568
    v_mfma_f32_32x32x16_bf16 v[16:31], v[128:131], a[164:167], v[16:31]
    ds_read_b64_tr_b16 v[138:139], v179 offset:58080
    v_xor_b32 v184, 64, v183
    s_add_u32 s84, s63, 0
    buffer_load_dwordx4 a[56:59], v155, s[28:31], s84 offen sc1
    buffer_load_dwordx4 a[60:63], v155, s[28:31], s84 offen offset:1024 sc1
    v_mfma_f32_16x16x32_bf16 v[156:159], v[144:147], v[128:131], v[156:159]
    s_waitcnt lgkmcnt(2)
    v_mfma_f32_32x32x16_bf16 v[0:15], v[132:135], a[168:171], v[0:15]
    ds_read_b64_tr_b16 v[140:141], v179 offset:59616
    v_add_u32 v174, s81, v183
    v_mfma_f32_32x32x16_bf16 v[16:31], v[132:135], a[172:175], v[16:31]
    ds_read_b64_tr_b16 v[142:143], v179 offset:60128
    v_mfma_f32_16x16x32_bf16 v[156:159], v[144:147], v[132:135], v[156:159]
    s_barrier
    s_waitcnt lgkmcnt(2)
    v_mfma_f32_32x32x16_bf16 v[0:15], v[136:139], a[176:179], v[0:15]
    ds_read_b64_tr_b16 v[128:129], v180 offset:24672
    s_add_u32 m0, s81, 74016
    s_lshl3_add_u32 s83, s63, s94
    buffer_load_dwordx4 v198, s[20:23], s83 offen lds
    buffer_load_dwordx4 v199, s[20:23], s83 offen offset:1024 lds
    s_add_u32 s94, s94, 131072
    v_mfma_f32_32x32x16_bf16 v[16:31], v[136:139], a[180:183], v[16:31]
    ds_read_b64_tr_b16 v[130:131], v180 offset:25184
    v_add_u32 v175, s81, v184
    s_waitcnt lgkmcnt(2)
    v_mfma_f32_32x32x16_bf16 v[0:15], v[140:143], a[184:187], v[0:15]
    ds_read_b64_tr_b16 v[132:133], v180 offset:26720
    v_add_u32 v176, 65792, v174
    v_mfma_f32_32x32x16_bf16 v[16:31], v[140:143], a[188:191], v[16:31]
    ds_read_b64_tr_b16 v[134:135], v180 offset:27232
    s_waitcnt lgkmcnt(2)
    v_mfma_f32_32x32x16_bf16 v[0:15], v[128:131], a[192:195], v[0:15]
    ds_read_b64_tr_b16 v[136:137], v181 offset:24672
    v_add_u32 v177, 65792, v175
    v_mfma_f32_32x32x16_bf16 v[16:31], v[128:131], a[196:199], v[16:31]
    ds_read_b64_tr_b16 v[138:139], v181 offset:25184
    v_mfma_f32_16x16x32_bf16 v[156:159], v[144:147], v[128:131], v[156:159]
    s_waitcnt lgkmcnt(2)
    v_mfma_f32_32x32x16_bf16 v[0:15], v[132:135], a[200:203], v[0:15]
    ds_read_b64_tr_b16 v[140:141], v181 offset:26720
    v_mfma_f32_32x32x16_bf16 v[16:31], v[132:135], a[204:207], v[16:31]
    ds_read_b64_tr_b16 v[142:143], v181 offset:27232
    v_mfma_f32_16x16x32_bf16 v[156:159], v[144:147], v[132:135], v[156:159]
    s_barrier
    s_waitcnt lgkmcnt(2)
    v_mfma_f32_32x32x16_bf16 v[0:15], v[136:139], a[208:211], v[0:15]
    ds_read_b64_tr_b16 v[128:129], v178 offset:8224
    v_mfma_f32_32x32x16_bf16 v[16:31], v[136:139], a[212:215], v[16:31]
    ds_read_b64_tr_b16 v[130:131], v178 offset:8736
    s_waitcnt lgkmcnt(2)
    v_mfma_f32_32x32x16_bf16 v[0:15], v[140:143], a[216:219], v[0:15]
    ds_read_b64_tr_b16 v[132:133], v178 offset:10272
    s_waitcnt vmcnt(16)
    v_mov_b32 v190, 2
    buffer_store_dword v190, v252, s[28:31], 0 offen sc1
    v_mfma_f32_32x32x16_bf16 v[16:31], v[140:143], a[220:223], v[16:31]
    ds_read_b64_tr_b16 v[134:135], v178 offset:10784
    s_waitcnt lgkmcnt(2)
    v_mfma_f32_32x32x16_bf16 v[0:15], v[128:131], a[224:227], v[0:15]
    ds_read_b64_tr_b16 v[136:137], v179 offset:8224
    s_mov_b32 s84, 0
    buffer_load_dwordx4 v[80:83], v153, s[28:31], s84 offen sc1
    s_mov_b32 s84, 8704
    buffer_load_dwordx4 v[84:87], v153, s[28:31], s84 offen sc1
    v_mfma_f32_32x32x16_bf16 v[16:31], v[128:131], a[228:231], v[16:31]
    ds_read_b64_tr_b16 v[138:139], v179 offset:8736
    s_mov_b32 s84, 17408
    buffer_load_dwordx4 v[88:91], v153, s[28:31], s84 offen sc1
    s_mov_b32 s84, 26112
    buffer_load_dwordx4 v[92:95], v153, s[28:31], s84 offen sc1
    v_mfma_f32_16x16x32_bf16 v[156:159], v[144:147], v[128:131], v[156:159]
    buffer_load_dword v182, v253, s[28:31], 0 offen sc1
    s_waitcnt lgkmcnt(2)
    v_mfma_f32_32x32x16_bf16 v[0:15], v[132:135], a[232:235], v[0:15]
    ds_read_b64_tr_b16 v[140:141], v179 offset:10272
    v_mfma_f32_32x32x16_bf16 v[16:31], v[132:135], a[236:239], v[16:31]
    ds_read_b64_tr_b16 v[142:143], v179 offset:10784
    v_mfma_f32_16x16x32_bf16 v[156:159], v[144:147], v[132:135], v[156:159]
    s_waitcnt lgkmcnt(2)
    v_mfma_f32_32x32x16_bf16 v[0:15], v[136:139], a[240:243], v[0:15]
    s_add_u32 m0, s81, 57568
    s_lshl3_add_u32 s83, s56, s94
    buffer_load_dwordx4 v198, s[20:23], s83 offen lds
    buffer_load_dwordx4 v199, s[20:23], s83 offen offset:1024 lds
    v_mfma_f32_32x32x16_bf16 v[16:31], v[136:139], a[244:247], v[16:31]
    s_nop 0
    ds_write_b32 v191, v156 offset:2048
    v_add_u32 v178, 131584, v174
    v_add_u32 v179, 131584, v175
    s_waitcnt lgkmcnt(0)
    s_barrier
    v_mfma_f32_32x32x16_bf16 v[0:15], v[140:143], a[248:251], v[0:15]
    ds_read_b64_tr_b16 v[128:129], v178 offset:0
    ds_read_b64_tr_b16 v[130:131], v178 offset:1024
    v_xor_b32 v183, 0x80, v191
    ds_read_b32 v183, v183 offset:2048
    v_mfma_f32_32x32x16_bf16 v[16:31], v[140:143], a[252:255], v[16:31]
    ds_read_b64_tr_b16 v[132:133], v179 offset:0
    ds_read_b64_tr_b16 v[134:135], v179 offset:1024
    s_waitcnt lgkmcnt(2)
    v_add_f32 v183, v183, v156
    v_cvt_pk_bf16_f32 v168, v183, v183
    v_lshlrev_b32 v169, 16, v168
    v_sub_f32 v183, v183, v169
    v_cvt_pk_bf16_f32 v169, v183, 0
    v_mfma_f32_32x32x16_bf16 v[96:111], v[128:131], a[0:3], 0
    s_add_u32 m0, s81, 8224
    s_lshl3_add_u32 s83, s57, s94
    buffer_load_dwordx4 v198, s[20:23], s83 offen lds
    buffer_load_dwordx4 v199, s[20:23], s83 offen offset:1024 lds
    ds_read_b64_tr_b16 v[136:137], v178 offset:8224
    v_mfma_f32_32x32x16_bf16 v[0:15], v[168:171], v[160:163], v[0:15]
    v_mfma_f32_32x32x16_bf16 v[16:31], v[168:171], v[164:167], v[16:31]
    v_mfma_f32_32x32x16_bf16 v[112:127], v[128:131], a[4:7], 0
    s_add_u32 m0, s81, 90464
    s_lshl3_add_u32 s83, s58, s94
    buffer_load_dwordx4 v198, s[20:23], s83 offen lds
    buffer_load_dwordx4 v199, s[20:23], s83 offen offset:1024 lds
    ds_read_b64_tr_b16 v[138:139], v178 offset:9248
    s_nop 4
    v_cvt_pk_bf16_f32 v64, v0, v1
    v_cvt_pk_bf16_f32 v65, v2, v3
    v_cvt_pk_bf16_f32 v66, v4, v5
    v_cvt_pk_bf16_f32 v67, v6, v7
    v_cvt_pk_bf16_f32 v68, v8, v9
    v_cvt_pk_bf16_f32 v69, v10, v11
    v_cvt_pk_bf16_f32 v70, v12, v13
    v_cvt_pk_bf16_f32 v71, v14, v15
    v_mfma_f32_32x32x16_bf16 v[0:15], v[200:203], v[64:67], 0
    s_nop 0
    v_mfma_f32_32x32x16_bf16 v[0:15], v[204:207], v[68:71], v[0:15]
    v_cvt_pk_bf16_f32 v72, v16, v17
    v_cvt_pk_bf16_f32 v73, v18, v19
    v_cvt_pk_bf16_f32 v74, v20, v21
    v_cvt_pk_bf16_f32 v75, v22, v23
    v_cvt_pk_bf16_f32 v76, v24, v25
    v_cvt_pk_bf16_f32 v77, v26, v27
    v_cvt_pk_bf16_f32 v78, v28, v29
    v_cvt_pk_bf16_f32 v79, v30, v31
L_padB1_8:
    s_cbranch_execz L_padB1_12
    v_mfma_f32_32x32x16_bf16 v[16:31], v[200:203], v[72:75], 0
    s_waitcnt lgkmcnt(2)
    v_mfma_f32_32x32x16_bf16 v[208:223], v[132:135], a[0:3], 0
    ds_read_b64_tr_b16 v[140:141], v179 offset:8224
    s_add_u32 m0, s81, 131584
    s_lshl3_add_u32 s83, s59, s94
    buffer_load_dwordx4 v198, s[20:23], s83 offen lds
    buffer_load_dwordx4 v199, s[20:23], s83 offen offset:1024 lds
    v_mfma_f32_32x32x16_bf16 v[16:31], v[204:207], v[76:79], v[16:31]
    v_max3_f32 v248, v0, v1, v2
    v_min3_f32 v249, v0, v1, v2
    v_max3_f32 v248, v248, v3, v4
    v_min3_f32 v249, v249, v3, v4
    v_max3_f32 v248, v248, v5, v6
    v_min3_f32 v249, v249, v5, v6
    v_max_f32 v248, v248, v7
    v_max_f32_e64 v249, -v249, -v7
    s_nop 1
    v_permlane32_swap_b32 v248, v249
    v_max_f32 v248, v248, v249
    v_mul_f32_e64 v248, -v248, v172
    v_mov_b32 v249, v248
    s_nop 1
    v_permlane32_swap_b32 v248, v249
    v_fma_f32 v240, v0, v172, v248
    v_fma_f32 v0, -v0, v172, v249
    v_exp_f32 v240, v240
    v_exp_f32 v0, v0
    v_fma_f32 v241, v1, v172, v248
    v_fma_f32 v1, -v1, v172, v249
    v_exp_f32 v241, v241
    v_exp_f32 v1, v1
    v_fma_f32 v242, v2, v172, v248
    s_waitcnt vmcnt(12)
    v_max3_u32 v254, v80, v81, v82
    s_waitcnt vmcnt(11)
    v_max3_u32 v254, v254, v83, v84
    v_max3_u32 v254, v254, v85, v86
    s_waitcnt vmcnt(10)
    v_max3_u32 v254, v254, v87, v88
    v_max3_u32 v254, v254, v89, v90
    s_waitcnt vmcnt(9)
    v_max3_u32 v254, v254, v91, v92
    v_max3_u32 v254, v254, v93, v94
    v_max_u32 v254, v254, v95
    v_cmp_eq_u32 vcc, -1, v254
    s_nop 4
    s_cbranch_vccz L_ok8
    s_mov_b32 s85, 200000
L_re8:
    s_sleep 1
    s_mov_b32 s84, 0
    buffer_load_dwordx4 v[80:83], v153, s[28:31], s84 offen sc1
    s_mov_b32 s84, 8704
    buffer_load_dwordx4 v[84:87], v153, s[28:31], s84 offen sc1
    s_mov_b32 s84, 17408
    buffer_load_dwordx4 v[88:91], v153, s[28:31], s84 offen sc1
    s_mov_b32 s84, 26112
    buffer_load_dwordx4 v[92:95], v153, s[28:31], s84 offen sc1
    s_waitcnt vmcnt(0)
    v_max3_u32 v254, v80, v81, v82
    v_max3_u32 v254, v254, v83, v84
    v_max3_u32 v254, v254, v85, v86
    v_max3_u32 v254, v254, v87, v88
    v_max3_u32 v254, v254, v89, v90
    v_max3_u32 v254, v254, v91, v92
    v_max3_u32 v254, v254, v93, v94
    v_max_u32 v254, v254, v95
    v_cmp_eq_u32 vcc, -1, v254
    s_sub_u32 s85, s85, 1
    s_cbranch_scc1 L_ok8
    s_nop 2
    s_cbranch_vccnz L_re8
L_ok8:
    v_add_f32 v80, v80, v84
    v_add_f32 v88, v88, v92
    v_add_f32 v81, v81, v85
    v_add_f32 v89, v89, v93
    v_add_f32 v82, v82, v86
    v_add_f32 v90, v90, v94
    v_add_f32 v83, v83, v87
    v_add_f32 v91, v91, v95
    v_add_f32 v80, v80, v88
    v_add_f32 v81, v81, v89
    v_add_f32 v82, v82, v90
    v_add_f32 v83, v83, v91
    v_permlane16_swap_b32 v80, v81
    s_nop 0
    v_permlane16_swap_b32 v82, v83
    v_add_f32 v80, v80, v81
    v_add_f32 v82, v82, v83
    s_nop 1
    v_permlane32_swap_b32 v80, v82
    v_add_f32 v80, v80, v82
    buffer_store_dword v80, v154, s[28:31], 0 offen sc1
    v_mfma_f32_32x32x16_bf16 v[224:239], v[132:135], a[4:7], 0
    ds_read_b64_tr_b16 v[142:143], v179 offset:9248
    v_fma_f32 v2, -v2, v172, v249
    v_add_f32 v250, v240, v241
    v_exp_f32 v242, v242
    v_add_f32 v251, v0, v1
    v_exp_f32 v2, v2
    v_fma_f32 v243, v3, v172, v248
    v_fma_f32 v3, -v3, v172, v249
    v_add_f32 v250, v250, v242
    v_exp_f32 v243, v243
    v_add_f32 v251, v251, v2
    v_exp_f32 v3, v3
    v_fma_f32 v244, v4, v172, v248
    v_fma_f32 v4, -v4, v172, v249
    v_add_f32 v250, v250, v243
    v_exp_f32 v244, v244
    v_add_f32 v251, v251, v3
    v_exp_f32 v4, v4
    v_fma_f32 v245, v5, v172, v248
    v_fma_f32 v5, -v5, v172, v249
    v_add_f32 v250, v250, v244
    v_exp_f32 v245, v245
    v_add_f32 v251, v251, v4
    v_exp_f32 v5, v5
    v_fma_f32 v246, v6, v172, v248
    v_fma_f32 v6, -v6, v172, v249
    v_add_f32 v250, v250, v245
    v_exp_f32 v246, v246
    v_add_f32 v251, v251, v5
    s_waitcnt lgkmcnt(2)
    v_mfma_f32_32x32x16_bf16 v[96:111], v[136:139], a[8:11], v[96:111]
    ds_read_b64_tr_b16 v[128:129], v174 offset:41120
    v_exp_f32 v6, v6
    v_fma_f32 v247, v7, v172, v248
    v_fma_f32 v7, -v7, v172, v249
    v_add_f32 v250, v250, v246
    v_exp_f32 v247, v247
    v_add_f32 v251, v251, v6
    v_exp_f32 v7, v7
    v_add_f32 v250, v250, v247
    v_add_f32 v251, v251, v7
    s_nop 1
    v_permlane32_swap_b32 v250, v251
    v_add_f32 v250, v250, v251
    v_rcp_f32 v250, v250
    s_nop 0
    v_mov_b32 v251, v250
    s_nop 1
    v_permlane32_swap_b32 v250, v251
    v_mul_f32 v0, v251, v0
    v_mul_f32 v1, v251, v1
    v_cvt_pk_bf16_f32 v0, v0, v1
    v_mul_f32 v2, v251, v2
    v_mul_f32 v3, v251, v3
    v_cvt_pk_bf16_f32 v1, v2, v3
    v_mul_f32 v4, v251, v4
    v_mul_f32 v5, v251, v5
    v_cvt_pk_bf16_f32 v2, v4, v5
    v_mul_f32 v6, v251, v6
    v_mul_f32 v7, v251, v7
    v_cvt_pk_bf16_f32 v3, v6, v7
    v_mul_f32 v240, v250, v240
    v_mul_f32 v241, v250, v241
    v_cvt_pk_bf16_f32 v4, v240, v241
    v_mul_f32 v242, v250, v242
    v_mul_f32 v243, v250, v243
    v_cvt_pk_bf16_f32 v5, v242, v243
    v_mfma_f32_32x32x16_bf16 v[112:127], v[136:139], a[12:15], v[112:127]
    ds_read_b64_tr_b16 v[130:131], v174 offset:42144
    v_mul_f32 v244, v250, v244
    v_mul_f32 v245, v250, v245
    v_cvt_pk_bf16_f32 v6, v244, v245
    v_mul_f32 v246, v250, v246
    v_mul_f32 v247, v250, v247
    v_cvt_pk_bf16_f32 v7, v246, v247
    v_max3_f32 v248, v8, v9, v10
    v_min3_f32 v249, v8, v9, v10
    v_max3_f32 v248, v248, v11, v12
    v_min3_f32 v249, v249, v11, v12
    v_max3_f32 v248, v248, v13, v14
    v_min3_f32 v249, v249, v13, v14
    v_max_f32 v248, v248, v15
    v_max_f32_e64 v249, -v249, -v15
    s_nop 1
    v_permlane32_swap_b32 v248, v249
L_padB1_9:
    s_cbranch_execz L_padB1_13
    v_max_f32 v248, v248, v249
    v_mul_f32_e64 v248, -v248, v172
    v_mov_b32 v249, v248
    s_nop 1
    v_permlane32_swap_b32 v248, v249
    v_fma_f32 v240, v8, v172, v248
    v_fma_f32 v8, -v8, v172, v249
    v_exp_f32 v240, v240
    v_exp_f32 v8, v8
    v_fma_f32 v241, v9, v172, v248
    v_fma_f32 v9, -v9, v172, v249
    v_exp_f32 v241, v241
    v_exp_f32 v9, v9
    v_fma_f32 v242, v10, v172, v248
    v_fma_f32 v10, -v10, v172, v249
    v_add_f32 v250, v240, v241
    v_exp_f32 v242, v242
    v_add_f32 v251, v8, v9
    s_waitcnt lgkmcnt(2)
    v_mfma_f32_32x32x16_bf16 v[208:223], v[140:143], a[8:11], v[208:223]
    ds_read_b64_tr_b16 v[132:133], v175 offset:41120
    s_add_u32 m0, s81, 139808
    s_lshl3_add_u32 s83, s60, s94
    buffer_load_dwordx4 v198, s[20:23], s83 offen lds
    buffer_load_dwordx4 v199, s[20:23], s83 offen offset:1024 lds
    v_exp_f32 v10, v10
    v_fma_f32 v243, v11, v172, v248
    v_fma_f32 v11, -v11, v172, v249
    v_add_f32 v250, v250, v242
    v_exp_f32 v243, v243
    v_add_f32 v251, v251, v10
    v_exp_f32 v11, v11
    v_fma_f32 v244, v12, v172, v248
    v_fma_f32 v12, -v12, v172, v249
    v_add_f32 v250, v250, v243
    v_exp_f32 v244, v244
    v_add_f32 v251, v251, v11
    v_exp_f32 v12, v12
    v_fma_f32 v245, v13, v172, v248
    v_fma_f32 v13, -v13, v172, v249
    v_add_f32 v250, v250, v244
    v_exp_f32 v245, v245
    v_add_f32 v251, v251, v12
    v_exp_f32 v13, v13
    v_fma_f32 v246, v14, v172, v248
    v_fma_f32 v14, -v14, v172, v249
    v_add_f32 v250, v250, v245
    v_exp_f32 v246, v246
    v_add_f32 v251, v251, v13
    v_cndmask_b32 v189, 0, 2, s[92:93]
    s_waitcnt vmcnt(11)
    v_cmp_gt_u32 vcc, v189, v182
    s_nop 4
    s_cbranch_vccz L_ok11
    s_mov_b32 s85, 200000
L_re11:
    s_sleep 1
    buffer_load_dword v182, v253, s[28:31], 0 offen sc1
    s_waitcnt vmcnt(0)
    v_cmp_gt_u32 vcc, v189, v182
    s_sub_u32 s85, s85, 1
    s_cbranch_scc1 L_ok11
    s_nop 2
    s_cbranch_vccnz L_re11
L_ok11:
    s_add_u32 s84, s56, 16384
    buffer_load_dwordx4 a[64:67], v155, s[28:31], s84 offen sc1
    buffer_load_dwordx4 a[68:71], v155, s[28:31], s84 offen offset:1024 sc1
    v_mfma_f32_32x32x16_bf16 v[224:239], v[140:143], a[12:15], v[224:239]
    ds_read_b64_tr_b16 v[134:135], v175 offset:42144
    v_exp_f32 v14, v14
    v_fma_f32 v247, v15, v172, v248
    v_fma_f32 v15, -v15, v172, v249
    v_add_f32 v250, v250, v246
    v_exp_f32 v247, v247
    v_add_f32 v251, v251, v14
    v_exp_f32 v15, v15
    v_add_f32 v250, v250, v247
    v_add_f32 v251, v251, v15
    s_nop 1
    v_permlane32_swap_b32 v250, v251
    v_add_f32 v250, v250, v251
    v_rcp_f32 v250, v250
    s_nop 0
    v_mov_b32 v251, v250
    s_nop 1
    v_permlane32_swap_b32 v250, v251
    v_mul_f32 v8, v251, v8
    v_mul_f32 v9, v251, v9
    v_cvt_pk_bf16_f32 v8, v8, v9
    v_mul_f32 v10, v251, v10
    v_mul_f32 v11, v251, v11
    v_cvt_pk_bf16_f32 v9, v10, v11
    v_mul_f32 v12, v251, v12
    v_mul_f32 v13, v251, v13
    v_cvt_pk_bf16_f32 v10, v12, v13
    v_mul_f32 v14, v251, v14
    v_mul_f32 v15, v251, v15
    v_cvt_pk_bf16_f32 v11, v14, v15
    v_mul_f32 v240, v250, v240
    v_mul_f32 v241, v250, v241
    v_cvt_pk_bf16_f32 v12, v240, v241
    v_mul_f32 v242, v250, v242
    v_mul_f32 v243, v250, v243
    v_cvt_pk_bf16_f32 v13, v242, v243
    v_mul_f32 v244, v250, v244
    s_waitcnt lgkmcnt(2)
    v_mfma_f32_32x32x16_bf16 v[96:111], v[128:131], a[16:19], v[96:111]
    ds_read_b64_tr_b16 v[136:137], v178 offset:16448
    v_mul_f32 v245, v250, v245
    v_cvt_pk_bf16_f32 v14, v244, v245
    v_mul_f32 v246, v250, v246
    v_mul_f32 v247, v250, v247
    v_cvt_pk_bf16_f32 v15, v246, v247
    v_max3_f32 v248, v16, v17, v18
    v_min3_f32 v249, v16, v17, v18
    v_max3_f32 v248, v248, v19, v20
    v_min3_f32 v249, v249, v19, v20
    v_max3_f32 v248, v248, v21, v22
    v_min3_f32 v249, v249, v21, v22
    v_max_f32 v248, v248, v23
    v_max_f32_e64 v249, -v249, -v23
    s_nop 1
    v_permlane32_swap_b32 v248, v249
    v_max_f32 v248, v248, v249
    v_mul_f32_e64 v248, -v248, v173
    v_mov_b32 v249, v248
    s_nop 1
    v_permlane32_swap_b32 v248, v249
    v_fma_f32 v240, v16, v173, v248
    v_fma_f32 v16, -v16, v173, v249
    v_exp_f32 v240, v240
    v_exp_f32 v16, v16
    v_fma_f32 v241, v17, v173, v248
    v_fma_f32 v17, -v17, v173, v249
    v_exp_f32 v241, v241
    v_exp_f32 v17, v17
    v_fma_f32 v242, v18, v173, v248
    v_fma_f32 v18, -v18, v173, v249
    v_add_f32 v250, v240, v241
    v_exp_f32 v242, v242
    v_add_f32 v251, v16, v17
    s_add_u32 s84, s57, 16384
    buffer_load_dwordx4 a[72:75], v155, s[28:31], s84 offen sc1
    buffer_load_dwordx4 a[76:79], v155, s[28:31], s84 offen offset:1024 sc1
    v_mfma_f32_32x32x16_bf16 v[112:127], v[128:131], a[20:23], v[112:127]
    ds_read_b64_tr_b16 v[138:139], v178 offset:17472
    v_exp_f32 v18, v18
    v_fma_f32 v243, v19, v173, v248
    v_fma_f32 v19, -v19, v173, v249
    v_add_f32 v250, v250, v242
    v_exp_f32 v243, v243
    v_add_f32 v251, v251, v18
    v_exp_f32 v19, v19
    v_fma_f32 v244, v20, v173, v248
    v_fma_f32 v20, -v20, v173, v249
    v_add_f32 v250, v250, v243
    v_exp_f32 v244, v244
    v_add_f32 v251, v251, v19
    v_exp_f32 v20, v20
    v_fma_f32 v245, v21, v173, v248
    v_fma_f32 v21, -v21, v173, v249
    v_add_f32 v250, v250, v244
    v_exp_f32 v245, v245
    v_add_f32 v251, v251, v20
    v_exp_f32 v21, v21
    v_fma_f32 v246, v22, v173, v248
    v_fma_f32 v22, -v22, v173, v249
    v_add_f32 v250, v250, v245
    v_exp_f32 v246, v246
    v_add_f32 v251, v251, v21
    v_exp_f32 v22, v22
    v_fma_f32 v247, v23, v173, v248
    v_fma_f32 v23, -v23, v173, v249
    v_add_f32 v250, v250, v246
    s_waitcnt lgkmcnt(2)
    v_mfma_f32_32x32x16_bf16 v[208:223], v[132:135], a[16:19], v[208:223]
    ds_read_b64_tr_b16 v[140:141], v179 offset:16448
    s_add_u32 m0, s81, 41120
    s_lshl3_add_u32 s83, s61, s94
    buffer_load_dwordx4 v198, s[20:23], s83 offen lds
    buffer_load_dwordx4 v199, s[20:23], s83 offen offset:1024 lds
    v_exp_f32 v247, v247
L_padB1_10:
    s_cbranch_execz L_padB1_14
    v_add_f32 v251, v251, v22
    v_exp_f32 v23, v23
    v_add_f32 v250, v250, v247
    v_add_f32 v251, v251, v23
    s_nop 1
    v_permlane32_swap_b32 v250, v251
    v_add_f32 v250, v250, v251
    v_rcp_f32 v250, v250
    s_nop 0
    v_mov_b32 v251, v250
    s_nop 1
    v_permlane32_swap_b32 v250, v251
    v_mul_f32 v16, v251, v16
    v_mul_f32 v17, v251, v17
    v_cvt_pk_bf16_f32 v16, v16, v17
    v_mul_f32 v18, v251, v18
    v_mul_f32 v19, v251, v19
    v_cvt_pk_bf16_f32 v17, v18, v19
    v_mul_f32 v20, v251, v20
    v_mul_f32 v21, v251, v21
    v_cvt_pk_bf16_f32 v18, v20, v21
    v_mul_f32 v22, v251, v22
    v_mul_f32 v23, v251, v23
    v_cvt_pk_bf16_f32 v19, v22, v23
    v_mul_f32 v240, v250, v240
    v_mul_f32 v241, v250, v241
    v_cvt_pk_bf16_f32 v20, v240, v241
    v_mul_f32 v242, v250, v242
    v_mul_f32 v243, v250, v243
    v_cvt_pk_bf16_f32 v21, v242, v243
    v_mul_f32 v244, v250, v244
    v_mul_f32 v245, v250, v245
    s_add_u32 s84, s58, 16384
    buffer_load_dwordx4 a[80:83], v155, s[28:31], s84 offen sc1
    buffer_load_dwordx4 a[84:87], v155, s[28:31], s84 offen offset:1024 sc1
    v_mfma_f32_32x32x16_bf16 v[224:239], v[132:135], a[20:23], v[224:239]
    ds_read_b64_tr_b16 v[142:143], v179 offset:17472
    v_cvt_pk_bf16_f32 v22, v244, v245
    v_mul_f32 v246, v250, v246
    v_mul_f32 v247, v250, v247
    v_cvt_pk_bf16_f32 v23, v246, v247
    v_max3_f32 v248, v24, v25, v26
    v_min3_f32 v249, v24, v25, v26
    v_max3_f32 v248, v248, v27, v28
    v_min3_f32 v249, v249, v27, v28
    v_max3_f32 v248, v248, v29, v30
    v_min3_f32 v249, v249, v29, v30
    v_max_f32 v248, v248, v31
    v_max_f32_e64 v249, -v249, -v31
    s_nop 1
    v_permlane32_swap_b32 v248, v249
    v_max_f32 v248, v248, v249
    v_mul_f32_e64 v248, -v248, v173
    v_mov_b32 v249, v248
    s_nop 1
    v_permlane32_swap_b32 v248, v249
    v_fma_f32 v240, v24, v173, v248
    v_fma_f32 v24, -v24, v173, v249
    v_exp_f32 v240, v240
    v_exp_f32 v24, v24
    v_fma_f32 v241, v25, v173, v248
    v_fma_f32 v25, -v25, v173, v249
    v_exp_f32 v241, v241
    v_exp_f32 v25, v25
    v_fma_f32 v242, v26, v173, v248
    v_fma_f32 v26, -v26, v173, v249
    v_add_f32 v250, v240, v241
    v_exp_f32 v242, v242
    v_add_f32 v251, v24, v25
    v_exp_f32 v26, v26
    s_waitcnt lgkmcnt(2)
    v_mfma_f32_32x32x16_bf16 v[96:111], v[136:139], a[24:27], v[96:111]
    ds_read_b64_tr_b16 v[128:129], v174 offset:49344
    v_fma_f32 v243, v27, v173, v248
    v_fma_f32 v27, -v27, v173, v249
    v_add_f32 v250, v250, v242
    v_exp_f32 v243, v243
    v_add_f32 v251, v251, v26
    v_exp_f32 v27, v27
    v_fma_f32 v244, v28, v173, v248
    v_fma_f32 v28, -v28, v173, v249
    v_add_f32 v250, v250, v243
    v_exp_f32 v244, v244
    v_add_f32 v251, v251, v27
    v_exp_f32 v28, v28
    v_fma_f32 v245, v29, v173, v248
    v_fma_f32 v29, -v29, v173, v249
    v_add_f32 v250, v250, v244
    v_exp_f32 v245, v245
    v_add_f32 v251, v251, v28
    v_exp_f32 v29, v29
    v_fma_f32 v246, v30, v173, v248
    v_fma_f32 v30, -v30, v173, v249
    v_add_f32 v250, v250, v245
    v_exp_f32 v246, v246
    v_add_f32 v251, v251, v29
    v_exp_f32 v30, v30
    v_fma_f32 v247, v31, v173, v248
    v_fma_f32 v31, -v31, v173, v249
    v_add_f32 v250, v250, v246
    s_add_u32 s84, s59, 16384
    buffer_load_dwordx4 a[88:91], v155, s[28:31], s84 offen sc1
    buffer_load_dwordx4 a[92:95], v155, s[28:31], s84 offen offset:1024 sc1
    v_mfma_f32_32x32x16_bf16 v[112:127], v[136:139], a[28:31], v[112:127]
    ds_read_b64_tr_b16 v[130:131], v174 offset:50368
    v_exp_f32 v247, v247
    v_add_f32 v251, v251, v30
    v_exp_f32 v31, v31
    v_add_f32 v250, v250, v247
    v_add_f32 v251, v251, v31
    s_nop 1
    v_permlane32_swap_b32 v250, v251
    v_add_f32 v250, v250, v251
    v_rcp_f32 v250, v250
    s_nop 0
    v_mov_b32 v251, v250
    s_nop 1
    v_permlane32_swap_b32 v250, v251
    v_mul_f32 v24, v251, v24
    v_mul_f32 v25, v251, v25
    v_cvt_pk_bf16_f32 v24, v24, v25
    v_mul_f32 v26, v251, v26
    v_mul_f32 v27, v251, v27
    v_cvt_pk_bf16_f32 v25, v26, v27
    v_mul_f32 v28, v251, v28
    v_mul_f32 v29, v251, v29
    v_cvt_pk_bf16_f32 v26, v28, v29
    v_mul_f32 v30, v251, v30
    v_mul_f32 v31, v251, v31
    v_cvt_pk_bf16_f32 v27, v30, v31
    v_mul_f32 v240, v250, v240
    v_mul_f32 v241, v250, v241
    v_cvt_pk_bf16_f32 v28, v240, v241
    v_mul_f32 v242, v250, v242
    v_mul_f32 v243, v250, v243
    v_cvt_pk_bf16_f32 v29, v242, v243
    v_mul_f32 v244, v250, v244
    v_mul_f32 v245, v250, v245
    v_cvt_pk_bf16_f32 v30, v244, v245
    v_mul_f32 v246, v250, v246
    v_mul_f32 v247, v250, v247
    v_cvt_pk_bf16_f32 v31, v246, v247
    s_waitcnt lgkmcnt(2)
    v_mfma_f32_32x32x16_bf16 v[208:223], v[140:143], a[24:27], v[208:223]
    ds_read_b64_tr_b16 v[132:133], v175 offset:49344
    s_add_u32 m0, s81, 148032
    s_lshl3_add_u32 s83, s62, s94
    buffer_load_dwordx4 v198, s[20:23], s83 offen lds
    buffer_load_dwordx4 v199, s[20:23], s83 offen offset:1024 lds
    buffer_load_dwordx4 v[32:35], v152, s[28:31], 0 offen offset:0 sc1
    buffer_load_dwordx4 v[36:39], v152, s[28:31], 0 offen offset:544 sc1
    s_add_u32 s84, s60, 16384
    buffer_load_dwordx4 a[96:99], v155, s[28:31], s84 offen sc1
    buffer_load_dwordx4 a[100:103], v155, s[28:31], s84 offen offset:1024 sc1
    v_mfma_f32_32x32x16_bf16 v[224:239], v[140:143], a[28:31], v[224:239]
    ds_read_b64_tr_b16 v[134:135], v175 offset:50368
    buffer_load_dwordx4 v[40:43], v152, s[28:31], 0 offen offset:1088 sc1
    buffer_load_dwordx4 v[44:47], v152, s[28:31], 0 offen offset:1632 sc1
    buffer_load_dwordx4 v[48:51], v152, s[28:31], 0 offen offset:2176 sc1
    buffer_load_dwordx4 v[52:55], v152, s[28:31], 0 offen offset:2720 sc1
    buffer_load_dwordx4 v[56:59], v152, s[28:31], 0 offen offset:3264 sc1
    buffer_load_dwordx4 v[60:63], v152, s[28:31], 0 offen offset:3808 sc1
    s_waitcnt lgkmcnt(2)
    v_mfma_f32_32x32x16_bf16 v[96:111], v[128:131], a[32:35], v[96:111]
    ds_read_b64_tr_b16 v[136:137], v176 offset:16448
    s_add_u32 s84, s61, 16384
    buffer_load_dwordx4 a[104:107], v155, s[28:31], s84 offen sc1
    buffer_load_dwordx4 a[108:111], v155, s[28:31], s84 offen offset:1024 sc1
    v_mfma_f32_32x32x16_bf16 v[112:127], v[128:131], a[36:39], v[112:127]
    ds_read_b64_tr_b16 v[138:139], v176 offset:17472
    s_waitcnt lgkmcnt(2)
    v_mfma_f32_32x32x16_bf16 v[208:223], v[132:135], a[32:35], v[208:223]
    ds_read_b64_tr_b16 v[140:141], v177 offset:16448
    s_add_u32 m0, s81, 49344
    s_lshl3_add_u32 s83, s63, s94
L_padB0_3:
    s_cbranch_execz L_retB0
    buffer_load_dwordx4 v198, s[20:23], s83 offen lds
    buffer_load_dwordx4 v199, s[20:23], s83 offen offset:1024 lds
    s_add_u32 s94, s94, 131072
    s_add_u32 s84, s62, 16384
    buffer_load_dwordx4 a[112:115], v155, s[28:31], s84 offen sc1
    buffer_load_dwordx4 a[116:119], v155, s[28:31], s84 offen offset:1024 sc1
    v_mfma_f32_32x32x16_bf16 v[224:239], v[132:135], a[36:39], v[224:239]
    ds_read_b64_tr_b16 v[142:143], v177 offset:17472
    s_waitcnt lgkmcnt(2)
    v_mfma_f32_32x32x16_bf16 v[96:111], v[136:139], a[40:43], v[96:111]
    ds_read_b64_tr_b16 v[128:129], v174 offset:0
    s_waitcnt vmcnt(15)
    v_max3_u32 v254, v32, v33, v34
    s_waitcnt vmcnt(14)
    v_max3_u32 v254, v254, v35, v36
    v_max3_u32 v254, v254, v37, v38
    s_waitcnt vmcnt(11)
    v_max3_u32 v254, v254, v39, v40
    v_max3_u32 v254, v254, v41, v42
    s_waitcnt vmcnt(10)
    v_max3_u32 v254, v254, v43, v44
    v_max3_u32 v254, v254, v45, v46
    s_waitcnt vmcnt(9)
    v_max3_u32 v254, v254, v47, v48
    v_max3_u32 v254, v254, v49, v50
    s_waitcnt vmcnt(8)
    v_max3_u32 v254, v254, v51, v52
    v_max3_u32 v254, v254, v53, v54
    s_waitcnt vmcnt(7)
    v_max3_u32 v254, v254, v55, v56
    v_max3_u32 v254, v254, v57, v58
    s_waitcnt vmcnt(6)
    v_max3_u32 v254, v254, v59, v60
    v_max3_u32 v254, v254, v61, v62
    v_max_u32 v254, v254, v63
    v_cmp_eq_u32 vcc, -1, v254
    s_nop 4
    s_cbranch_vccz L_ok9
    s_mov_b32 s85, 200000
L_re9:
    s_sleep 1
    buffer_load_dwordx4 v[32:35], v152, s[28:31], 0 offen offset:0 sc1
    buffer_load_dwordx4 v[36:39], v152, s[28:31], 0 offen offset:544 sc1
    buffer_load_dwordx4 v[40:43], v152, s[28:31], 0 offen offset:1088 sc1
    buffer_load_dwordx4 v[44:47], v152, s[28:31], 0 offen offset:1632 sc1
    buffer_load_dwordx4 v[48:51], v152, s[28:31], 0 offen offset:2176 sc1
    buffer_load_dwordx4 v[52:55], v152, s[28:31], 0 offen offset:2720 sc1
    buffer_load_dwordx4 v[56:59], v152, s[28:31], 0 offen offset:3264 sc1
    buffer_load_dwordx4 v[60:63], v152, s[28:31], 0 offen offset:3808 sc1
    s_waitcnt vmcnt(0)
    v_max3_u32 v254, v32, v33, v34
    v_max3_u32 v254, v254, v35, v36
    v_max3_u32 v254, v254, v37, v38
    v_max3_u32 v254, v254, v39, v40
    v_max3_u32 v254, v254, v41, v42
    v_max3_u32 v254, v254, v43, v44
    v_max3_u32 v254, v254, v45, v46
    v_max3_u32 v254, v254, v47, v48
    v_max3_u32 v254, v254, v49, v50
    v_max3_u32 v254, v254, v51, v52
    v_max3_u32 v254, v254, v53, v54
    v_max3_u32 v254, v254, v55, v56
    v_max3_u32 v254, v254, v57, v58
    v_max3_u32 v254, v254, v59, v60
    v_max3_u32 v254, v254, v61, v62
    v_max_u32 v254, v254, v63
    v_cmp_eq_u32 vcc, -1, v254
    s_sub_u32 s85, s85, 1
    s_cbranch_scc1 L_ok9
    s_nop 2
    s_cbranch_vccnz L_re9
L_ok9:
    s_add_u32 s84, s63, 16384
    buffer_load_dwordx4 a[120:123], v155, s[28:31], s84 offen sc1
    buffer_load_dwordx4 a[124:127], v155, s[28:31], s84 offen offset:1024 sc1
    v_mfma_f32_32x32x16_bf16 v[112:127], v[136:139], a[44:47], v[112:127]
    ds_read_b64_tr_b16 v[130:131], v174 offset:1024
    v_cvt_pk_bf16_f32 v32, v32, v33
    v_cvt_pk_bf16_f32 v33, v34, v35
    v_cvt_pk_bf16_f32 v34, v36, v37
    v_cvt_pk_bf16_f32 v35, v38, v39
    v_cvt_pk_bf16_f32 v36, v40, v41
    v_cvt_pk_bf16_f32 v37, v42, v43
    v_cvt_pk_bf16_f32 v38, v44, v45
    v_cvt_pk_bf16_f32 v39, v46, v47
    v_cvt_pk_bf16_f32 v48, v48, v49
    v_cvt_pk_bf16_f32 v49, v50, v51
    v_cvt_pk_bf16_f32 v50, v52, v53
    v_cvt_pk_bf16_f32 v51, v54, v55
    v_cvt_pk_bf16_f32 v52, v56, v57
    v_cvt_pk_bf16_f32 v53, v58, v59
    v_cvt_pk_bf16_f32 v54, v60, v61
    v_cvt_pk_bf16_f32 v55, v62, v63
    v_mfma_f32_32x32x16_bf16 v[64:79], v[32:35], v[4:7], 0
    v_mfma_f32_32x32x16_bf16 v[64:79], v[36:39], v[0:3], v[64:79]
    v_mfma_f32_32x32x16_bf16 v[80:95], v[32:35], v[20:23], 0
    v_mfma_f32_32x32x16_bf16 v[80:95], v[36:39], v[16:19], v[80:95]
    s_nop 9
    v_add_f32 v72, 0x358637bd, v72
    s_waitcnt lgkmcnt(2)
    v_mfma_f32_32x32x16_bf16 v[208:223], v[140:143], a[40:43], v[208:223]
    ds_read_b64_tr_b16 v[132:133], v175 offset:0
    v_rcp_f32 v72, v72
    s_nop 0
    v_mul_f32 v64, v72, v64
    v_mul_f32 v65, v72, v65
    v_cvt_pk_bf16_f32 v64, v64, v65
    v_mul_f32 v66, v72, v66
    v_mul_f32 v67, v72, v67
    v_cvt_pk_bf16_f32 v65, v66, v67
    v_mul_f32 v68, v72, v68
    v_mul_f32 v69, v72, v69
    v_cvt_pk_bf16_f32 v66, v68, v69
    v_mul_f32 v70, v72, v70
    v_mul_f32 v71, v72, v71
    v_cvt_pk_bf16_f32 v67, v70, v71
    s_mov_b32 s84, 57344
    buffer_store_dwordx4 v[64:67], v196, s[28:31], s84 offen offset:0 sc1
    s_nop 1
    v_mfma_f32_32x32x16_bf16 v[64:79], v[48:51], v[12:15], 0
    v_mfma_f32_32x32x16_bf16 v[64:79], v[52:55], v[8:11], v[64:79]
    v_add_f32 v88, 0x358637bd, v88
    v_rcp_f32 v88, v88
    s_nop 0
    v_mul_f32 v80, v88, v80
    v_mul_f32 v81, v88, v81
    v_mfma_f32_32x32x16_bf16 v[224:239], v[140:143], a[44:47], v[224:239]
    ds_read_b64_tr_b16 v[134:135], v175 offset:1024
    v_cvt_pk_bf16_f32 v80, v80, v81
    v_mul_f32 v82, v88, v82
    v_mul_f32 v83, v88, v83
    v_cvt_pk_bf16_f32 v81, v82, v83
    v_mul_f32 v84, v88, v84
    v_mul_f32 v85, v88, v85
    v_cvt_pk_bf16_f32 v82, v84, v85
    v_mul_f32 v86, v88, v86
    v_mul_f32 v87, v88, v87
    v_cvt_pk_bf16_f32 v83, v86, v87
    s_mov_b32 s84, 57344
    buffer_store_dwordx4 v[80:83], v196, s[28:31], s84 offen offset:1024 sc1
    s_nop 1
    v_mfma_f32_32x32x16_bf16 v[80:95], v[48:51], v[28:31], 0
    v_mfma_f32_32x32x16_bf16 v[80:95], v[52:55], v[24:27], v[80:95]
    v_add_f32 v72, 0x358637bd, v72
    v_rcp_f32 v72, v72
    s_nop 0
    v_mul_f32 v64, v72, v64
    v_mul_f32 v65, v72, v65
    v_cvt_pk_bf16_f32 v64, v64, v65
    v_mul_f32 v66, v72, v66
    v_mul_f32 v67, v72, v67
    v_cvt_pk_bf16_f32 v65, v66, v67
    s_waitcnt lgkmcnt(2)
    v_mfma_f32_32x32x16_bf16 v[96:111], v[128:131], a[48:51], v[96:111]
    ds_read_b64_tr_b16 v[136:137], v176 offset:32896
    v_mul_f32 v68, v72, v68
L_padB1_11:
    s_cbranch_execz L_retB1
    v_mul_f32 v69, v72, v69
    v_cvt_pk_bf16_f32 v66, v68, v69
    v_mul_f32 v70, v72, v70
    v_mul_f32 v71, v72, v71
    v_cvt_pk_bf16_f32 v67, v70, v71
    s_mov_b32 s84, 57344
    buffer_store_dwordx4 v[64:67], v196, s[28:31], s84 offen offset:2048 sc1
    v_add_f32 v88, 0x358637bd, v88
    v_rcp_f32 v88, v88
    s_nop 0
    v_mul_f32 v80, v88, v80
    v_mul_f32 v81, v88, v81
    v_cvt_pk_bf16_f32 v80, v80, v81
    v_mul_f32 v82, v88, v82
    v_mul_f32 v83, v88, v83
    v_cvt_pk_bf16_f32 v81, v82, v83
    v_mul_f32 v84, v88, v84
    v_mul_f32 v85, v88, v85
    v_cvt_pk_bf16_f32 v82, v84, v85
    v_mul_f32 v86, v88, v86
    v_mul_f32 v87, v88, v87
    v_cvt_pk_bf16_f32 v83, v86, v87
    s_mov_b32 s84, 57344
    buffer_store_dwordx4 v[80:83], v196, s[28:31], s84 offen offset:3072 sc1
    v_mfma_f32_32x32x16_bf16 v[112:127], v[128:131], a[52:55], v[112:127]
    ds_read_b64_tr_b16 v[138:139], v176 offset:33920
    s_waitcnt lgkmcnt(2)
    v_mfma_f32_32x32x16_bf16 v[208:223], v[132:135], a[48:51], v[208:223]
    ds_read_b64_tr_b16 v[140:141], v177 offset:32896
    s_add_u32 m0, s81, 0
    s_and_b32 s83, s56, 0x1800
    s_lshl3_add_u32 s83, s83, s94
    buffer_load_dwordx4 v198, s[20:23], s83 offen lds
    buffer_load_dwordx4 v199, s[20:23], s83 offen offset:1024 lds
    v_mfma_f32_32x32x16_bf16 v[224:239], v[132:135], a[52:55], v[224:239]
    ds_read_b64_tr_b16 v[142:143], v177 offset:33920
    s_waitcnt lgkmcnt(2)
    v_mfma_f32_32x32x16_bf16 v[96:111], v[136:139], a[56:59], v[96:111]
    ds_read_b64_tr_b16 v[128:129], v176 offset:41120
    v_mfma_f32_32x32x16_bf16 v[112:127], v[136:139], a[60:63], v[112:127]
    ds_read_b64_tr_b16 v[130:131], v176 offset:42144
    buffer_load_dword v188, v253, s[28:31], 0 offen sc1
    s_waitcnt lgkmcnt(2)
    v_mfma_f32_32x32x16_bf16 v[208:223], v[140:143], a[56:59], v[208:223]
    ds_read_b64_tr_b16 v[132:133], v177 offset:41120
    v_mfma_f32_32x32x16_bf16 v[224:239], v[140:143], a[60:63], v[224:239]
    ds_read_b64_tr_b16 v[134:135], v177 offset:42144
    s_waitcnt lgkmcnt(2)
    v_mfma_f32_32x32x16_bf16 v[96:111], v[128:131], a[64:67], v[96:111]
    ds_read_b64_tr_b16 v[136:137], v176 offset:49344
    v_mfma_f32_32x32x16_bf16 v[112:127], v[128:131], a[68:71], v[112:127]
    ds_read_b64_tr_b16 v[138:139], v176 offset:50368
    s_waitcnt lgkmcnt(2)
    v_mfma_f32_32x32x16_bf16 v[208:223], v[132:135], a[64:67], v[208:223]
    ds_read_b64_tr_b16 v[140:141], v177 offset:49344
    s_add_u32 m0, s81, 82240
    s_and_b32 s83, s57, 0x1800
    s_lshl3_add_u32 s83, s83, s94
    buffer_load_dwordx4 v198, s[20:23], s83 offen lds
    buffer_load_dwordx4 v199, s[20:23], s83 offen offset:1024 lds
    v_mfma_f32_32x32x16_bf16 v[224:239], v[132:135], a[68:71], v[224:239]
    ds_read_b64_tr_b16 v[142:143], v177 offset:50368
    s_waitcnt lgkmcnt(2)
    v_mfma_f32_32x32x16_bf16 v[96:111], v[136:139], a[72:75], v[96:111]
    ds_read_b64_tr_b16 v[128:129], v176 offset:57568
    v_mfma_f32_32x32x16_bf16 v[112:127], v[136:139], a[76:79], v[112:127]
    ds_read_b64_tr_b16 v[130:131], v176 offset:58592
    s_waitcnt lgkmcnt(2)
    v_mfma_f32_32x32x16_bf16 v[208:223], v[140:143], a[72:75], v[208:223]
    ds_read_b64_tr_b16 v[132:133], v177 offset:57568
    v_mfma_f32_32x32x16_bf16 v[224:239], v[140:143], a[76:79], v[224:239]
    ds_read_b64_tr_b16 v[134:135], v177 offset:58592
    s_waitcnt vmcnt(5)
    v_mov_b32 v190, 3
    buffer_store_dword v190, v252, s[28:31], 0 offen sc1
    s_waitcnt lgkmcnt(2)
    v_mfma_f32_32x32x16_bf16 v[96:111], v[128:131], a[80:83], v[96:111]
    ds_read_b64_tr_b16 v[136:137], v174 offset:16448
    v_mfma_f32_32x32x16_bf16 v[112:127], v[128:131], a[84:87], v[112:127]
    ds_read_b64_tr_b16 v[138:139], v174 offset:17472
    s_waitcnt lgkmcnt(2)
    v_mfma_f32_32x32x16_bf16 v[208:223], v[132:135], a[80:83], v[208:223]
    ds_read_b64_tr_b16 v[140:141], v175 offset:16448
    s_add_u32 m0, s81, 98688
    s_and_b32 s83, s58, 0x1800
    s_lshl3_add_u32 s83, s83, s94
    buffer_load_dwordx4 v198, s[20:23], s83 offen lds
    buffer_load_dwordx4 v199, s[20:23], s83 offen offset:1024 lds
    v_mfma_f32_32x32x16_bf16 v[224:239], v[132:135], a[84:87], v[224:239]
    ds_read_b64_tr_b16 v[142:143], v175 offset:17472
    s_waitcnt lgkmcnt(2)
    v_mfma_f32_32x32x16_bf16 v[96:111], v[136:139], a[88:91], v[96:111]
    ds_read_b64_tr_b16 v[128:129], v174 offset:24672
    v_mfma_f32_32x32x16_bf16 v[112:127], v[136:139], a[92:95], v[112:127]
    ds_read_b64_tr_b16 v[130:131], v174 offset:25696
    v_cndmask_b32 v189, 1, 2, s[92:93]
    s_waitcnt vmcnt(5)
    v_cmp_gt_u32 vcc, v189, v188
    s_nop 4
    s_cbranch_vccz L_ok12
    s_mov_b32 s85, 200000
L_re12:
    s_sleep 1
    buffer_load_dword v188, v253, s[28:31], 0 offen sc1
    s_waitcnt vmcnt(0)
    v_cmp_gt_u32 vcc, v189, v188
    s_sub_u32 s85, s85, 1
    s_cbranch_scc1 L_ok12
    s_nop 2
    s_cbranch_vccnz L_re12
L_ok12:
    s_add_u32 s84, s56, 32768
    buffer_load_dwordx4 a[128:131], v155, s[28:31], s84 offen sc1
    buffer_load_dwordx4 a[132:135], v155, s[28:31], s84 offen offset:1024 sc1
    s_waitcnt lgkmcnt(2)
    v_mfma_f32_32x32x16_bf16 v[208:223], v[140:143], a[88:91], v[208:223]
    ds_read_b64_tr_b16 v[132:133], v175 offset:24672
    v_mfma_f32_32x32x16_bf16 v[224:239], v[140:143], a[92:95], v[224:239]
    ds_read_b64_tr_b16 v[134:135], v175 offset:25696
    s_waitcnt lgkmcnt(2)
    v_mfma_f32_32x32x16_bf16 v[96:111], v[128:131], a[96:99], v[96:111]
    ds_read_b64_tr_b16 v[136:137], v174 offset:32896
    v_mfma_f32_32x32x16_bf16 v[112:127], v[128:131], a[100:103], v[112:127]
    ds_read_b64_tr_b16 v[138:139], v174 offset:33920
    s_add_u32 s84, s57, 32768
    buffer_load_dwordx4 a[136:139], v155, s[28:31], s84 offen sc1
    buffer_load_dwordx4 a[140:143], v155, s[28:31], s84 offen offset:1024 sc1
    s_waitcnt lgkmcnt(2)
    v_mfma_f32_32x32x16_bf16 v[208:223], v[132:135], a[96:99], v[208:223]
    ds_read_b64_tr_b16 v[140:141], v175 offset:32896
    s_add_u32 m0, s81, 16448
    s_and_b32 s83, s59, 0x1800
    s_lshl3_add_u32 s83, s83, s94
    buffer_load_dwordx4 v198, s[20:23], s83 offen lds
    buffer_load_dwordx4 v199, s[20:23], s83 offen offset:1024 lds
    v_mfma_f32_32x32x16_bf16 v[224:239], v[132:135], a[100:103], v[224:239]
    ds_read_b64_tr_b16 v[142:143], v175 offset:33920
    s_waitcnt lgkmcnt(2)
    v_mfma_f32_32x32x16_bf16 v[96:111], v[136:139], a[104:107], v[96:111]
    ds_read_b64_tr_b16 v[128:129], v176 offset:0
    v_mfma_f32_32x32x16_bf16 v[112:127], v[136:139], a[108:111], v[112:127]
    ds_read_b64_tr_b16 v[130:131], v176 offset:1024
    s_add_u32 s84, s58, 32768
    buffer_load_dwordx4 a[144:147], v155, s[28:31], s84 offen sc1
    buffer_load_dwordx4 a[148:151], v155, s[28:31], s84 offen offset:1024 sc1
    s_waitcnt lgkmcnt(2)
    v_mfma_f32_32x32x16_bf16 v[208:223], v[140:143], a[104:107], v[208:223]
    ds_read_b64_tr_b16 v[132:133], v177 offset:0
    s_add_u32 m0, s81, 24672
    s_lshl3_add_u32 s83, s56, s95
    buffer_load_dwordx4 v198, s[24:27], s83 offen lds
    buffer_load_dwordx4 v199, s[24:27], s83 offen offset:1024 lds
    v_mfma_f32_32x32x16_bf16 v[224:239], v[140:143], a[108:111], v[224:239]
L_padB1_12:
    s_cbranch_execz L_retB1
    ds_read_b64_tr_b16 v[134:135], v177 offset:1024
    s_waitcnt lgkmcnt(2)
    v_mfma_f32_32x32x16_bf16 v[96:111], v[128:131], a[112:115], v[96:111]
    ds_read_b64_tr_b16 v[136:137], v176 offset:8224
    v_mfma_f32_32x32x16_bf16 v[112:127], v[128:131], a[116:119], v[112:127]
    ds_read_b64_tr_b16 v[138:139], v176 offset:9248
    s_add_u32 s84, s59, 32768
    buffer_load_dwordx4 a[152:155], v155, s[28:31], s84 offen sc1
    buffer_load_dwordx4 a[156:159], v155, s[28:31], s84 offen offset:1024 sc1
    s_waitcnt lgkmcnt(2)
    v_mfma_f32_32x32x16_bf16 v[208:223], v[132:135], a[112:115], v[208:223]
    ds_read_b64_tr_b16 v[140:141], v177 offset:8224
    v_mfma_f32_32x32x16_bf16 v[224:239], v[132:135], a[116:119], v[224:239]
    ds_read_b64_tr_b16 v[142:143], v177 offset:9248
    s_waitcnt lgkmcnt(2)
    v_mfma_f32_32x32x16_bf16 v[96:111], v[136:139], a[120:123], v[96:111]
    ds_read_b64_tr_b16 v[128:129], v174 offset:57568
    v_mfma_f32_32x32x16_bf16 v[112:127], v[136:139], a[124:127], v[112:127]
    ds_read_b64_tr_b16 v[130:131], v174 offset:58592
    s_add_u32 s84, s60, 32768
    buffer_load_dwordx4 a[160:163], v155, s[28:31], s84 offen sc1
    buffer_load_dwordx4 a[164:167], v155, s[28:31], s84 offen offset:1024 sc1
    buffer_load_dword v182, v253, s[28:31], 0 offen sc1
    s_waitcnt lgkmcnt(2)
    v_mfma_f32_32x32x16_bf16 v[208:223], v[140:143], a[120:123], v[208:223]
    ds_read_b64_tr_b16 v[132:133], v175 offset:57568
    s_add_u32 m0, s81, 32896
    s_lshl3_add_u32 s83, s57, s95
    buffer_load_dwordx4 v198, s[24:27], s83 offen lds
    buffer_load_dwordx4 v199, s[24:27], s83 offen offset:1024 lds
    v_mfma_f32_32x32x16_bf16 v[224:239], v[140:143], a[124:127], v[224:239]
    ds_read_b64_tr_b16 v[134:135], v175 offset:58592
    s_waitcnt vmcnt(16) lgkmcnt(2)
    v_mfma_f32_32x32x16_bf16 v[96:111], v[128:131], a[128:131], v[96:111]
    ds_read_b64_tr_b16 v[136:137], v174 offset:8224
    s_waitcnt vmcnt(15)
    v_mfma_f32_32x32x16_bf16 v[112:127], v[128:131], a[132:135], v[112:127]
    ds_read_b64_tr_b16 v[138:139], v174 offset:9248
    s_add_u32 s84, s61, 32768
    buffer_load_dwordx4 a[168:171], v155, s[28:31], s84 offen sc1
    buffer_load_dwordx4 a[172:175], v155, s[28:31], s84 offen offset:1024 sc1
    s_waitcnt lgkmcnt(2)
    v_mfma_f32_32x32x16_bf16 v[208:223], v[132:135], a[128:131], v[208:223]
    ds_read_b64_tr_b16 v[140:141], v175 offset:8224
    v_mfma_f32_32x32x16_bf16 v[224:239], v[132:135], a[132:135], v[224:239]
    ds_read_b64_tr_b16 v[142:143], v175 offset:9248
    s_waitcnt vmcnt(16) lgkmcnt(2)
    v_mfma_f32_32x32x16_bf16 v[96:111], v[136:139], a[136:139], v[96:111]
    ds_read_b64_tr_b16 v[128:129], v176 offset:24672
    s_waitcnt vmcnt(15)
    v_mfma_f32_32x32x16_bf16 v[112:127], v[136:139], a[140:143], v[112:127]
    ds_read_b64_tr_b16 v[130:131], v176 offset:25696
    s_add_u32 s84, s62, 32768
    buffer_load_dwordx4 a[176:179], v155, s[28:31], s84 offen sc1
    buffer_load_dwordx4 a[180:183], v155, s[28:31], s84 offen offset:1024 sc1
    s_waitcnt lgkmcnt(2)
    v_mfma_f32_32x32x16_bf16 v[208:223], v[140:143], a[136:139], v[208:223]
    ds_read_b64_tr_b16 v[132:133], v177 offset:24672
    s_add_u32 m0, s81, 8224
    s_lshl3_add_u32 s83, s58, s95
    buffer_load_dwordx4 v198, s[24:27], s83 offen lds
    buffer_load_dwordx4 v199, s[24:27], s83 offen offset:1024 lds
    v_mfma_f32_32x32x16_bf16 v[224:239], v[140:143], a[140:143], v[224:239]
    ds_read_b64_tr_b16 v[134:135], v177 offset:25696
    s_waitcnt vmcnt(16) lgkmcnt(2)
    v_mfma_f32_32x32x16_bf16 v[96:111], v[128:131], a[144:147], v[96:111]
    ds_read_b64_tr_b16 v[136:137], v178 offset:0
    s_waitcnt vmcnt(15)
    v_mfma_f32_32x32x16_bf16 v[112:127], v[128:131], a[148:151], v[112:127]
    ds_read_b64_tr_b16 v[138:139], v178 offset:1024
    s_add_u32 s84, s63, 32768
    buffer_load_dwordx4 a[184:187], v155, s[28:31], s84 offen sc1
    buffer_load_dwordx4 a[188:191], v155, s[28:31], s84 offen offset:1024 sc1
    s_waitcnt lgkmcnt(2)
    v_mfma_f32_32x32x16_bf16 v[208:223], v[132:135], a[144:147], v[208:223]
    ds_read_b64_tr_b16 v[140:141], v179 offset:0
    v_mfma_f32_32x32x16_bf16 v[224:239], v[132:135], a[148:151], v[224:239]
    ds_read_b64_tr_b16 v[142:143], v179 offset:1024
    s_waitcnt vmcnt(14) lgkmcnt(2)
    v_mfma_f32_32x32x16_bf16 v[96:111], v[136:139], a[152:155], v[96:111]
    ds_read_b64_tr_b16 v[128:129], v178 offset:8224
    s_waitcnt vmcnt(13)
    v_mfma_f32_32x32x16_bf16 v[112:127], v[136:139], a[156:159], v[112:127]
    ds_read_b64_tr_b16 v[130:131], v178 offset:9248
    v_cndmask_b32 v189, 2, 2, s[92:93]
    s_waitcnt vmcnt(10)
    v_cmp_gt_u32 vcc, v189, v182
    s_nop 4
    s_cbranch_vccz L_ok13
    s_mov_b32 s85, 200000
L_re13:
    s_sleep 1
    buffer_load_dword v182, v253, s[28:31], 0 offen sc1
    s_waitcnt vmcnt(0)
    v_cmp_gt_u32 vcc, v189, v182
    s_sub_u32 s85, s85, 1
    s_cbranch_scc1 L_ok13
    s_nop 2
    s_cbranch_vccnz L_re13
L_ok13:
    s_and_b32 s84, s56, 0x1800
    s_add_u32 s84, s84, 49152
    buffer_load_dwordx4 a[192:195], v155, s[28:31], s84 offen sc1
    buffer_load_dwordx4 a[196:199], v155, s[28:31], s84 offen offset:1024 sc1
    s_waitcnt lgkmcnt(2)
    v_mfma_f32_32x32x16_bf16 v[208:223], v[140:143], a[152:155], v[208:223]
    ds_read_b64_tr_b16 v[132:133], v179 offset:8224
    s_add_u32 m0, s81, 57568
    s_lshl3_add_u32 s83, s59, s95
    buffer_load_dwordx4 v198, s[24:27], s83 offen lds
    buffer_load_dwordx4 v199, s[24:27], s83 offen offset:1024 lds
    v_mfma_f32_32x32x16_bf16 v[224:239], v[140:143], a[156:159], v[224:239]
    ds_read_b64_tr_b16 v[134:135], v179 offset:9248
    buffer_load_dword v188, v253, s[28:31], 0 offen sc1
    s_waitcnt lgkmcnt(2)
    v_mfma_f32_32x32x16_bf16 v[96:111], v[128:131], a[160:163], v[96:111]
    ds_read_b64_tr_b16 v[136:137], v174 offset:41120
    v_mfma_f32_32x32x16_bf16 v[112:127], v[128:131], a[164:167], v[112:127]
    ds_read_b64_tr_b16 v[138:139], v174 offset:42144
    s_and_b32 s84, s57, 0x1800
    s_add_u32 s84, s84, 49152
    buffer_load_dwordx4 a[200:203], v155, s[28:31], s84 offen sc1
    buffer_load_dwordx4 a[204:207], v155, s[28:31], s84 offen offset:1024 sc1
    s_waitcnt lgkmcnt(2)
    v_mfma_f32_32x32x16_bf16 v[208:223], v[132:135], a[160:163], v[208:223]
    ds_read_b64_tr_b16 v[140:141], v175 offset:41120
    v_mfma_f32_32x32x16_bf16 v[224:239], v[132:135], a[164:167], v[224:239]
    ds_read_b64_tr_b16 v[142:143], v175 offset:42144
    s_waitcnt vmcnt(14) lgkmcnt(2)
    v_mfma_f32_32x32x16_bf16 v[96:111], v[136:139], a[168:171], v[96:111]
    ds_read_b64_tr_b16 v[128:129], v178 offset:16448
    s_waitcnt vmcnt(13)
    v_mfma_f32_32x32x16_bf16 v[112:127], v[136:139], a[172:175], v[112:127]
    ds_read_b64_tr_b16 v[130:131], v178 offset:17472
    s_and_b32 s84, s58, 0x1800
    s_add_u32 s84, s84, 49152
    buffer_load_dwordx4 a[208:211], v155, s[28:31], s84 offen sc1
    buffer_load_dwordx4 a[212:215], v155, s[28:31], s84 offen offset:1024 sc1
    s_waitcnt lgkmcnt(2)
    v_mfma_f32_32x32x16_bf16 v[208:223], v[140:143], a[168:171], v[208:223]
    ds_read_b64_tr_b16 v[132:133], v179 offset:16448
    s_add_u32 m0, s81, 41120
    s_lshl3_add_u32 s83, s60, s95
    buffer_load_dwordx4 v198, s[24:27], s83 offen lds
    buffer_load_dwordx4 v199, s[24:27], s83 offen offset:1024 lds
    v_mfma_f32_32x32x16_bf16 v[224:239], v[140:143], a[172:175], v[224:239]
    ds_read_b64_tr_b16 v[134:135], v179 offset:17472
    s_waitcnt vmcnt(16) lgkmcnt(2)
L_padB1_13:
    s_cbranch_execz L_retB1
    v_mfma_f32_32x32x16_bf16 v[96:111], v[128:131], a[176:179], v[96:111]
    ds_read_b64_tr_b16 v[136:137], v174 offset:49344
    s_waitcnt vmcnt(15)
    v_mfma_f32_32x32x16_bf16 v[112:127], v[128:131], a[180:183], v[112:127]
    ds_read_b64_tr_b16 v[138:139], v174 offset:50368
    s_and_b32 s84, s59, 0x1800
    s_add_u32 s84, s84, 49152
    buffer_load_dwordx4 a[216:219], v155, s[28:31], s84 offen sc1
    buffer_load_dwordx4 a[220:223], v155, s[28:31], s84 offen offset:1024 sc1
    s_waitcnt lgkmcnt(2)
    v_mfma_f32_32x32x16_bf16 v[208:223], v[132:135], a[176:179], v[208:223]
    ds_read_b64_tr_b16 v[140:141], v175 offset:49344
    v_mfma_f32_32x32x16_bf16 v[224:239], v[132:135], a[180:183], v[224:239]
    ds_read_b64_tr_b16 v[142:143], v175 offset:50368
    s_waitcnt vmcnt(14) lgkmcnt(2)
    v_mfma_f32_32x32x16_bf16 v[96:111], v[136:139], a[184:187], v[96:111]
    ds_read_b64_tr_b16 v[128:129], v174 offset:0
    s_waitcnt vmcnt(13)
    v_mfma_f32_32x32x16_bf16 v[112:127], v[136:139], a[188:191], v[112:127]
    ds_read_b64_tr_b16 v[130:131], v174 offset:1024
    v_cndmask_b32 v189, 2, 3, s[92:93]
    s_waitcnt vmcnt(8)
    v_cmp_gt_u32 vcc, v189, v188
    s_nop 4
    s_cbranch_vccz L_ok14
    s_mov_b32 s85, 200000
L_re14:
    s_sleep 1
    buffer_load_dword v188, v253, s[28:31], 0 offen sc1
    s_waitcnt vmcnt(0)
    v_cmp_gt_u32 vcc, v189, v188
    s_sub_u32 s85, s85, 1
    s_cbranch_scc1 L_ok14
    s_nop 2
    s_cbranch_vccnz L_re14
L_ok14:
    s_add_u32 s84, s56, 57344
    buffer_load_dwordx4 a[224:227], v155, s[28:31], s84 offen sc1
    buffer_load_dwordx4 a[228:231], v155, s[28:31], s84 offen offset:1024 sc1
    s_waitcnt lgkmcnt(2)
    v_mfma_f32_32x32x16_bf16 v[208:223], v[140:143], a[184:187], v[208:223]
    ds_read_b64_tr_b16 v[132:133], v175 offset:0
    s_add_u32 m0, s81, 49344
    s_lshl3_add_u32 s83, s61, s95
    buffer_load_dwordx4 v198, s[24:27], s83 offen lds
    buffer_load_dwordx4 v199, s[24:27], s83 offen offset:1024 lds
    v_mfma_f32_32x32x16_bf16 v[224:239], v[140:143], a[188:191], v[224:239]
    ds_read_b64_tr_b16 v[134:135], v175 offset:1024
    s_waitcnt lgkmcnt(2)
    v_mfma_f32_32x32x16_bf16 v[96:111], v[128:131], a[192:195], v[96:111]
    ds_read_b64_tr_b16 v[136:137], v176 offset:16448
    s_lshl_b32 s83, s52, 2
    s_add_u32 s83, s83, s44
    s_lshl_b32 s83, s83, 14
    s_lshl_b32 s84, s53, 7
    s_add_u32 s83, s83, s84
    v_lshrrev_b32 v248, 3, v197
    v_lshlrev_b32 v248, 10, v248
    v_and_b32 v249, 7, v197
    v_lshl_add_u32 v248, v249, 4, v248
    v_add_u32 v185, s83, v248
    v_mfma_f32_32x32x16_bf16 v[112:127], v[128:131], a[196:199], v[112:127]
    ds_read_b64_tr_b16 v[138:139], v176 offset:17472
    s_add_u32 s84, s57, 57344
    buffer_load_dwordx4 a[232:235], v155, s[28:31], s84 offen sc1
    buffer_load_dwordx4 a[236:239], v155, s[28:31], s84 offen offset:1024 sc1
    s_mov_b32 s84, 8192
    buffer_load_dwordx4 v[240:243], v185, s[4:7], 0 offen
    buffer_load_dwordx4 v[244:247], v185, s[4:7], s84 offen
    s_waitcnt lgkmcnt(2)
    v_mfma_f32_32x32x16_bf16 v[208:223], v[132:135], a[192:195], v[208:223]
    ds_read_b64_tr_b16 v[140:141], v177 offset:16448
    v_bfe_u32 v8, v197, 3, 2
    v_mul_u32_u24 v8, 8224, v8
    v_and_b32 v9, 7, v197
    v_lshl_add_u32 v8, v9, 8, v8
    v_mfma_f32_32x32x16_bf16 v[224:239], v[132:135], a[196:199], v[224:239]
    ds_read_b64_tr_b16 v[142:143], v177 offset:17472
    v_add_u32 v8, s81, v8
    v_lshrrev_b32 v10, 5, v197
    v_xor_b32 v10, v10, v9
    s_waitcnt vmcnt(15) lgkmcnt(2)
    v_mfma_f32_32x32x16_bf16 v[96:111], v[136:139], a[200:203], v[96:111]
    ds_read_b64_tr_b16 v[128:129], v176 offset:32896
    v_lshl_add_u32 v0, v10, 4, v8
    v_xor_b32 v11, 2, v10
    v_lshl_add_u32 v1, v11, 4, v8
    s_waitcnt vmcnt(14)
    v_mfma_f32_32x32x16_bf16 v[112:127], v[136:139], a[204:207], v[112:127]
    ds_read_b64_tr_b16 v[130:131], v176 offset:33920
    s_add_u32 s84, s58, 57344
    buffer_load_dwordx4 a[240:243], v155, s[28:31], s84 offen sc1
    buffer_load_dwordx4 a[244:247], v155, s[28:31], s84 offen offset:1024 sc1
    v_xor_b32 v11, 4, v10
    s_waitcnt lgkmcnt(2)
    v_mfma_f32_32x32x16_bf16 v[208:223], v[140:143], a[200:203], v[208:223]
    ds_read_b64_tr_b16 v[132:133], v177 offset:32896
    s_add_u32 m0, s81, 0
    s_lshl3_add_u32 s83, s62, s95
    buffer_load_dwordx4 v198, s[24:27], s83 offen lds
    buffer_load_dwordx4 v199, s[24:27], s83 offen offset:1024 lds
    v_mfma_f32_32x32x16_bf16 v[224:239], v[140:143], a[204:207], v[224:239]
    ds_read_b64_tr_b16 v[134:135], v177 offset:33920
    v_lshl_add_u32 v2, v11, 4, v8
    v_xor_b32 v11, 6, v10
    v_lshl_add_u32 v3, v11, 4, v8
    s_waitcnt vmcnt(17) lgkmcnt(2)
    v_mfma_f32_32x32x16_bf16 v[96:111], v[128:131], a[208:211], v[96:111]
    ds_read_b64_tr_b16 v[136:137], v174 offset:16448
    v_lshrrev_b32 v8, 3, v197
    v_and_b32 v10, 3, v197
    v_lshlrev_b32 v10, 1, v10
    s_waitcnt vmcnt(16)
    v_mfma_f32_32x32x16_bf16 v[112:127], v[128:131], a[212:215], v[112:127]
    ds_read_b64_tr_b16 v[138:139], v174 offset:17472
    s_add_u32 s84, s59, 57344
    buffer_load_dwordx4 a[248:251], v155, s[28:31], s84 offen sc1
    buffer_load_dwordx4 a[252:255], v155, s[28:31], s84 offen offset:1024 sc1
    v_xor_b32 v10, v10, v8
    s_waitcnt lgkmcnt(2)
    v_mfma_f32_32x32x16_bf16 v[208:223], v[132:135], a[208:211], v[208:223]
    ds_read_b64_tr_b16 v[140:141], v175 offset:16448
    v_bfe_u32 v11, v197, 2, 1
    v_lshlrev_b32 v11, 7, v11
    v_lshl_add_u32 v11, v8, 8, v11
    v_mfma_f32_32x32x16_bf16 v[224:239], v[132:135], a[212:215], v[224:239]
    ds_read_b64_tr_b16 v[142:143], v175 offset:17472
    v_mov_b32 v9, s44
    v_mul_u32_u24 v9, 16448, v9
    v_add_u32 v11, v11, v9
    v_lshl_add_u32 v4, v10, 4, v11
    s_waitcnt vmcnt(15) lgkmcnt(2)
    v_mfma_f32_32x32x16_bf16 v[96:111], v[136:139], a[216:219], v[96:111]
    ds_read_b64_tr_b16 v[128:129], v174 offset:24672
    v_xor_b32 v10, 1, v10
    v_lshl_add_u32 v5, v10, 4, v11
    s_waitcnt vmcnt(14)
    v_mfma_f32_32x32x16_bf16 v[112:127], v[136:139], a[220:223], v[112:127]
    ds_read_b64_tr_b16 v[130:131], v174 offset:25696
    s_add_u32 s84, s60, 57344
    buffer_load_dwordx4 a[0:3], v155, s[28:31], s84 offen sc1
    buffer_load_dwordx4 a[4:7], v155, s[28:31], s84 offen offset:1024 sc1
    s_waitcnt lgkmcnt(2)
    v_mfma_f32_32x32x16_bf16 v[208:223], v[140:143], a[216:219], v[208:223]
    ds_read_b64_tr_b16 v[132:133], v175 offset:24672
    s_add_u32 m0, s81, 16448
    s_lshl3_add_u32 s83, s63, s95
    buffer_load_dwordx4 v198, s[24:27], s83 offen lds
    buffer_load_dwordx4 v199, s[24:27], s83 offen offset:1024 lds
    v_mfma_f32_32x32x16_bf16 v[224:239], v[140:143], a[220:223], v[224:239]
    ds_read_b64_tr_b16 v[134:135], v175 offset:25696
    v_mov_b32 v6, v185
    s_waitcnt vmcnt(17) lgkmcnt(2)
    v_mfma_f32_32x32x16_bf16 v[96:111], v[128:131], a[224:227], v[96:111]
    ds_read_b64_tr_b16 v[136:137], v174 offset:32896
    s_waitcnt vmcnt(16)
    v_mfma_f32_32x32x16_bf16 v[112:127], v[128:131], a[228:231], v[112:127]
    ds_read_b64_tr_b16 v[138:139], v174 offset:33920
    s_add_u32 s84, s61, 57344
L_padB0_4:
    s_cbranch_execz L_retB0
    buffer_load_dwordx4 a[8:11], v155, s[28:31], s84 offen sc1
    buffer_load_dwordx4 a[12:15], v155, s[28:31], s84 offen offset:1024 sc1
    s_waitcnt lgkmcnt(2)
    v_mfma_f32_32x32x16_bf16 v[208:223], v[132:135], a[224:227], v[208:223]
    ds_read_b64_tr_b16 v[140:141], v175 offset:32896
    v_mfma_f32_32x32x16_bf16 v[224:239], v[132:135], a[228:231], v[224:239]
    ds_read_b64_tr_b16 v[142:143], v175 offset:33920
    s_waitcnt vmcnt(15) lgkmcnt(2)
    v_mfma_f32_32x32x16_bf16 v[96:111], v[136:139], a[232:235], v[96:111]
    ds_read_b64_tr_b16 v[128:129], v174 offset:8224
    s_waitcnt vmcnt(14)
    v_mfma_f32_32x32x16_bf16 v[112:127], v[136:139], a[236:239], v[112:127]
    ds_read_b64_tr_b16 v[130:131], v174 offset:9248
    s_add_u32 s84, s62, 57344
    buffer_load_dwordx4 a[16:19], v155, s[28:31], s84 offen sc1
    buffer_load_dwordx4 a[20:23], v155, s[28:31], s84 offen offset:1024 sc1
    s_waitcnt lgkmcnt(2)
    v_mfma_f32_32x32x16_bf16 v[208:223], v[140:143], a[232:235], v[208:223]
    ds_read_b64_tr_b16 v[132:133], v175 offset:8224
    v_mfma_f32_32x32x16_bf16 v[224:239], v[140:143], a[236:239], v[224:239]
    ds_read_b64_tr_b16 v[134:135], v175 offset:9248
    s_waitcnt vmcnt(13) lgkmcnt(2)
    v_mfma_f32_32x32x16_bf16 v[96:111], v[128:131], a[240:243], v[96:111]
    ds_read_b64_tr_b16 v[136:137], v174 offset:57568
    s_waitcnt vmcnt(12)
    v_mfma_f32_32x32x16_bf16 v[112:127], v[128:131], a[244:247], v[112:127]
    ds_read_b64_tr_b16 v[138:139], v174 offset:58592
    s_add_u32 s84, s63, 57344
    buffer_load_dwordx4 a[24:27], v155, s[28:31], s84 offen sc1
    buffer_load_dwordx4 a[28:31], v155, s[28:31], s84 offen offset:1024 sc1
    s_waitcnt lgkmcnt(2)
    v_mfma_f32_32x32x16_bf16 v[208:223], v[132:135], a[240:243], v[208:223]
    ds_read_b64_tr_b16 v[140:141], v175 offset:57568
    v_mfma_f32_32x32x16_bf16 v[224:239], v[132:135], a[244:247], v[224:239]
    ds_read_b64_tr_b16 v[142:143], v175 offset:58592
    s_waitcnt vmcnt(11) lgkmcnt(2)
    v_mfma_f32_32x32x16_bf16 v[96:111], v[136:139], a[248:251], v[96:111]
    ds_read_b64_tr_b16 v[128:129], v174 offset:41120
    v_lshlrev_b32 v64, 16, v240
    s_waitcnt vmcnt(10)
    v_mfma_f32_32x32x16_bf16 v[112:127], v[136:139], a[252:255], v[112:127]
    ds_read_b64_tr_b16 v[130:131], v174 offset:42144
    v_and_b32 v65, 0xffff0000, v240
    v_lshlrev_b32 v66, 16, v241
    s_waitcnt lgkmcnt(2)
    v_mfma_f32_32x32x16_bf16 v[208:223], v[140:143], a[248:251], v[208:223]
    ds_read_b64_tr_b16 v[132:133], v175 offset:41120
    v_and_b32 v67, 0xffff0000, v241
    v_mfma_f32_32x32x16_bf16 v[224:239], v[140:143], a[252:255], v[224:239]
    ds_read_b64_tr_b16 v[134:135], v175 offset:42144
    v_lshlrev_b32 v68, 16, v242
    v_and_b32 v69, 0xffff0000, v242
    s_waitcnt vmcnt(9) lgkmcnt(2)
    v_mfma_f32_32x32x16_bf16 v[96:111], v[128:131], a[0:3], v[96:111]
    ds_read_b64_tr_b16 v[136:137], v174 offset:49344
    v_lshlrev_b32 v70, 16, v243
    s_waitcnt vmcnt(8)
    v_mfma_f32_32x32x16_bf16 v[112:127], v[128:131], a[4:7], v[112:127]
    ds_read_b64_tr_b16 v[138:139], v174 offset:50368
    v_and_b32 v71, 0xffff0000, v243
    s_waitcnt lgkmcnt(2)
    v_mfma_f32_32x32x16_bf16 v[208:223], v[132:135], a[0:3], v[208:223]
    ds_read_b64_tr_b16 v[140:141], v175 offset:49344
    v_lshlrev_b32 v72, 16, v244
    v_and_b32 v73, 0xffff0000, v244
    v_mfma_f32_32x32x16_bf16 v[224:239], v[132:135], a[4:7], v[224:239]
    ds_read_b64_tr_b16 v[142:143], v175 offset:50368
    v_lshlrev_b32 v74, 16, v245
    s_waitcnt vmcnt(5) lgkmcnt(2)
    v_mfma_f32_32x32x16_bf16 v[96:111], v[136:139], a[8:11], v[96:111]
    ds_read_b64_tr_b16 v[128:129], v174 offset:0
    v_and_b32 v75, 0xffff0000, v245
    s_waitcnt vmcnt(4)
    v_mfma_f32_32x32x16_bf16 v[112:127], v[136:139], a[12:15], v[112:127]
    ds_read_b64_tr_b16 v[130:131], v174 offset:1024
    v_lshlrev_b32 v76, 16, v246
    v_and_b32 v77, 0xffff0000, v246
    s_waitcnt lgkmcnt(2)
    v_mfma_f32_32x32x16_bf16 v[208:223], v[140:143], a[8:11], v[208:223]
    ds_read_b64_tr_b16 v[132:133], v175 offset:0
    v_lshlrev_b32 v78, 16, v247
    v_mfma_f32_32x32x16_bf16 v[224:239], v[140:143], a[12:15], v[224:239]
    ds_read_b64_tr_b16 v[134:135], v175 offset:1024
    v_and_b32 v79, 0xffff0000, v247
    ds_read_b64_tr_b16 v[136:137], v174 offset:16448
    ds_read_b64_tr_b16 v[138:139], v174 offset:17472
    ds_read_b64_tr_b16 v[140:141], v175 offset:16448
    ds_read_b64_tr_b16 v[142:143], v175 offset:17472
    s_waitcnt vmcnt(3) lgkmcnt(6)
    v_mfma_f32_32x32x16_bf16 v[96:111], v[128:131], a[16:19], v[96:111]
    s_waitcnt vmcnt(1) lgkmcnt(2)
    v_mfma_f32_32x32x16_bf16 v[96:111], v[136:139], a[24:27], v[96:111]
    v_mfma_f32_32x32x16_bf16 v[208:223], v[132:135], a[16:19], v[208:223]
    s_waitcnt lgkmcnt(0)
    v_mfma_f32_32x32x16_bf16 v[208:223], v[140:143], a[24:27], v[208:223]
    v_mfma_f32_32x32x16_bf16 v[112:127], v[128:131], a[20:23], v[112:127]
    s_nop 7
    ds_write_b128 v0, v[96:99] offset:0
    ds_write_b128 v1, v[100:103] offset:0
    s_waitcnt vmcnt(0)
    v_mfma_f32_32x32x16_bf16 v[112:127], v[136:139], a[28:31], v[112:127]
    ds_write_b128 v2, v[104:107] offset:0
    ds_write_b128 v3, v[108:111] offset:0
    ds_write_b128 v0, v[208:211] offset:128
    v_mfma_f32_32x32x16_bf16 v[224:239], v[132:135], a[20:23], v[224:239]
    ds_write_b128 v1, v[212:215] offset:128
    ds_write_b128 v2, v[216:219] offset:128
    v_mfma_f32_32x32x16_bf16 v[224:239], v[140:143], a[28:31], v[224:239]
    ds_write_b128 v3, v[220:223] offset:128
    s_nop 3
    ds_write_b128 v0, v[112:115] offset:32896
    ds_write_b128 v1, v[116:119] offset:32896
    ds_write_b128 v2, v[120:123] offset:32896
    ds_write_b128 v3, v[124:127] offset:32896
    s_nop 2
    ds_write_b128 v0, v[224:227] offset:33024
    ds_write_b128 v1, v[228:231] offset:33024
    ds_write_b128 v2, v[232:235] offset:33024
    ds_write_b128 v3, v[236:239] offset:33024
    s_waitcnt lgkmcnt(0)
    s_barrier
    ds_read_b128 v[128:131], v4 offset:0
    ds_read_b128 v[132:135], v4 offset:2048
    ds_read_b128 v[136:139], v4 offset:4096
    ds_read_b128 v[140:143], v4 offset:6144
    ds_read_b128 v[144:147], v5 offset:0
    ds_read_b128 v[148:151], v5 offset:2048
    ds_read_b128 v[152:155], v5 offset:4096
    ds_read_b128 v[156:159], v5 offset:6144
    ds_read_b128 v[160:163], v4 offset:8224
    ds_read_b128 v[164:167], v4 offset:10272
    ds_read_b128 v[168:171], v4 offset:12320
    ds_read_b128 v[172:175], v4 offset:14368
    ds_read_b128 v[176:179], v5 offset:8224
    ds_read_b128 v[180:183], v5 offset:10272
    ds_read_b128 v[184:187], v5 offset:12320
    ds_read_b128 v[188:191], v5 offset:14368
    s_waitcnt lgkmcnt(15)
    v_pk_add_f32 v[64:65], v[64:65], v[128:129]
    v_pk_add_f32 v[66:67], v[66:67], v[130:131]
    s_waitcnt lgkmcnt(13)
    v_pk_add_f32 v[132:133], v[132:133], v[136:137]
    v_pk_add_f32 v[134:135], v[134:135], v[138:139]
    s_waitcnt lgkmcnt(12)
    v_pk_add_f32 v[64:65], v[64:65], v[140:141]
L_padB1_14:
    s_cbranch_execz L_retB1
    v_pk_add_f32 v[66:67], v[66:67], v[142:143]
    v_pk_add_f32 v[64:65], v[64:65], v[132:133]
    v_pk_add_f32 v[66:67], v[66:67], v[134:135]
    v_cvt_pk_bf16_f32 v8, v64, v65
    v_cvt_pk_bf16_f32 v9, v66, v67
    s_waitcnt lgkmcnt(11)
    v_pk_add_f32 v[68:69], v[68:69], v[144:145]
    v_pk_add_f32 v[70:71], v[70:71], v[146:147]
    s_waitcnt lgkmcnt(9)
    v_pk_add_f32 v[148:149], v[148:149], v[152:153]
    v_pk_add_f32 v[150:151], v[150:151], v[154:155]
    s_waitcnt lgkmcnt(8)
    v_pk_add_f32 v[68:69], v[68:69], v[156:157]
    v_pk_add_f32 v[70:71], v[70:71], v[158:159]
    v_pk_add_f32 v[68:69], v[68:69], v[148:149]
    v_pk_add_f32 v[70:71], v[70:71], v[150:151]
    v_cvt_pk_bf16_f32 v10, v68, v69
    v_cvt_pk_bf16_f32 v11, v70, v71
    s_mov_b32 s84, 0
    buffer_store_dwordx4 v[8:11], v6, s[32:35], s84 offen sc1
    s_waitcnt lgkmcnt(7)
    v_pk_add_f32 v[72:73], v[72:73], v[160:161]
    v_pk_add_f32 v[74:75], v[74:75], v[162:163]
    s_waitcnt lgkmcnt(5)
    v_pk_add_f32 v[164:165], v[164:165], v[168:169]
    v_pk_add_f32 v[166:167], v[166:167], v[170:171]
    s_waitcnt lgkmcnt(4)
    v_pk_add_f32 v[72:73], v[72:73], v[172:173]
    v_pk_add_f32 v[74:75], v[74:75], v[174:175]
    v_pk_add_f32 v[72:73], v[72:73], v[164:165]
    v_pk_add_f32 v[74:75], v[74:75], v[166:167]
    v_cvt_pk_bf16_f32 v12, v72, v73
    v_cvt_pk_bf16_f32 v13, v74, v75
    s_waitcnt lgkmcnt(3)
    v_pk_add_f32 v[76:77], v[76:77], v[176:177]
    v_pk_add_f32 v[78:79], v[78:79], v[178:179]
    s_waitcnt lgkmcnt(1)
    v_pk_add_f32 v[180:181], v[180:181], v[184:185]
    v_pk_add_f32 v[182:183], v[182:183], v[186:187]
    s_waitcnt lgkmcnt(0)
    v_pk_add_f32 v[76:77], v[76:77], v[188:189]
    v_pk_add_f32 v[78:79], v[78:79], v[190:191]
    v_pk_add_f32 v[76:77], v[76:77], v[180:181]
    v_pk_add_f32 v[78:79], v[78:79], v[182:183]
    v_cvt_pk_bf16_f32 v14, v76, v77
    v_cvt_pk_bf16_f32 v15, v78, v79
    s_mov_b32 s84, 8192
    buffer_store_dwordx4 v[12:15], v6, s[32:35], s84 offen sc1
    s_endpgm
L_endB:
.section .rodata,"a"
.p2align 6
.amdhsa_kernel parallel_sum__linear_kernel_hedgehog__glu_gated_bilinear__prompt_kernel
  .amdhsa_next_free_vgpr 512
  .amdhsa_next_free_sgpr 102
  .amdhsa_accum_offset 256
  .amdhsa_group_segment_fixed_size 0
  .amdhsa_kernarg_size 88
  .amdhsa_user_sgpr_count 2
  .amdhsa_user_sgpr_kernarg_segment_ptr 1
  .amdhsa_system_sgpr_workgroup_id_x 1
.end_amdhsa_kernel
```
